```python
import torch

def _softmax(x, axis=-1):
    return torch.softmax(x, dim=axis)

def _gelu(x):
    return torch.nn.functional.gelu(x, approximate='tanh')

def _silu(x):
    return torch.nn.functional.silu(x)

def _sigmoid(x):
    return torch.sigmoid(x)

def _layernorm(x, axis=-1, eps=1e-05):
    m = x.mean(dim=axis, keepdim=True)
    v = x.var(dim=axis, keepdim=True, unbiased=False)
    return (x - m) / torch.sqrt(v + eps)

def _scatter_add(tgt, idx, src, axis=0):
    return tgt.clone().index_add_(axis, idx, src)

def _segment_sum(src, seg, n):
    out = torch.zeros((n,) + src.shape[1:], dtype=src.dtype)
    return out.index_add_(0, seg, src)

def _pad(x, pw):
    flat = tuple((v for pair in reversed(pw) for v in pair))
    return torch.nn.functional.pad(x, flat)
kernel_name = 'adaLN_cond__ssm_conv_s4__geglu_ffn__prompt'

def setup_inputs():

    _w = lambda a: (lambda t: t.to(torch.bfloat16) if t.is_floating_point() else t)(torch.as_tensor(a))

    def _A_setup():
        B, L, D, N = (1, 2048, 576, 128)
        A_re = -(lambda _x: torch.exp(torch.as_tensor(_x)))((lambda *s: torch.randn(*s, dtype=torch.bfloat16) * 3.2)(D, N))
        A_im = torch.pi * (lambda *s: torch.randn(*s, dtype=torch.bfloat16) * 0.1)(D, N)
        B_re = (lambda *s: torch.randn(*s, dtype=torch.bfloat16) * 0.2)(D, N)
        B_im = (lambda *s: torch.randn(*s, dtype=torch.bfloat16) * 0.2)(D, N)
        C_re = (lambda *s: torch.randn(*s, dtype=torch.bfloat16) * 0.2)(D, N)
        C_im = (lambda *s: torch.randn(*s, dtype=torch.bfloat16) * 0.2)(D, N)
        log_dt = (lambda *s: torch.randn(*s, dtype=torch.bfloat16) * 0.1)(D) * 0.5 - 4.0
        Dskip = (lambda *s: torch.randn(*s, dtype=torch.bfloat16) * 0.1)(D)
        return {'u': _w((lambda *s: torch.randn(*s, dtype=torch.bfloat16) * 0.05)(B, L, D)), 'A_re': _w(A_re), 'A_im': _w(A_im), 'B_re': _w(B_re), 'B_im': _w(B_im), 'C_re': _w(C_re), 'C_im': _w(C_im), 'log_dt': _w(log_dt), 'Dskip': _w(Dskip)}
    _A_in = _A_setup()

    def _B_setup():
        B, S, D, F = (1, 2048, 576, 4608)
        return {'x': _w((lambda *s: torch.randn(*s, dtype=torch.bfloat16) * 0.05)(B, S, D)), 'w_gate': _w((lambda *s: torch.randn(*s, dtype=torch.bfloat16) * 0.05)(D, F)), 'w_up': _w((lambda *s: torch.randn(*s, dtype=torch.bfloat16) * 0.05)(D, F)), 'w_down': _w((lambda *s: torch.randn(*s, dtype=torch.bfloat16) * 0.05)(F, D))}
    _B_in = _B_setup()
    return {'A_u': _A_in['u'], 'A_A_re': _A_in['A_re'], 'A_A_im': _A_in['A_im'], 'A_B_re': _A_in['B_re'], 'A_B_im': _A_in['B_im'], 'A_C_re': _A_in['C_re'], 'A_C_im': _A_in['C_im'], 'A_log_dt': _A_in['log_dt'], 'A_Dskip': _A_in['Dskip'], 'B_x': _B_in['x'], 'B_w_gate': _B_in['w_gate'], 'B_w_up': _B_in['w_up'], 'B_w_down': _B_in['w_down'], 'c': _w((lambda *s: torch.randn(*s, dtype=torch.bfloat16) * 0.1)(1, 576) * 8.0), 'w_mod': _w((lambda *s: torch.randn(*s, dtype=torch.bfloat16) * 0.1)(576, 6 * 576) * 576 ** (-0.5) * 8.0)}

def reference(A_u, A_A_re, A_A_im, A_B_re, A_B_im, A_C_re, A_C_im, A_log_dt, A_Dskip, B_x, B_w_gate, B_w_up, B_w_down, c, w_mod):

    def _A_ref(u, A_re, A_im, B_re, B_im, C_re, C_im, log_dt, Dskip):
        Bsz, L, D = u.shape
        dt = torch.exp(log_dt)[:, None]
        A = A_re + 1j * A_im
        Bc = B_re + 1j * B_im
        Cc = C_re + 1j * C_im
        logdA = dt * A
        dB = dt * Bc
        l = (lambda x, dt: x.to(dt))(torch.arange(L), A_re.dtype)
        P = torch.exp(logdA[:, :, None] * l[None, None, :])
        K = torch.einsum('dn,dnl,dn->dl', Cc, P, dB).real
        L2 = 2 * L
        Kp = _pad(K, ((0, 0), (0, L)))
        up = (lambda x, *d: x.permute(*d))(u, 0, 2, 1)
        up = _pad(up, ((0, 0), (0, 0), (0, L)))
        Kf = (lambda x, axes=(-2, -1): torch.fft.rfft2(x.float(), dim=axes))(Kp[:, None, :], axes=(-2, -1))
        Uf = (lambda x, axes=(-2, -1): torch.fft.rfft2(x.float(), dim=axes))(up[:, :, None, :], axes=(-2, -1))
        Yf = Uf * Kf[None, :, :, :]
        y = (lambda x, s, axes=(-2, -1): torch.fft.irfft2(x, s=s, dim=axes).to(torch.bfloat16))(Yf, (1, L2), axes=(-2, -1))[:, :, 0, :L]
        y = (lambda x, *d: x.permute(*d))(y, 0, 2, 1) + u * Dskip[None, None, :]
        return y

    def _B_ref(x, w_gate, w_up, w_down):
        return _gelu(x @ w_gate) * (x @ w_up) @ w_down
    x = A_u
    mod = (_silu(c) @ w_mod).reshape(c.shape[0], 6, 1, -1)
    sa, ca, ga, sb, cb, gb = (mod[:, 0].clone(), mod[:, 1].clone(), mod[:, 2].clone(), mod[:, 3].clone(), mod[:, 4].clone(), mod[:, 5].clone())
    h = _layernorm(x, axis=-1) * (1 + ca) + sa
    x = x + ga * _A_ref(h, A_A_re, A_A_im, A_B_re, A_B_im, A_C_re, A_C_im, A_log_dt, A_Dskip)
    h = _layernorm(x, axis=-1) * (1 + cb) + sb
    x = x + gb * _B_ref(h, B_w_gate, B_w_up, B_w_down)
    return x
```

```asm
; @launch kernel=prep_kernel grid=(524,1,1) block=(256,1,1) lds=45088
; @launch kernel=conv_kernel grid=(253,1,1) block=(256,1,1) lds=115264
; @launch kernel=gemm1_kernel grid=(256,1,1) block=(256,1,1) lds=148480
; @launch kernel=gemm2_kernel grid=(256,1,1) block=(256,1,1) lds=147456
.amdgcn_target "amdgcn-amd-amdhsa--gfx950"
.text
.globl prep_kernel
.p2align 8
.type prep_kernel,@function
prep_kernel:
L_prep_kernel:
  s_cmp_lt_u32 s2, 288
  s_cbranch_scc1 K1_KGEN
  s_sub_u32 s2, s2, 288
  s_cmp_lt_u32 s2, 128
  s_cbranch_scc1 K1_LN1
  s_sub_u32 s2, s2, 128
  s_cmp_lt_u32 s2, 108
  s_cbranch_scc1 K1_MOD
  s_sub_u32 s2, s2, 108
  s_endpgm
K1_KGEN:
  s_load_dwordx4 s[4:7], s[0:1], 8
  s_load_dwordx4 s[8:11], s[0:1], 24
  s_load_dwordx4 s[12:15], s[0:1], 40
  s_load_dwordx2 s[16:17], s[0:1], 56
  s_load_dwordx2 s[18:19], s[0:1], 136
  v_and_b32 v1, 63, v0
  s_getpc_b64 s[96:97]
PFPC1:
  v_lshlrev_b32 v120, 7, v1
  v_min_u32 v120, K1_LN1-PFPC1-4, v120
  global_load_dword v121, v120, s[96:97]
  v_lshrrev_b32 v2, 6, v0
  s_nop 0
  v_readfirstlane_b32 s3, v2
  s_lshr_b32 s20, s3, 1
  s_and_b32 s21, s3, 1
  s_lshl_b32 s22, s2, 1
  s_add_u32 s22, s22, s20
  s_lshl_b32 s23, s22, 8
  s_lshl_b32 s24, s21, 7
  s_add_u32 s23, s23, s24
  v_lshl_add_u32 v3, v1, 1, s23
  s_lshl_b32 s24, s22, 1
  v_mov_b32 v4, s24
  s_waitcnt lgkmcnt(0)
  global_load_ushort v8, v4, s[16:17]
  global_load_ushort v9, v3, s[4:5] nt
  global_load_ushort v10, v3, s[6:7] nt
  global_load_ushort v11, v3, s[8:9] nt
  global_load_ushort v12, v3, s[10:11] nt
  global_load_ushort v13, v3, s[12:13] nt
  global_load_ushort v14, v3, s[14:15] nt
  s_add_u32 s28, s18, 2527232
  s_addc_u32 s29, s19, 0
  s_mov_b32 s30, 2368512
  s_mov_b32 s31, 0x20000
  s_mul_i32 s25, s3, 9216
  v_lshl_add_u32 v5, v1, 2, s25
  v_and_b32 v6, 15, v1
  v_lshrrev_b32 v7, 4, v1
  v_mul_u32_u24 v16, 288, v6
  v_lshl_add_u32 v16, v7, 4, v16
  v_add_u32 v16, s25, v16
  s_mul_i32 s26, s20, 4112
  s_add_u32 s26, s26, 36864
  s_waitcnt vmcnt(0)
  v_lshlrev_b32 v8, 16, v8
  v_lshlrev_b32 v9, 16, v9
  v_lshlrev_b32 v10, 16, v10
  v_lshlrev_b32 v11, 16, v11
  v_lshlrev_b32 v12, 16, v12
  v_lshlrev_b32 v13, 16, v13
  v_lshlrev_b32 v14, 16, v14
  v_mul_f32 v8, 0x3fb8aa3b, v8
  v_exp_f32 v8, v8
  s_nop 0
  v_cvt_pk_bf16_f32 v8, v8, v8
  v_lshlrev_b32 v8, 16, v8
  v_mul_f32 v9, v8, v9
  v_mul_f32 v10, v8, v10
  v_mul_f32 v11, v8, v11
  v_mul_f32 v12, v8, v12
  v_mul_f32 v40, v13, v11
  v_mul_f32 v41, v13, v12
  v_fma_f32 v40, -v14, v12, v40
  v_fma_f32 v41, v14, v11, v41
  v_mul_f32 v9, 0x3fb8aa3b, v9
  v_mul_f32 v10, 0x3e22f983, v10
  v_mul_f32 v72, 0x3f800000, v9
  v_mul_f32 v73, 0x3f800000, v10
  v_mul_f32 v75, 0x41800000, v9
  v_mul_f32 v76, 0x41800000, v10
  v_mul_f32 v78, 0x43800000, v9
  v_mul_f32 v79, 0x43800000, v10
  v_mul_f32 v81, 0x44000000, v9
  v_mul_f32 v82, 0x44000000, v10
  v_mul_f32 v84, 0x44800000, v9
  v_mul_f32 v85, 0x44800000, v10
  v_fract_f32 v73, v73
  v_fract_f32 v76, v76
  v_fract_f32 v79, v79
  v_fract_f32 v82, v82
  v_fract_f32 v85, v85
  v_exp_f32 v72, v72
  v_exp_f32 v75, v75
  v_exp_f32 v78, v78
  v_exp_f32 v81, v81
  v_exp_f32 v84, v84
  v_cos_f32 v74, v73
  v_cos_f32 v77, v76
  v_cos_f32 v80, v79
  v_cos_f32 v83, v82
  v_cos_f32 v86, v85
  v_sin_f32 v73, v73
  v_sin_f32 v76, v76
  v_sin_f32 v79, v79
  v_sin_f32 v82, v82
  v_sin_f32 v85, v85
  s_nop 0
  v_mul_f32 v18, v72, v74
  v_mul_f32 v19, v72, v73
  v_mul_f32 v20, v75, v77
  v_mul_f32 v21, v75, v76
  v_mul_f32 v22, v78, v80
  v_mul_f32 v23, v78, v79
  v_mul_f32 v24, v81, v83
  v_mul_f32 v25, v81, v82
  v_mul_f32 v26, v84, v86
  v_mul_f32 v27, v84, v85
  v_pk_mul_f32 v[38:39], v[24:25], v[22:23] op_sel:[0,0] op_sel_hi:[1,0]
  v_pk_fma_f32 v[28:29], v[24:25], v[22:23], v[38:39] op_sel:[1,1,0] op_sel_hi:[0,1,1] neg_lo:[0,1,0]
  v_pk_mul_f32 v[38:39], v[26:27], v[22:23] op_sel:[0,0] op_sel_hi:[1,0]
  v_pk_fma_f32 v[30:31], v[26:27], v[22:23], v[38:39] op_sel:[1,1,0] op_sel_hi:[0,1,1] neg_lo:[0,1,0]
  v_pk_mul_f32 v[38:39], v[26:27], v[24:25] op_sel:[0,0] op_sel_hi:[1,0]
  v_pk_fma_f32 v[32:33], v[26:27], v[24:25], v[38:39] op_sel:[1,1,0] op_sel_hi:[0,1,1] neg_lo:[0,1,0]
  v_pk_mul_f32 v[38:39], v[26:27], v[26:27] op_sel:[0,0] op_sel_hi:[1,0]
  v_pk_fma_f32 v[36:37], v[26:27], v[26:27], v[38:39] op_sel:[1,1,0] op_sel_hi:[0,1,1] neg_lo:[0,1,0]
  v_pk_mul_f32 v[38:39], v[26:27], v[28:29] op_sel:[0,0] op_sel_hi:[1,0]
  v_pk_fma_f32 v[34:35], v[26:27], v[28:29], v[38:39] op_sel:[1,1,0] op_sel_hi:[0,1,1] neg_lo:[0,1,0]
  v_mov_b32 v78, 0x00003f80
  ds_write_b32 v5, v78 offset:0
  v_cvt_pk_bf16_f32 v79, v20, -v21
  ds_write_b32 v5, v79 offset:288
  v_cvt_pk_bf16_f32 v80, v40, v41
  ds_write_b32 v5, v80 offset:4608
  v_pk_mul_f32 v[38:39], v[40:41], v[18:19] op_sel:[0,0] op_sel_hi:[1,0]
  v_pk_fma_f32 v[42:43], v[40:41], v[18:19], v[38:39] op_sel:[1,1,0] op_sel_hi:[0,1,1] neg_lo:[0,1,0]
  v_cvt_pk_bf16_f32 v80, v42, v43
  ds_write_b32 v5, v80 offset:4896
  v_pk_mul_f32 v[38:39], v[42:43], v[18:19] op_sel:[0,0] op_sel_hi:[1,0]
  v_pk_fma_f32 v[44:45], v[42:43], v[18:19], v[38:39] op_sel:[1,1,0] op_sel_hi:[0,1,1] neg_lo:[0,1,0]
  v_pk_mul_f32 v[76:77], v[20:21], v[20:21] op_sel:[0,0] op_sel_hi:[1,0]
  v_pk_fma_f32 v[72:73], v[20:21], v[20:21], v[76:77] op_sel:[1,1,0] op_sel_hi:[0,1,1] neg_lo:[0,1,0]
  v_cvt_pk_bf16_f32 v78, v44, v45
  ds_write_b32 v5, v78 offset:5184
  v_cvt_pk_bf16_f32 v79, v72, -v73
  ds_write_b32 v5, v79 offset:576
  v_pk_mul_f32 v[38:39], v[44:45], v[18:19] op_sel:[0,0] op_sel_hi:[1,0]
  v_pk_fma_f32 v[46:47], v[44:45], v[18:19], v[38:39] op_sel:[1,1,0] op_sel_hi:[0,1,1] neg_lo:[0,1,0]
  v_pk_mul_f32 v[76:77], v[72:73], v[20:21] op_sel:[0,0] op_sel_hi:[1,0]
  v_pk_fma_f32 v[74:75], v[72:73], v[20:21], v[76:77] op_sel:[1,1,0] op_sel_hi:[0,1,1] neg_lo:[0,1,0]
  v_cvt_pk_bf16_f32 v80, v46, v47
  ds_write_b32 v5, v80 offset:5472
  v_cvt_pk_bf16_f32 v81, v74, -v75
  ds_write_b32 v5, v81 offset:864
  v_pk_mul_f32 v[38:39], v[46:47], v[18:19] op_sel:[0,0] op_sel_hi:[1,0]
  v_pk_fma_f32 v[48:49], v[46:47], v[18:19], v[38:39] op_sel:[1,1,0] op_sel_hi:[0,1,1] neg_lo:[0,1,0]
  v_pk_mul_f32 v[76:77], v[74:75], v[20:21] op_sel:[0,0] op_sel_hi:[1,0]
  v_pk_fma_f32 v[72:73], v[74:75], v[20:21], v[76:77] op_sel:[1,1,0] op_sel_hi:[0,1,1] neg_lo:[0,1,0]
  v_cvt_pk_bf16_f32 v78, v48, v49
  ds_write_b32 v5, v78 offset:5760
  v_cvt_pk_bf16_f32 v79, v72, -v73
  ds_write_b32 v5, v79 offset:1152
  v_pk_mul_f32 v[38:39], v[48:49], v[18:19] op_sel:[0,0] op_sel_hi:[1,0]
  v_pk_fma_f32 v[50:51], v[48:49], v[18:19], v[38:39] op_sel:[1,1,0] op_sel_hi:[0,1,1] neg_lo:[0,1,0]
  v_pk_mul_f32 v[76:77], v[72:73], v[20:21] op_sel:[0,0] op_sel_hi:[1,0]
  v_pk_fma_f32 v[74:75], v[72:73], v[20:21], v[76:77] op_sel:[1,1,0] op_sel_hi:[0,1,1] neg_lo:[0,1,0]
  v_cvt_pk_bf16_f32 v80, v50, v51
  ds_write_b32 v5, v80 offset:6048
  v_cvt_pk_bf16_f32 v81, v74, -v75
  ds_write_b32 v5, v81 offset:1440
  v_pk_mul_f32 v[38:39], v[50:51], v[18:19] op_sel:[0,0] op_sel_hi:[1,0]
  v_pk_fma_f32 v[52:53], v[50:51], v[18:19], v[38:39] op_sel:[1,1,0] op_sel_hi:[0,1,1] neg_lo:[0,1,0]
  v_pk_mul_f32 v[76:77], v[74:75], v[20:21] op_sel:[0,0] op_sel_hi:[1,0]
  v_pk_fma_f32 v[72:73], v[74:75], v[20:21], v[76:77] op_sel:[1,1,0] op_sel_hi:[0,1,1] neg_lo:[0,1,0]
  v_cvt_pk_bf16_f32 v78, v52, v53
  ds_write_b32 v5, v78 offset:6336
  v_cvt_pk_bf16_f32 v79, v72, -v73
  ds_write_b32 v5, v79 offset:1728
  v_pk_mul_f32 v[38:39], v[52:53], v[18:19] op_sel:[0,0] op_sel_hi:[1,0]
  v_pk_fma_f32 v[54:55], v[52:53], v[18:19], v[38:39] op_sel:[1,1,0] op_sel_hi:[0,1,1] neg_lo:[0,1,0]
  v_pk_mul_f32 v[76:77], v[72:73], v[20:21] op_sel:[0,0] op_sel_hi:[1,0]
  v_pk_fma_f32 v[74:75], v[72:73], v[20:21], v[76:77] op_sel:[1,1,0] op_sel_hi:[0,1,1] neg_lo:[0,1,0]
  v_cvt_pk_bf16_f32 v80, v54, v55
  ds_write_b32 v5, v80 offset:6624
  v_cvt_pk_bf16_f32 v81, v74, -v75
  ds_write_b32 v5, v81 offset:2016
  v_pk_mul_f32 v[38:39], v[54:55], v[18:19] op_sel:[0,0] op_sel_hi:[1,0]
  v_pk_fma_f32 v[56:57], v[54:55], v[18:19], v[38:39] op_sel:[1,1,0] op_sel_hi:[0,1,1] neg_lo:[0,1,0]
  v_pk_mul_f32 v[76:77], v[74:75], v[20:21] op_sel:[0,0] op_sel_hi:[1,0]
  v_pk_fma_f32 v[72:73], v[74:75], v[20:21], v[76:77] op_sel:[1,1,0] op_sel_hi:[0,1,1] neg_lo:[0,1,0]
  v_cvt_pk_bf16_f32 v78, v56, v57
  ds_write_b32 v5, v78 offset:6912
  v_cvt_pk_bf16_f32 v79, v72, -v73
  ds_write_b32 v5, v79 offset:2304
  v_pk_mul_f32 v[38:39], v[56:57], v[18:19] op_sel:[0,0] op_sel_hi:[1,0]
  v_pk_fma_f32 v[58:59], v[56:57], v[18:19], v[38:39] op_sel:[1,1,0] op_sel_hi:[0,1,1] neg_lo:[0,1,0]
  v_pk_mul_f32 v[76:77], v[72:73], v[20:21] op_sel:[0,0] op_sel_hi:[1,0]
  v_pk_fma_f32 v[74:75], v[72:73], v[20:21], v[76:77] op_sel:[1,1,0] op_sel_hi:[0,1,1] neg_lo:[0,1,0]
  v_cvt_pk_bf16_f32 v80, v58, v59
  ds_write_b32 v5, v80 offset:7200
  v_cvt_pk_bf16_f32 v81, v74, -v75
  ds_write_b32 v5, v81 offset:2592
  v_pk_mul_f32 v[38:39], v[58:59], v[18:19] op_sel:[0,0] op_sel_hi:[1,0]
  v_pk_fma_f32 v[60:61], v[58:59], v[18:19], v[38:39] op_sel:[1,1,0] op_sel_hi:[0,1,1] neg_lo:[0,1,0]
  v_pk_mul_f32 v[76:77], v[74:75], v[20:21] op_sel:[0,0] op_sel_hi:[1,0]
  v_pk_fma_f32 v[72:73], v[74:75], v[20:21], v[76:77] op_sel:[1,1,0] op_sel_hi:[0,1,1] neg_lo:[0,1,0]
  v_cvt_pk_bf16_f32 v78, v60, v61
  ds_write_b32 v5, v78 offset:7488
  v_cvt_pk_bf16_f32 v79, v72, -v73
  ds_write_b32 v5, v79 offset:2880
  v_pk_mul_f32 v[38:39], v[60:61], v[18:19] op_sel:[0,0] op_sel_hi:[1,0]
  v_pk_fma_f32 v[62:63], v[60:61], v[18:19], v[38:39] op_sel:[1,1,0] op_sel_hi:[0,1,1] neg_lo:[0,1,0]
  v_pk_mul_f32 v[76:77], v[72:73], v[20:21] op_sel:[0,0] op_sel_hi:[1,0]
  v_pk_fma_f32 v[74:75], v[72:73], v[20:21], v[76:77] op_sel:[1,1,0] op_sel_hi:[0,1,1] neg_lo:[0,1,0]
  v_cvt_pk_bf16_f32 v80, v62, v63
  ds_write_b32 v5, v80 offset:7776
  v_cvt_pk_bf16_f32 v81, v74, -v75
  ds_write_b32 v5, v81 offset:3168
  v_pk_mul_f32 v[38:39], v[62:63], v[18:19] op_sel:[0,0] op_sel_hi:[1,0]
  v_pk_fma_f32 v[64:65], v[62:63], v[18:19], v[38:39] op_sel:[1,1,0] op_sel_hi:[0,1,1] neg_lo:[0,1,0]
  v_pk_mul_f32 v[76:77], v[74:75], v[20:21] op_sel:[0,0] op_sel_hi:[1,0]
  v_pk_fma_f32 v[72:73], v[74:75], v[20:21], v[76:77] op_sel:[1,1,0] op_sel_hi:[0,1,1] neg_lo:[0,1,0]
  v_cvt_pk_bf16_f32 v78, v64, v65
  ds_write_b32 v5, v78 offset:8064
  v_cvt_pk_bf16_f32 v79, v72, -v73
  ds_write_b32 v5, v79 offset:3456
  v_pk_mul_f32 v[38:39], v[64:65], v[18:19] op_sel:[0,0] op_sel_hi:[1,0]
  v_pk_fma_f32 v[66:67], v[64:65], v[18:19], v[38:39] op_sel:[1,1,0] op_sel_hi:[0,1,1] neg_lo:[0,1,0]
  v_pk_mul_f32 v[76:77], v[72:73], v[20:21] op_sel:[0,0] op_sel_hi:[1,0]
  v_pk_fma_f32 v[74:75], v[72:73], v[20:21], v[76:77] op_sel:[1,1,0] op_sel_hi:[0,1,1] neg_lo:[0,1,0]
  v_cvt_pk_bf16_f32 v80, v66, v67
  ds_write_b32 v5, v80 offset:8352
  v_cvt_pk_bf16_f32 v81, v74, -v75
  ds_write_b32 v5, v81 offset:3744
  v_pk_mul_f32 v[38:39], v[66:67], v[18:19] op_sel:[0,0] op_sel_hi:[1,0]
  v_pk_fma_f32 v[68:69], v[66:67], v[18:19], v[38:39] op_sel:[1,1,0] op_sel_hi:[0,1,1] neg_lo:[0,1,0]
  v_pk_mul_f32 v[76:77], v[74:75], v[20:21] op_sel:[0,0] op_sel_hi:[1,0]
  v_pk_fma_f32 v[72:73], v[74:75], v[20:21], v[76:77] op_sel:[1,1,0] op_sel_hi:[0,1,1] neg_lo:[0,1,0]
  v_cvt_pk_bf16_f32 v78, v68, v69
  ds_write_b32 v5, v78 offset:8640
  v_cvt_pk_bf16_f32 v79, v72, -v73
  ds_write_b32 v5, v79 offset:4032
  v_pk_mul_f32 v[38:39], v[68:69], v[18:19] op_sel:[0,0] op_sel_hi:[1,0]
  v_pk_fma_f32 v[70:71], v[68:69], v[18:19], v[38:39] op_sel:[1,1,0] op_sel_hi:[0,1,1] neg_lo:[0,1,0]
  v_pk_mul_f32 v[76:77], v[72:73], v[20:21] op_sel:[0,0] op_sel_hi:[1,0]
  v_pk_fma_f32 v[74:75], v[72:73], v[20:21], v[76:77] op_sel:[1,1,0] op_sel_hi:[0,1,1] neg_lo:[0,1,0]
  v_cvt_pk_bf16_f32 v80, v70, v71
  ds_write_b32 v5, v80 offset:8928
  v_cvt_pk_bf16_f32 v81, v74, -v75
  ds_write_b32 v5, v81 offset:4320
  s_waitcnt lgkmcnt(0)
  ds_read_b128 v[80:83], v16 offset:0
  ds_read_b128 v[84:87], v16 offset:64
  ds_read_b128 v[88:91], v16 offset:128
  ds_read_b128 v[92:95], v16 offset:192
  ds_read_b128 v[96:99], v16 offset:4608
  ds_read_b128 v[100:103], v16 offset:4672
  ds_read_b128 v[104:107], v16 offset:4736
  ds_read_b128 v[108:111], v16 offset:4800
  s_waitcnt lgkmcnt(3)
  v_mfma_f32_16x16x32_bf16 v[112:115], v[96:99], v[80:83], 0
  s_waitcnt lgkmcnt(2)
  v_mfma_f32_16x16x32_bf16 v[112:115], v[100:103], v[84:87], v[112:115]
  s_waitcnt lgkmcnt(1)
  v_mfma_f32_16x16x32_bf16 v[112:115], v[104:107], v[88:91], v[112:115]
  s_waitcnt lgkmcnt(0)
  v_mfma_f32_16x16x32_bf16 v[112:115], v[108:111], v[92:95], v[112:115]
  v_pk_mul_f32 v[76:77], v[40:41], v[22:23] op_sel:[0,0] op_sel_hi:[1,0]
  v_pk_fma_f32 v[72:73], v[40:41], v[22:23], v[76:77] op_sel:[1,1,0] op_sel_hi:[0,1,1] neg_lo:[0,1,0]
  v_cvt_pk_bf16_f32 v78, v72, v73
  ds_write_b32 v5, v78 offset:4608
  v_pk_mul_f32 v[38:39], v[44:45], v[22:23] op_sel:[0,0] op_sel_hi:[1,0]
  v_pk_fma_f32 v[74:75], v[44:45], v[22:23], v[38:39] op_sel:[1,1,0] op_sel_hi:[0,1,1] neg_lo:[0,1,0]
  v_cvt_pk_bf16_f32 v79, v74, v75
  ds_write_b32 v5, v79 offset:4896
  v_pk_mul_f32 v[76:77], v[48:49], v[22:23] op_sel:[0,0] op_sel_hi:[1,0]
  v_pk_fma_f32 v[72:73], v[48:49], v[22:23], v[76:77] op_sel:[1,1,0] op_sel_hi:[0,1,1] neg_lo:[0,1,0]
  v_cvt_pk_bf16_f32 v78, v72, v73
  ds_write_b32 v5, v78 offset:5184
  v_pk_mul_f32 v[38:39], v[52:53], v[22:23] op_sel:[0,0] op_sel_hi:[1,0]
  v_pk_fma_f32 v[74:75], v[52:53], v[22:23], v[38:39] op_sel:[1,1,0] op_sel_hi:[0,1,1] neg_lo:[0,1,0]
  v_cvt_pk_bf16_f32 v79, v74, v75
  ds_write_b32 v5, v79 offset:5472
  v_pk_mul_f32 v[76:77], v[56:57], v[22:23] op_sel:[0,0] op_sel_hi:[1,0]
  v_pk_fma_f32 v[72:73], v[56:57], v[22:23], v[76:77] op_sel:[1,1,0] op_sel_hi:[0,1,1] neg_lo:[0,1,0]
  v_cvt_pk_bf16_f32 v78, v72, v73
  ds_write_b32 v5, v78 offset:5760
  v_pk_mul_f32 v[38:39], v[60:61], v[22:23] op_sel:[0,0] op_sel_hi:[1,0]
  v_pk_fma_f32 v[74:75], v[60:61], v[22:23], v[38:39] op_sel:[1,1,0] op_sel_hi:[0,1,1] neg_lo:[0,1,0]
  v_cvt_pk_bf16_f32 v79, v74, v75
  ds_write_b32 v5, v79 offset:6048
  v_pk_mul_f32 v[76:77], v[64:65], v[22:23] op_sel:[0,0] op_sel_hi:[1,0]
  v_pk_fma_f32 v[72:73], v[64:65], v[22:23], v[76:77] op_sel:[1,1,0] op_sel_hi:[0,1,1] neg_lo:[0,1,0]
  v_cvt_pk_bf16_f32 v78, v72, v73
  ds_write_b32 v5, v78 offset:6336
  v_pk_mul_f32 v[38:39], v[68:69], v[22:23] op_sel:[0,0] op_sel_hi:[1,0]
  v_pk_fma_f32 v[74:75], v[68:69], v[22:23], v[38:39] op_sel:[1,1,0] op_sel_hi:[0,1,1] neg_lo:[0,1,0]
  v_cvt_pk_bf16_f32 v79, v74, v75
  ds_write_b32 v5, v79 offset:6624
  v_pk_mul_f32 v[76:77], v[40:41], v[24:25] op_sel:[0,0] op_sel_hi:[1,0]
  v_pk_fma_f32 v[72:73], v[40:41], v[24:25], v[76:77] op_sel:[1,1,0] op_sel_hi:[0,1,1] neg_lo:[0,1,0]
  v_cvt_pk_bf16_f32 v78, v72, v73
  ds_write_b32 v5, v78 offset:6912
  v_pk_mul_f32 v[38:39], v[48:49], v[24:25] op_sel:[0,0] op_sel_hi:[1,0]
  v_pk_fma_f32 v[74:75], v[48:49], v[24:25], v[38:39] op_sel:[1,1,0] op_sel_hi:[0,1,1] neg_lo:[0,1,0]
  v_cvt_pk_bf16_f32 v79, v74, v75
  ds_write_b32 v5, v79 offset:7200
  v_pk_mul_f32 v[76:77], v[56:57], v[24:25] op_sel:[0,0] op_sel_hi:[1,0]
  v_pk_fma_f32 v[72:73], v[56:57], v[24:25], v[76:77] op_sel:[1,1,0] op_sel_hi:[0,1,1] neg_lo:[0,1,0]
  v_cvt_pk_bf16_f32 v78, v72, v73
  ds_write_b32 v5, v78 offset:7488
  v_pk_mul_f32 v[38:39], v[64:65], v[24:25] op_sel:[0,0] op_sel_hi:[1,0]
  v_pk_fma_f32 v[74:75], v[64:65], v[24:25], v[38:39] op_sel:[1,1,0] op_sel_hi:[0,1,1] neg_lo:[0,1,0]
  v_cvt_pk_bf16_f32 v79, v74, v75
  ds_write_b32 v5, v79 offset:7776
  v_pk_mul_f32 v[76:77], v[40:41], v[28:29] op_sel:[0,0] op_sel_hi:[1,0]
  v_pk_fma_f32 v[72:73], v[40:41], v[28:29], v[76:77] op_sel:[1,1,0] op_sel_hi:[0,1,1] neg_lo:[0,1,0]
  v_cvt_pk_bf16_f32 v78, v72, v73
  ds_write_b32 v5, v78 offset:8064
  v_pk_mul_f32 v[38:39], v[48:49], v[28:29] op_sel:[0,0] op_sel_hi:[1,0]
  v_pk_fma_f32 v[74:75], v[48:49], v[28:29], v[38:39] op_sel:[1,1,0] op_sel_hi:[0,1,1] neg_lo:[0,1,0]
  v_cvt_pk_bf16_f32 v79, v74, v75
  ds_write_b32 v5, v79 offset:8352
  v_pk_mul_f32 v[76:77], v[56:57], v[28:29] op_sel:[0,0] op_sel_hi:[1,0]
  v_pk_fma_f32 v[72:73], v[56:57], v[28:29], v[76:77] op_sel:[1,1,0] op_sel_hi:[0,1,1] neg_lo:[0,1,0]
  v_cvt_pk_bf16_f32 v78, v72, v73
  ds_write_b32 v5, v78 offset:8640
  v_pk_mul_f32 v[38:39], v[64:65], v[28:29] op_sel:[0,0] op_sel_hi:[1,0]
  v_pk_fma_f32 v[74:75], v[64:65], v[28:29], v[38:39] op_sel:[1,1,0] op_sel_hi:[0,1,1] neg_lo:[0,1,0]
  v_cvt_pk_bf16_f32 v79, v74, v75
  ds_write_b32 v5, v79 offset:8928
  s_waitcnt lgkmcnt(0)
  ds_read_b128 v[96:99], v16 offset:4608
  ds_read_b128 v[100:103], v16 offset:4672
  ds_read_b128 v[104:107], v16 offset:4736
  ds_read_b128 v[108:111], v16 offset:4800
  s_waitcnt lgkmcnt(3)
  v_mfma_f32_16x16x32_bf16 v[116:119], v[96:99], v[80:83], 0
  s_waitcnt lgkmcnt(2)
  v_mfma_f32_16x16x32_bf16 v[116:119], v[100:103], v[84:87], v[116:119]
  s_waitcnt lgkmcnt(1)
  v_mfma_f32_16x16x32_bf16 v[116:119], v[104:107], v[88:91], v[116:119]
  s_waitcnt lgkmcnt(0)
  v_mfma_f32_16x16x32_bf16 v[116:119], v[108:111], v[92:95], v[116:119]
  v_pk_mul_f32 v[76:77], v[40:41], v[26:27] op_sel:[0,0] op_sel_hi:[1,0]
  v_pk_fma_f32 v[72:73], v[40:41], v[26:27], v[76:77] op_sel:[1,1,0] op_sel_hi:[0,1,1] neg_lo:[0,1,0]
  v_cvt_pk_bf16_f32 v78, v72, v73
  ds_write_b32 v5, v78 offset:4608
  v_pk_mul_f32 v[38:39], v[56:57], v[26:27] op_sel:[0,0] op_sel_hi:[1,0]
  v_pk_fma_f32 v[74:75], v[56:57], v[26:27], v[38:39] op_sel:[1,1,0] op_sel_hi:[0,1,1] neg_lo:[0,1,0]
  v_cvt_pk_bf16_f32 v79, v74, v75
  ds_write_b32 v5, v79 offset:4896
  v_pk_mul_f32 v[76:77], v[40:41], v[30:31] op_sel:[0,0] op_sel_hi:[1,0]
  v_pk_fma_f32 v[72:73], v[40:41], v[30:31], v[76:77] op_sel:[1,1,0] op_sel_hi:[0,1,1] neg_lo:[0,1,0]
  v_cvt_pk_bf16_f32 v78, v72, v73
  ds_write_b32 v5, v78 offset:5184
  v_pk_mul_f32 v[38:39], v[56:57], v[30:31] op_sel:[0,0] op_sel_hi:[1,0]
  v_pk_fma_f32 v[74:75], v[56:57], v[30:31], v[38:39] op_sel:[1,1,0] op_sel_hi:[0,1,1] neg_lo:[0,1,0]
  v_cvt_pk_bf16_f32 v79, v74, v75
  ds_write_b32 v5, v79 offset:5472
  v_pk_mul_f32 v[76:77], v[40:41], v[32:33] op_sel:[0,0] op_sel_hi:[1,0]
  v_pk_fma_f32 v[72:73], v[40:41], v[32:33], v[76:77] op_sel:[1,1,0] op_sel_hi:[0,1,1] neg_lo:[0,1,0]
  v_cvt_pk_bf16_f32 v78, v72, v73
  ds_write_b32 v5, v78 offset:5760
  v_pk_mul_f32 v[38:39], v[56:57], v[32:33] op_sel:[0,0] op_sel_hi:[1,0]
  v_pk_fma_f32 v[74:75], v[56:57], v[32:33], v[38:39] op_sel:[1,1,0] op_sel_hi:[0,1,1] neg_lo:[0,1,0]
  v_cvt_pk_bf16_f32 v79, v74, v75
  ds_write_b32 v5, v79 offset:6048
  v_pk_mul_f32 v[76:77], v[40:41], v[34:35] op_sel:[0,0] op_sel_hi:[1,0]
  v_pk_fma_f32 v[72:73], v[40:41], v[34:35], v[76:77] op_sel:[1,1,0] op_sel_hi:[0,1,1] neg_lo:[0,1,0]
  v_cvt_pk_bf16_f32 v78, v72, v73
  ds_write_b32 v5, v78 offset:6336
  v_pk_mul_f32 v[38:39], v[56:57], v[34:35] op_sel:[0,0] op_sel_hi:[1,0]
  v_pk_fma_f32 v[74:75], v[56:57], v[34:35], v[38:39] op_sel:[1,1,0] op_sel_hi:[0,1,1] neg_lo:[0,1,0]
  v_cvt_pk_bf16_f32 v79, v74, v75
  ds_write_b32 v5, v79 offset:6624
  v_pk_mul_f32 v[76:77], v[40:41], v[36:37] op_sel:[0,0] op_sel_hi:[1,0]
  v_pk_fma_f32 v[72:73], v[40:41], v[36:37], v[76:77] op_sel:[1,1,0] op_sel_hi:[0,1,1] neg_lo:[0,1,0]
  v_cvt_pk_bf16_f32 v78, v72, v73
  ds_write_b32 v5, v78 offset:6912
  s_waitcnt lgkmcnt(0)
  ds_read_b128 v[96:99], v16 offset:4608
  ds_read_b128 v[100:103], v16 offset:4672
  ds_read_b128 v[104:107], v16 offset:4736
  ds_read_b128 v[108:111], v16 offset:4800
  s_waitcnt lgkmcnt(3)
  v_mfma_f32_16x16x32_bf16 v[120:123], v[96:99], v[80:83], 0
  s_waitcnt lgkmcnt(2)
  v_mfma_f32_16x16x32_bf16 v[120:123], v[100:103], v[84:87], v[120:123]
  s_waitcnt lgkmcnt(1)
  v_mfma_f32_16x16x32_bf16 v[120:123], v[104:107], v[88:91], v[120:123]
  s_waitcnt lgkmcnt(0)
  v_mfma_f32_16x16x32_bf16 v[120:123], v[108:111], v[92:95], v[120:123]
  s_nop 7
  v_lshlrev_b32 v17, 4, v1
  s_cmp_eq_u32 s21, 0
  s_cbranch_scc1 KG_LOW
  v_add_u32 v17, s25, v17
  ds_write_b128 v17, v[112:115] offset:0
  ds_write_b128 v17, v[116:119] offset:1024
  ds_write_b128 v17, v[120:123] offset:2048
  s_waitcnt lgkmcnt(0)
  s_barrier
  s_branch KG_JOIN
KG_LOW:
  s_add_u32 s27, s25, 9216
  v_add_u32 v17, s27, v17
  s_barrier
  ds_read_b128 v[96:99], v17 offset:0
  ds_read_b128 v[100:103], v17 offset:1024
  ds_read_b128 v[104:107], v17 offset:2048
  v_lshlrev_b32 v18, 5, v6
  v_add_u32 v18, s26, v18
  v_lshl_add_u32 v19, v7, 3, v18
  v_lshlrev_b32 v20, 4, v7
  v_add_u32 v20, 512, v20
  v_lshlrev_b32 v21, 9, v7
  v_cmp_gt_u32 vcc, 2, v7
  v_mov_b32 v22, 8
  v_mov_b32 v23, 4
  v_cndmask_b32 v20, v21, v20, vcc
  v_cndmask_b32 v22, v22, v23, vcc
  v_add_u32 v20, v20, v18
  v_add_u32 v21, v20, v22
  v_add_u32 v24, v21, v22
  v_add_u32 v25, v24, v22
  v_lshlrev_b32 v26, 10, v7
  v_add_u32 v26, 2048, v26
  v_add_u32 v26, v26, v18
  s_waitcnt lgkmcnt(0)
  v_add_f32 v112, v112, v96
  v_add_f32 v113, v113, v97
  v_add_f32 v114, v114, v98
  v_add_f32 v115, v115, v99
  v_add_f32 v116, v116, v100
  v_add_f32 v117, v117, v101
  v_add_f32 v118, v118, v102
  v_add_f32 v119, v119, v103
  v_add_f32 v120, v120, v104
  v_add_f32 v121, v121, v105
  v_add_f32 v122, v122, v106
  v_add_f32 v123, v123, v107
  v_cvt_pk_bf16_f32 v96, v112, v113
  v_cvt_pk_bf16_f32 v97, v114, v115
  v_cvt_pk_bf16_f32 v98, v116, v117
  v_cvt_pk_bf16_f32 v99, v118, v119
  v_cvt_pk_bf16_f32 v100, v120, v121
  v_cvt_pk_bf16_f32 v101, v122, v123
  ds_write_b16 v19, v96 offset:0
  ds_write_b16_d16_hi v19, v96 offset:2
  ds_write_b16 v19, v97 offset:4
  ds_write_b16_d16_hi v19, v97 offset:6
  ds_write_b16 v20, v98
  ds_write_b16_d16_hi v21, v98
  ds_write_b16 v24, v99
  ds_write_b16_d16_hi v25, v99
  s_mov_b32 exec_lo, -1
  s_mov_b32 exec_hi, 1
  ds_write_b16 v26, v100 offset:0
  s_mov_b32 exec_hi, 0
  ds_write_b16_d16_hi v26, v100 offset:16
  ds_write_b16 v26, v101 offset:512
  ds_write_b16_d16_hi v26, v101 offset:528
  s_mov_b64 exec, -1
KG_JOIN:
  s_waitcnt lgkmcnt(0)
  s_barrier
  s_mul_i32 s27, s22, 4112
  s_lshl_b32 s24, s21, 11
  v_lshl_add_u32 v40, v1, 4, s24
  v_add_u32 v41, s26, v40
  v_add_u32 v42, s27, v40
  ds_read_b128 v[44:47], v41
  ds_read_b128 v[48:51], v41 offset:1024
  ds_read_b128 v[52:55], v41 offset:2048
  s_waitcnt lgkmcnt(1)
  buffer_store_dwordx4 v[44:47], v42, s[28:31], 0 offen sc1
  buffer_store_dwordx4 v[48:51], v42, s[28:31], 0 offen offset:1024 sc1
  s_cmp_eq_u32 s21, 1
  s_cbranch_scc0 KG_END
  s_waitcnt lgkmcnt(0)
  s_mov_b64 exec, 1
  buffer_store_dwordx4 v[52:55], v42, s[28:31], 0 offen offset:2048 sc1
KG_END:
  s_mov_b64 exec, -1
  s_endpgm
K1_LN1:
  s_load_dwordx2 s[4:5], s[0:1], 0
  s_load_dwordx2 s[6:7], s[0:1], 136
  v_and_b32 v1, 63, v0
  v_lshrrev_b32 v2, 6, v0
  v_and_b32 v3, 7, v1
  v_readfirstlane_b32 s18, v2
  s_cmp_lt_u32 s18, 2
  s_cbranch_scc1 LN1_WORK
  s_cmp_lt_u32 s2, 16
  s_cbranch_scc0 LN1_IDLE
  s_waitcnt lgkmcnt(0)
  s_add_u32 s8, s6, 36864
  s_addc_u32 s9, s7, 0
  s_mov_b32 s10, 131072
  s_mov_b32 s11, 0x20000
  s_lshl_b32 s19, s2, 13
  v_lshl_add_u32 v10, v1, 7, s19
  v_mov_b32 v11, 0
  s_cmp_eq_u32 s18, 2
  s_cbranch_scc0 LN1_NOZ
  buffer_store_dword v11, v10, s[8:11], 0 offen sc1
LN1_NOZ:
  s_getpc_b64 s[96:97]
PFPC2:
  s_add_u32 s96, s96, L_conv_kernel-PFPC2
  s_addc_u32 s97, s97, 0
  v_lshlrev_b32 v8, 7, v1
  v_min_u32 v8, TEXT_END-L_conv_kernel-4, v8
  global_load_dword v9, v8, s[96:97]
  v_add_u32 v8, 8192, v8
  v_min_u32 v8, TEXT_END-L_conv_kernel-4, v8
  global_load_dword v9, v8, s[96:97]
  v_add_u32 v8, 8192, v8
  v_min_u32 v8, TEXT_END-L_conv_kernel-4, v8
  global_load_dword v9, v8, s[96:97]
  v_add_u32 v8, 8192, v8
  v_min_u32 v8, TEXT_END-L_conv_kernel-4, v8
  global_load_dword v9, v8, s[96:97]
  v_add_u32 v8, 8192, v8
  v_min_u32 v8, TEXT_END-L_conv_kernel-4, v8
  global_load_dword v9, v8, s[96:97]
  v_add_u32 v8, 8192, v8
  v_min_u32 v8, TEXT_END-L_conv_kernel-4, v8
  global_load_dword v9, v8, s[96:97]
  v_add_u32 v8, 8192, v8
  v_min_u32 v8, TEXT_END-L_conv_kernel-4, v8
  global_load_dword v9, v8, s[96:97]
  v_add_u32 v8, 8192, v8
  v_min_u32 v8, TEXT_END-L_conv_kernel-4, v8
  global_load_dword v9, v8, s[96:97]
  v_add_u32 v8, 8192, v8
  v_min_u32 v8, TEXT_END-L_conv_kernel-4, v8
  global_load_dword v9, v8, s[96:97]
  v_add_u32 v8, 8192, v8
  v_min_u32 v8, TEXT_END-L_conv_kernel-4, v8
  global_load_dword v9, v8, s[96:97]
  s_waitcnt vmcnt(0)
LN1_IDLE:
  s_endpgm
LN1_WORK:
  s_getpc_b64 s[96:97]
PFPC3:
  v_lshlrev_b32 v8, 7, v1
  v_min_u32 v8, K1_MOD-PFPC3-4, v8
  global_load_dword v120, v8, s[96:97]
  v_lshrrev_b32 v4, 3, v1
  s_lshl_b32 s3, s2, 4
  v_lshl_add_u32 v5, v2, 3, v3
  v_add_u32 v5, s3, v5
  v_mul_u32_u24 v6, 1152, v5
  v_lshl_add_u32 v6, v4, 4, v6
  v_lshlrev_b32 v7, 15, v4
  v_lshl_add_u32 v7, v5, 3, v7
  s_waitcnt lgkmcnt(0)
  s_mov_b32 s8, s4
  s_mov_b32 s9, s5
  s_mov_b32 s10, 2359296
  s_mov_b32 s11, 0x20000
  s_add_u32 s12, s6, 167936
  s_addc_u32 s13, s7, 0
  s_mov_b32 s14, 2359296
  s_mov_b32 s15, 0x20000
  buffer_load_dwordx4 v[8:11], v6, s[8:11], 0 offen offset:0
  buffer_load_dwordx4 v[12:15], v6, s[8:11], 0 offen offset:128
  buffer_load_dwordx4 v[16:19], v6, s[8:11], 0 offen offset:256
  buffer_load_dwordx4 v[20:23], v6, s[8:11], 0 offen offset:384
  buffer_load_dwordx4 v[24:27], v6, s[8:11], 0 offen offset:512
  buffer_load_dwordx4 v[28:31], v6, s[8:11], 0 offen offset:640
  buffer_load_dwordx4 v[32:35], v6, s[8:11], 0 offen offset:768
  buffer_load_dwordx4 v[36:39], v6, s[8:11], 0 offen offset:896
  buffer_load_dwordx4 v[40:43], v6, s[8:11], 0 offen offset:1024
  v_mov_b32 v116, 0
  v_mov_b32 v117, 0
  v_mov_b32 v118, 0
  v_mov_b32 v119, 0
  s_waitcnt vmcnt(8)
  v_lshlrev_b32 v44, 16, v8
  v_and_b32 v45, 0xffff0000, v8
  v_lshlrev_b32 v46, 16, v9
  v_and_b32 v47, 0xffff0000, v9
  v_lshlrev_b32 v48, 16, v10
  v_and_b32 v49, 0xffff0000, v10
  v_lshlrev_b32 v50, 16, v11
  v_and_b32 v51, 0xffff0000, v11
  v_pk_add_f32 v[116:117], v[116:117], v[44:45]
  v_pk_fma_f32 v[118:119], v[44:45], v[44:45], v[118:119]
  v_pk_add_f32 v[116:117], v[116:117], v[46:47]
  v_pk_fma_f32 v[118:119], v[46:47], v[46:47], v[118:119]
  v_pk_add_f32 v[116:117], v[116:117], v[48:49]
  v_pk_fma_f32 v[118:119], v[48:49], v[48:49], v[118:119]
  v_pk_add_f32 v[116:117], v[116:117], v[50:51]
  v_pk_fma_f32 v[118:119], v[50:51], v[50:51], v[118:119]
  s_waitcnt vmcnt(7)
  v_lshlrev_b32 v52, 16, v12
  v_and_b32 v53, 0xffff0000, v12
  v_lshlrev_b32 v54, 16, v13
  v_and_b32 v55, 0xffff0000, v13
  v_lshlrev_b32 v56, 16, v14
  v_and_b32 v57, 0xffff0000, v14
  v_lshlrev_b32 v58, 16, v15
  v_and_b32 v59, 0xffff0000, v15
  v_pk_add_f32 v[116:117], v[116:117], v[52:53]
  v_pk_fma_f32 v[118:119], v[52:53], v[52:53], v[118:119]
  v_pk_add_f32 v[116:117], v[116:117], v[54:55]
  v_pk_fma_f32 v[118:119], v[54:55], v[54:55], v[118:119]
  v_pk_add_f32 v[116:117], v[116:117], v[56:57]
  v_pk_fma_f32 v[118:119], v[56:57], v[56:57], v[118:119]
  v_pk_add_f32 v[116:117], v[116:117], v[58:59]
  v_pk_fma_f32 v[118:119], v[58:59], v[58:59], v[118:119]
  s_waitcnt vmcnt(6)
  v_lshlrev_b32 v60, 16, v16
  v_and_b32 v61, 0xffff0000, v16
  v_lshlrev_b32 v62, 16, v17
  v_and_b32 v63, 0xffff0000, v17
  v_lshlrev_b32 v64, 16, v18
  v_and_b32 v65, 0xffff0000, v18
  v_lshlrev_b32 v66, 16, v19
  v_and_b32 v67, 0xffff0000, v19
  v_pk_add_f32 v[116:117], v[116:117], v[60:61]
  v_pk_fma_f32 v[118:119], v[60:61], v[60:61], v[118:119]
  v_pk_add_f32 v[116:117], v[116:117], v[62:63]
  v_pk_fma_f32 v[118:119], v[62:63], v[62:63], v[118:119]
  v_pk_add_f32 v[116:117], v[116:117], v[64:65]
  v_pk_fma_f32 v[118:119], v[64:65], v[64:65], v[118:119]
  v_pk_add_f32 v[116:117], v[116:117], v[66:67]
  v_pk_fma_f32 v[118:119], v[66:67], v[66:67], v[118:119]
  s_waitcnt vmcnt(5)
  v_lshlrev_b32 v68, 16, v20
  v_and_b32 v69, 0xffff0000, v20
  v_lshlrev_b32 v70, 16, v21
  v_and_b32 v71, 0xffff0000, v21
  v_lshlrev_b32 v72, 16, v22
  v_and_b32 v73, 0xffff0000, v22
  v_lshlrev_b32 v74, 16, v23
  v_and_b32 v75, 0xffff0000, v23
  v_pk_add_f32 v[116:117], v[116:117], v[68:69]
  v_pk_fma_f32 v[118:119], v[68:69], v[68:69], v[118:119]
  v_pk_add_f32 v[116:117], v[116:117], v[70:71]
  v_pk_fma_f32 v[118:119], v[70:71], v[70:71], v[118:119]
  v_pk_add_f32 v[116:117], v[116:117], v[72:73]
  v_pk_fma_f32 v[118:119], v[72:73], v[72:73], v[118:119]
  v_pk_add_f32 v[116:117], v[116:117], v[74:75]
  v_pk_fma_f32 v[118:119], v[74:75], v[74:75], v[118:119]
  s_waitcnt vmcnt(4)
  v_lshlrev_b32 v76, 16, v24
  v_and_b32 v77, 0xffff0000, v24
  v_lshlrev_b32 v78, 16, v25
  v_and_b32 v79, 0xffff0000, v25
  v_lshlrev_b32 v80, 16, v26
  v_and_b32 v81, 0xffff0000, v26
  v_lshlrev_b32 v82, 16, v27
  v_and_b32 v83, 0xffff0000, v27
  v_pk_add_f32 v[116:117], v[116:117], v[76:77]
  v_pk_fma_f32 v[118:119], v[76:77], v[76:77], v[118:119]
  v_pk_add_f32 v[116:117], v[116:117], v[78:79]
  v_pk_fma_f32 v[118:119], v[78:79], v[78:79], v[118:119]
  v_pk_add_f32 v[116:117], v[116:117], v[80:81]
  v_pk_fma_f32 v[118:119], v[80:81], v[80:81], v[118:119]
  v_pk_add_f32 v[116:117], v[116:117], v[82:83]
  v_pk_fma_f32 v[118:119], v[82:83], v[82:83], v[118:119]
  s_waitcnt vmcnt(3)
  v_lshlrev_b32 v84, 16, v28
  v_and_b32 v85, 0xffff0000, v28
  v_lshlrev_b32 v86, 16, v29
  v_and_b32 v87, 0xffff0000, v29
  v_lshlrev_b32 v88, 16, v30
  v_and_b32 v89, 0xffff0000, v30
  v_lshlrev_b32 v90, 16, v31
  v_and_b32 v91, 0xffff0000, v31
  v_pk_add_f32 v[116:117], v[116:117], v[84:85]
  v_pk_fma_f32 v[118:119], v[84:85], v[84:85], v[118:119]
  v_pk_add_f32 v[116:117], v[116:117], v[86:87]
  v_pk_fma_f32 v[118:119], v[86:87], v[86:87], v[118:119]
  v_pk_add_f32 v[116:117], v[116:117], v[88:89]
  v_pk_fma_f32 v[118:119], v[88:89], v[88:89], v[118:119]
  v_pk_add_f32 v[116:117], v[116:117], v[90:91]
  v_pk_fma_f32 v[118:119], v[90:91], v[90:91], v[118:119]
  s_waitcnt vmcnt(2)
  v_lshlrev_b32 v92, 16, v32
  v_and_b32 v93, 0xffff0000, v32
  v_lshlrev_b32 v94, 16, v33
  v_and_b32 v95, 0xffff0000, v33
  v_lshlrev_b32 v96, 16, v34
  v_and_b32 v97, 0xffff0000, v34
  v_lshlrev_b32 v98, 16, v35
  v_and_b32 v99, 0xffff0000, v35
  v_pk_add_f32 v[116:117], v[116:117], v[92:93]
  v_pk_fma_f32 v[118:119], v[92:93], v[92:93], v[118:119]
  v_pk_add_f32 v[116:117], v[116:117], v[94:95]
  v_pk_fma_f32 v[118:119], v[94:95], v[94:95], v[118:119]
  v_pk_add_f32 v[116:117], v[116:117], v[96:97]
  v_pk_fma_f32 v[118:119], v[96:97], v[96:97], v[118:119]
  v_pk_add_f32 v[116:117], v[116:117], v[98:99]
  v_pk_fma_f32 v[118:119], v[98:99], v[98:99], v[118:119]
  s_waitcnt vmcnt(1)
  v_lshlrev_b32 v100, 16, v36
  v_and_b32 v101, 0xffff0000, v36
  v_lshlrev_b32 v102, 16, v37
  v_and_b32 v103, 0xffff0000, v37
  v_lshlrev_b32 v104, 16, v38
  v_and_b32 v105, 0xffff0000, v38
  v_lshlrev_b32 v106, 16, v39
  v_and_b32 v107, 0xffff0000, v39
  v_pk_add_f32 v[116:117], v[116:117], v[100:101]
  v_pk_fma_f32 v[118:119], v[100:101], v[100:101], v[118:119]
  v_pk_add_f32 v[116:117], v[116:117], v[102:103]
  v_pk_fma_f32 v[118:119], v[102:103], v[102:103], v[118:119]
  v_pk_add_f32 v[116:117], v[116:117], v[104:105]
  v_pk_fma_f32 v[118:119], v[104:105], v[104:105], v[118:119]
  v_pk_add_f32 v[116:117], v[116:117], v[106:107]
  v_pk_fma_f32 v[118:119], v[106:107], v[106:107], v[118:119]
  s_waitcnt vmcnt(0)
  v_lshlrev_b32 v108, 16, v40
  v_and_b32 v109, 0xffff0000, v40
  v_lshlrev_b32 v110, 16, v41
  v_and_b32 v111, 0xffff0000, v41
  v_lshlrev_b32 v112, 16, v42
  v_and_b32 v113, 0xffff0000, v42
  v_lshlrev_b32 v114, 16, v43
  v_and_b32 v115, 0xffff0000, v43
  v_pk_add_f32 v[116:117], v[116:117], v[108:109]
  v_pk_fma_f32 v[118:119], v[108:109], v[108:109], v[118:119]
  v_pk_add_f32 v[116:117], v[116:117], v[110:111]
  v_pk_fma_f32 v[118:119], v[110:111], v[110:111], v[118:119]
  v_pk_add_f32 v[116:117], v[116:117], v[112:113]
  v_pk_fma_f32 v[118:119], v[112:113], v[112:113], v[118:119]
  v_pk_add_f32 v[116:117], v[116:117], v[114:115]
  v_pk_fma_f32 v[118:119], v[114:115], v[114:115], v[118:119]
  v_add_f32 v116, v116, v117
  v_add_f32 v118, v118, v119
  s_nop 1
  v_add_f32_dpp v116, v116, v116 row_ror:8 row_mask:0xf bank_mask:0xf
  v_add_f32_dpp v118, v118, v118 row_ror:8 row_mask:0xf bank_mask:0xf
  v_mov_b32 v120, v116
  v_mov_b32 v121, v118
  s_nop 1
  v_permlane16_swap_b32 v116, v120
  v_permlane16_swap_b32 v118, v121
  s_nop 1
  v_add_f32 v116, v116, v120
  v_add_f32 v118, v118, v121
  v_mov_b32 v120, v116
  v_mov_b32 v121, v118
  s_nop 1
  v_permlane32_swap_b32 v116, v120
  v_permlane32_swap_b32 v118, v121
  s_nop 1
  v_add_f32 v116, v116, v120
  v_add_f32 v118, v118, v121
  v_mul_f32 v116, 0x3ae38e39, v116
  v_mul_f32 v118, 0x3ae38e39, v118
  v_fma_f32 v118, -v116, v116, v118
  v_max_f32 v118, 0, v118
  v_cvt_pk_bf16_f32 v120, v118, v118
  v_lshlrev_b32 v120, 16, v120
  v_add_f32 v120, 0x3727c5ac, v120
  v_cvt_pk_bf16_f32 v120, v120, v120
  v_lshlrev_b32 v120, 16, v120
  v_sqrt_f32 v120, v120
  v_cvt_pk_bf16_f32 v121, v116, v116
  v_lshlrev_b32 v121, 16, v121
  v_cvt_pk_bf16_f32 v120, v120, v120
  v_lshlrev_b32 v120, 16, v120
  v_rcp_f32 v122, v120
  s_nop 0
  v_mul_f32 v124, v121, v122
  v_sub_f32 v124, 0, v124
  v_pk_fma_f32 v[44:45], v[44:45], v[122:123], v[124:125] op_sel_hi:[1,0,0]
  v_pk_fma_f32 v[46:47], v[46:47], v[122:123], v[124:125] op_sel_hi:[1,0,0]
  v_pk_fma_f32 v[48:49], v[48:49], v[122:123], v[124:125] op_sel_hi:[1,0,0]
  v_pk_fma_f32 v[50:51], v[50:51], v[122:123], v[124:125] op_sel_hi:[1,0,0]
  v_cvt_pk_bf16_f32 v8, v44, v45
  v_cvt_pk_bf16_f32 v9, v46, v47
  v_cvt_pk_bf16_f32 v10, v48, v49
  v_cvt_pk_bf16_f32 v11, v50, v51
  s_mov_b32 s16, 0
  s_mov_b32 s17, 16384
  buffer_store_dwordx2 v[8:9], v7, s[12:15], s16 offen
  buffer_store_dwordx2 v[10:11], v7, s[12:15], s17 offen
  v_pk_fma_f32 v[52:53], v[52:53], v[122:123], v[124:125] op_sel_hi:[1,0,0]
  v_pk_fma_f32 v[54:55], v[54:55], v[122:123], v[124:125] op_sel_hi:[1,0,0]
  v_pk_fma_f32 v[56:57], v[56:57], v[122:123], v[124:125] op_sel_hi:[1,0,0]
  v_pk_fma_f32 v[58:59], v[58:59], v[122:123], v[124:125] op_sel_hi:[1,0,0]
  v_cvt_pk_bf16_f32 v12, v52, v53
  v_cvt_pk_bf16_f32 v13, v54, v55
  v_cvt_pk_bf16_f32 v14, v56, v57
  v_cvt_pk_bf16_f32 v15, v58, v59
  s_mov_b32 s16, 262144
  s_mov_b32 s17, 278528
  buffer_store_dwordx2 v[12:13], v7, s[12:15], s16 offen
  buffer_store_dwordx2 v[14:15], v7, s[12:15], s17 offen
  v_pk_fma_f32 v[60:61], v[60:61], v[122:123], v[124:125] op_sel_hi:[1,0,0]
  v_pk_fma_f32 v[62:63], v[62:63], v[122:123], v[124:125] op_sel_hi:[1,0,0]
  v_pk_fma_f32 v[64:65], v[64:65], v[122:123], v[124:125] op_sel_hi:[1,0,0]
  v_pk_fma_f32 v[66:67], v[66:67], v[122:123], v[124:125] op_sel_hi:[1,0,0]
  v_cvt_pk_bf16_f32 v16, v60, v61
  v_cvt_pk_bf16_f32 v17, v62, v63
  v_cvt_pk_bf16_f32 v18, v64, v65
  v_cvt_pk_bf16_f32 v19, v66, v67
  s_mov_b32 s16, 524288
  s_mov_b32 s17, 540672
  buffer_store_dwordx2 v[16:17], v7, s[12:15], s16 offen
  buffer_store_dwordx2 v[18:19], v7, s[12:15], s17 offen
  v_pk_fma_f32 v[68:69], v[68:69], v[122:123], v[124:125] op_sel_hi:[1,0,0]
  v_pk_fma_f32 v[70:71], v[70:71], v[122:123], v[124:125] op_sel_hi:[1,0,0]
  v_pk_fma_f32 v[72:73], v[72:73], v[122:123], v[124:125] op_sel_hi:[1,0,0]
  v_pk_fma_f32 v[74:75], v[74:75], v[122:123], v[124:125] op_sel_hi:[1,0,0]
  v_cvt_pk_bf16_f32 v20, v68, v69
  v_cvt_pk_bf16_f32 v21, v70, v71
  v_cvt_pk_bf16_f32 v22, v72, v73
  v_cvt_pk_bf16_f32 v23, v74, v75
  s_mov_b32 s16, 786432
  s_mov_b32 s17, 802816
  buffer_store_dwordx2 v[20:21], v7, s[12:15], s16 offen
  buffer_store_dwordx2 v[22:23], v7, s[12:15], s17 offen
  v_pk_fma_f32 v[76:77], v[76:77], v[122:123], v[124:125] op_sel_hi:[1,0,0]
  v_pk_fma_f32 v[78:79], v[78:79], v[122:123], v[124:125] op_sel_hi:[1,0,0]
  v_pk_fma_f32 v[80:81], v[80:81], v[122:123], v[124:125] op_sel_hi:[1,0,0]
  v_pk_fma_f32 v[82:83], v[82:83], v[122:123], v[124:125] op_sel_hi:[1,0,0]
  v_cvt_pk_bf16_f32 v24, v76, v77
  v_cvt_pk_bf16_f32 v25, v78, v79
  v_cvt_pk_bf16_f32 v26, v80, v81
  v_cvt_pk_bf16_f32 v27, v82, v83
  s_mov_b32 s16, 1048576
  s_mov_b32 s17, 1064960
  buffer_store_dwordx2 v[24:25], v7, s[12:15], s16 offen
  buffer_store_dwordx2 v[26:27], v7, s[12:15], s17 offen
  v_pk_fma_f32 v[84:85], v[84:85], v[122:123], v[124:125] op_sel_hi:[1,0,0]
  v_pk_fma_f32 v[86:87], v[86:87], v[122:123], v[124:125] op_sel_hi:[1,0,0]
  v_pk_fma_f32 v[88:89], v[88:89], v[122:123], v[124:125] op_sel_hi:[1,0,0]
  v_pk_fma_f32 v[90:91], v[90:91], v[122:123], v[124:125] op_sel_hi:[1,0,0]
  v_cvt_pk_bf16_f32 v28, v84, v85
  v_cvt_pk_bf16_f32 v29, v86, v87
  v_cvt_pk_bf16_f32 v30, v88, v89
  v_cvt_pk_bf16_f32 v31, v90, v91
  s_mov_b32 s16, 1310720
  s_mov_b32 s17, 1327104
  buffer_store_dwordx2 v[28:29], v7, s[12:15], s16 offen
  buffer_store_dwordx2 v[30:31], v7, s[12:15], s17 offen
  v_pk_fma_f32 v[92:93], v[92:93], v[122:123], v[124:125] op_sel_hi:[1,0,0]
  v_pk_fma_f32 v[94:95], v[94:95], v[122:123], v[124:125] op_sel_hi:[1,0,0]
  v_pk_fma_f32 v[96:97], v[96:97], v[122:123], v[124:125] op_sel_hi:[1,0,0]
  v_pk_fma_f32 v[98:99], v[98:99], v[122:123], v[124:125] op_sel_hi:[1,0,0]
  v_cvt_pk_bf16_f32 v32, v92, v93
  v_cvt_pk_bf16_f32 v33, v94, v95
  v_cvt_pk_bf16_f32 v34, v96, v97
  v_cvt_pk_bf16_f32 v35, v98, v99
  s_mov_b32 s16, 1572864
  s_mov_b32 s17, 1589248
  buffer_store_dwordx2 v[32:33], v7, s[12:15], s16 offen
  buffer_store_dwordx2 v[34:35], v7, s[12:15], s17 offen
  v_pk_fma_f32 v[100:101], v[100:101], v[122:123], v[124:125] op_sel_hi:[1,0,0]
  v_pk_fma_f32 v[102:103], v[102:103], v[122:123], v[124:125] op_sel_hi:[1,0,0]
  v_pk_fma_f32 v[104:105], v[104:105], v[122:123], v[124:125] op_sel_hi:[1,0,0]
  v_pk_fma_f32 v[106:107], v[106:107], v[122:123], v[124:125] op_sel_hi:[1,0,0]
  v_cvt_pk_bf16_f32 v36, v100, v101
  v_cvt_pk_bf16_f32 v37, v102, v103
  v_cvt_pk_bf16_f32 v38, v104, v105
  v_cvt_pk_bf16_f32 v39, v106, v107
  s_mov_b32 s16, 1835008
  s_mov_b32 s17, 1851392
  buffer_store_dwordx2 v[36:37], v7, s[12:15], s16 offen
  buffer_store_dwordx2 v[38:39], v7, s[12:15], s17 offen
  v_pk_fma_f32 v[108:109], v[108:109], v[122:123], v[124:125] op_sel_hi:[1,0,0]
  v_pk_fma_f32 v[110:111], v[110:111], v[122:123], v[124:125] op_sel_hi:[1,0,0]
  v_pk_fma_f32 v[112:113], v[112:113], v[122:123], v[124:125] op_sel_hi:[1,0,0]
  v_pk_fma_f32 v[114:115], v[114:115], v[122:123], v[124:125] op_sel_hi:[1,0,0]
  v_cvt_pk_bf16_f32 v40, v108, v109
  v_cvt_pk_bf16_f32 v41, v110, v111
  v_cvt_pk_bf16_f32 v42, v112, v113
  v_cvt_pk_bf16_f32 v43, v114, v115
  s_mov_b32 s16, 2097152
  s_mov_b32 s17, 2113536
  buffer_store_dwordx2 v[40:41], v7, s[12:15], s16 offen
  buffer_store_dwordx2 v[42:43], v7, s[12:15], s17 offen
  s_endpgm
K1_MOD:
  s_load_dwordx2 s[4:5], s[0:1], 112
  s_load_dwordx2 s[6:7], s[0:1], 136
  s_load_dwordx2 s[20:21], s[0:1], 104
  v_and_b32 v1, 63, v0
  s_getpc_b64 s[96:97]
PFPC4:
  v_lshlrev_b32 v8, 7, v1
  v_min_u32 v8, K1_END-PFPC4-4, v8
  global_load_dword v120, v8, s[96:97]
  s_cmp_ge_u32 s2, 54
  s_cselect_b32 s26, 1, 0
  s_mul_i32 s27, s26, 54
  s_sub_u32 s2, s2, s27
  v_lshrrev_b32 v2, 6, v0
  v_and_b32 v3, 7, v1
  v_lshrrev_b32 v4, 3, v1
  v_mul_u32_u24 v5, 72, v2
  v_add_u32 v5, v5, v4
  s_mul_i32 s27, s26, 288
  v_add_u32 v5, s27, v5
  v_mul_u32_u24 v6, 6912, v5
  v_lshl_add_u32 v6, v3, 4, v6
  s_lshl_b32 s3, s2, 7
  v_add_u32 v6, s3, v6
  v_lshlrev_b32 v7, 1, v5
  s_waitcnt lgkmcnt(0)
  s_mov_b32 s8, s4
  s_mov_b32 s9, s5
  s_mov_b32 s10, 3981312
  s_mov_b32 s11, 0x20000
  s_mov_b32 s16, s20
  s_mov_b32 s17, s21
  s_mov_b32 s18, 1152
  s_mov_b32 s19, 0x20000
  s_mov_b32 s22, 0
  buffer_load_dwordx4 v[28:31], v6, s[8:11], s22 offen nt
  s_mov_b32 s22, 55296
  buffer_load_dwordx4 v[32:35], v6, s[8:11], s22 offen nt
  s_mov_b32 s22, 110592
  buffer_load_dwordx4 v[36:39], v6, s[8:11], s22 offen nt
  s_mov_b32 s22, 165888
  buffer_load_dwordx4 v[40:43], v6, s[8:11], s22 offen nt
  s_mov_b32 s22, 221184
  buffer_load_dwordx4 v[44:47], v6, s[8:11], s22 offen nt
  s_mov_b32 s22, 276480
  buffer_load_dwordx4 v[48:51], v6, s[8:11], s22 offen nt
  s_mov_b32 s22, 331776
  buffer_load_dwordx4 v[52:55], v6, s[8:11], s22 offen nt
  s_mov_b32 s22, 387072
  buffer_load_dwordx4 v[56:59], v6, s[8:11], s22 offen nt
  s_mov_b32 s22, 442368
  buffer_load_dwordx4 v[60:63], v6, s[8:11], s22 offen nt
  buffer_load_ushort v8, v7, s[16:19], 0 offen offset:0
  buffer_load_ushort v9, v7, s[16:19], 0 offen offset:16
  buffer_load_ushort v10, v7, s[16:19], 0 offen offset:32
  buffer_load_ushort v11, v7, s[16:19], 0 offen offset:48
  buffer_load_ushort v12, v7, s[16:19], 0 offen offset:64
  buffer_load_ushort v13, v7, s[16:19], 0 offen offset:80
  buffer_load_ushort v14, v7, s[16:19], 0 offen offset:96
  buffer_load_ushort v15, v7, s[16:19], 0 offen offset:112
  buffer_load_ushort v16, v7, s[16:19], 0 offen offset:128
  s_add_u32 s12, s6, 8192
  s_addc_u32 s13, s7, 0
  s_mov_b32 s14, 27648
  s_mov_b32 s15, 0x20000
  s_waitcnt vmcnt(0)
  v_lshlrev_b32 v8, 16, v8
  v_lshlrev_b32 v9, 16, v9
  v_lshlrev_b32 v10, 16, v10
  v_lshlrev_b32 v11, 16, v11
  v_lshlrev_b32 v12, 16, v12
  v_lshlrev_b32 v13, 16, v13
  v_lshlrev_b32 v14, 16, v14
  v_lshlrev_b32 v15, 16, v15
  v_lshlrev_b32 v16, 16, v16
  v_mul_f32 v100, 0xbfb8aa3b, v8
  v_mul_f32 v101, 0xbfb8aa3b, v9
  v_mul_f32 v102, 0xbfb8aa3b, v10
  v_mul_f32 v103, 0xbfb8aa3b, v11
  v_mul_f32 v104, 0xbfb8aa3b, v12
  v_mul_f32 v105, 0xbfb8aa3b, v13
  v_mul_f32 v106, 0xbfb8aa3b, v14
  v_mul_f32 v107, 0xbfb8aa3b, v15
  v_mul_f32 v108, 0xbfb8aa3b, v16
  v_exp_f32 v100, v100
  v_exp_f32 v101, v101
  v_exp_f32 v102, v102
  v_exp_f32 v103, v103
  v_exp_f32 v104, v104
  v_exp_f32 v105, v105
  v_exp_f32 v106, v106
  v_exp_f32 v107, v107
  v_exp_f32 v108, v108
  v_add_f32 v100, 1.0, v100
  v_add_f32 v101, 1.0, v101
  v_add_f32 v102, 1.0, v102
  v_add_f32 v103, 1.0, v103
  v_add_f32 v104, 1.0, v104
  v_add_f32 v105, 1.0, v105
  v_add_f32 v106, 1.0, v106
  v_add_f32 v107, 1.0, v107
  v_add_f32 v108, 1.0, v108
  v_rcp_f32 v100, v100
  v_rcp_f32 v101, v101
  v_rcp_f32 v102, v102
  v_rcp_f32 v103, v103
  v_rcp_f32 v104, v104
  v_rcp_f32 v105, v105
  v_rcp_f32 v106, v106
  v_rcp_f32 v107, v107
  v_rcp_f32 v108, v108
  v_mul_f32 v8, v8, v100
  v_mul_f32 v9, v9, v101
  v_mul_f32 v10, v10, v102
  v_mul_f32 v11, v11, v103
  v_mul_f32 v12, v12, v104
  v_mul_f32 v13, v13, v105
  v_mul_f32 v14, v14, v106
  v_mul_f32 v15, v15, v107
  v_mul_f32 v16, v16, v108
  v_cvt_pk_bf16_f32 v8, v8, v8
  v_cvt_pk_bf16_f32 v9, v9, v9
  v_cvt_pk_bf16_f32 v10, v10, v10
  v_cvt_pk_bf16_f32 v11, v11, v11
  v_cvt_pk_bf16_f32 v12, v12, v12
  v_cvt_pk_bf16_f32 v13, v13, v13
  v_cvt_pk_bf16_f32 v14, v14, v14
  v_cvt_pk_bf16_f32 v15, v15, v15
  v_cvt_pk_bf16_f32 v16, v16, v16
  v_lshlrev_b32 v100, 16, v8
  v_lshlrev_b32 v101, 16, v9
  v_lshlrev_b32 v102, 16, v10
  v_lshlrev_b32 v103, 16, v11
  v_lshlrev_b32 v104, 16, v12
  v_lshlrev_b32 v105, 16, v13
  v_lshlrev_b32 v106, 16, v14
  v_lshlrev_b32 v107, 16, v15
  v_lshlrev_b32 v108, 16, v16
  v_mov_b32 v112, 0
  v_mov_b32 v113, 0
  v_mov_b32 v114, 0
  v_mov_b32 v115, 0
  v_mov_b32 v116, 0
  v_mov_b32 v117, 0
  v_mov_b32 v118, 0
  v_mov_b32 v119, 0
  v_lshlrev_b32 v64, 16, v28
  v_and_b32 v65, 0xffff0000, v28
  v_lshlrev_b32 v66, 16, v29
  v_and_b32 v67, 0xffff0000, v29
  v_lshlrev_b32 v68, 16, v30
  v_and_b32 v69, 0xffff0000, v30
  v_lshlrev_b32 v70, 16, v31
  v_and_b32 v71, 0xffff0000, v31
  v_pk_fma_f32 v[112:113], v[64:65], v[100:101], v[112:113] op_sel:[0,0,0] op_sel_hi:[1,0,1]
  v_pk_fma_f32 v[114:115], v[66:67], v[100:101], v[114:115] op_sel:[0,0,0] op_sel_hi:[1,0,1]
  v_pk_fma_f32 v[116:117], v[68:69], v[100:101], v[116:117] op_sel:[0,0,0] op_sel_hi:[1,0,1]
  v_pk_fma_f32 v[118:119], v[70:71], v[100:101], v[118:119] op_sel:[0,0,0] op_sel_hi:[1,0,1]
  v_lshlrev_b32 v72, 16, v32
  v_and_b32 v73, 0xffff0000, v32
  v_lshlrev_b32 v74, 16, v33
  v_and_b32 v75, 0xffff0000, v33
  v_lshlrev_b32 v76, 16, v34
  v_and_b32 v77, 0xffff0000, v34
  v_lshlrev_b32 v78, 16, v35
  v_and_b32 v79, 0xffff0000, v35
  v_pk_fma_f32 v[112:113], v[72:73], v[100:101], v[112:113] op_sel:[0,1,0] op_sel_hi:[1,1,1]
  v_pk_fma_f32 v[114:115], v[74:75], v[100:101], v[114:115] op_sel:[0,1,0] op_sel_hi:[1,1,1]
  v_pk_fma_f32 v[116:117], v[76:77], v[100:101], v[116:117] op_sel:[0,1,0] op_sel_hi:[1,1,1]
  v_pk_fma_f32 v[118:119], v[78:79], v[100:101], v[118:119] op_sel:[0,1,0] op_sel_hi:[1,1,1]
  v_lshlrev_b32 v64, 16, v36
  v_and_b32 v65, 0xffff0000, v36
  v_lshlrev_b32 v66, 16, v37
  v_and_b32 v67, 0xffff0000, v37
  v_lshlrev_b32 v68, 16, v38
  v_and_b32 v69, 0xffff0000, v38
  v_lshlrev_b32 v70, 16, v39
  v_and_b32 v71, 0xffff0000, v39
  v_pk_fma_f32 v[112:113], v[64:65], v[102:103], v[112:113] op_sel:[0,0,0] op_sel_hi:[1,0,1]
  v_pk_fma_f32 v[114:115], v[66:67], v[102:103], v[114:115] op_sel:[0,0,0] op_sel_hi:[1,0,1]
  v_pk_fma_f32 v[116:117], v[68:69], v[102:103], v[116:117] op_sel:[0,0,0] op_sel_hi:[1,0,1]
  v_pk_fma_f32 v[118:119], v[70:71], v[102:103], v[118:119] op_sel:[0,0,0] op_sel_hi:[1,0,1]
  v_lshlrev_b32 v72, 16, v40
  v_and_b32 v73, 0xffff0000, v40
  v_lshlrev_b32 v74, 16, v41
  v_and_b32 v75, 0xffff0000, v41
  v_lshlrev_b32 v76, 16, v42
  v_and_b32 v77, 0xffff0000, v42
  v_lshlrev_b32 v78, 16, v43
  v_and_b32 v79, 0xffff0000, v43
  v_pk_fma_f32 v[112:113], v[72:73], v[102:103], v[112:113] op_sel:[0,1,0] op_sel_hi:[1,1,1]
  v_pk_fma_f32 v[114:115], v[74:75], v[102:103], v[114:115] op_sel:[0,1,0] op_sel_hi:[1,1,1]
  v_pk_fma_f32 v[116:117], v[76:77], v[102:103], v[116:117] op_sel:[0,1,0] op_sel_hi:[1,1,1]
  v_pk_fma_f32 v[118:119], v[78:79], v[102:103], v[118:119] op_sel:[0,1,0] op_sel_hi:[1,1,1]
  v_lshlrev_b32 v64, 16, v44
  v_and_b32 v65, 0xffff0000, v44
  v_lshlrev_b32 v66, 16, v45
  v_and_b32 v67, 0xffff0000, v45
  v_lshlrev_b32 v68, 16, v46
  v_and_b32 v69, 0xffff0000, v46
  v_lshlrev_b32 v70, 16, v47
  v_and_b32 v71, 0xffff0000, v47
  v_pk_fma_f32 v[112:113], v[64:65], v[104:105], v[112:113] op_sel:[0,0,0] op_sel_hi:[1,0,1]
  v_pk_fma_f32 v[114:115], v[66:67], v[104:105], v[114:115] op_sel:[0,0,0] op_sel_hi:[1,0,1]
  v_pk_fma_f32 v[116:117], v[68:69], v[104:105], v[116:117] op_sel:[0,0,0] op_sel_hi:[1,0,1]
  v_pk_fma_f32 v[118:119], v[70:71], v[104:105], v[118:119] op_sel:[0,0,0] op_sel_hi:[1,0,1]
  v_lshlrev_b32 v72, 16, v48
  v_and_b32 v73, 0xffff0000, v48
  v_lshlrev_b32 v74, 16, v49
  v_and_b32 v75, 0xffff0000, v49
  v_lshlrev_b32 v76, 16, v50
  v_and_b32 v77, 0xffff0000, v50
  v_lshlrev_b32 v78, 16, v51
  v_and_b32 v79, 0xffff0000, v51
  v_pk_fma_f32 v[112:113], v[72:73], v[104:105], v[112:113] op_sel:[0,1,0] op_sel_hi:[1,1,1]
  v_pk_fma_f32 v[114:115], v[74:75], v[104:105], v[114:115] op_sel:[0,1,0] op_sel_hi:[1,1,1]
  v_pk_fma_f32 v[116:117], v[76:77], v[104:105], v[116:117] op_sel:[0,1,0] op_sel_hi:[1,1,1]
  v_pk_fma_f32 v[118:119], v[78:79], v[104:105], v[118:119] op_sel:[0,1,0] op_sel_hi:[1,1,1]
  v_lshlrev_b32 v64, 16, v52
  v_and_b32 v65, 0xffff0000, v52
  v_lshlrev_b32 v66, 16, v53
  v_and_b32 v67, 0xffff0000, v53
  v_lshlrev_b32 v68, 16, v54
  v_and_b32 v69, 0xffff0000, v54
  v_lshlrev_b32 v70, 16, v55
  v_and_b32 v71, 0xffff0000, v55
  v_pk_fma_f32 v[112:113], v[64:65], v[106:107], v[112:113] op_sel:[0,0,0] op_sel_hi:[1,0,1]
  v_pk_fma_f32 v[114:115], v[66:67], v[106:107], v[114:115] op_sel:[0,0,0] op_sel_hi:[1,0,1]
  v_pk_fma_f32 v[116:117], v[68:69], v[106:107], v[116:117] op_sel:[0,0,0] op_sel_hi:[1,0,1]
  v_pk_fma_f32 v[118:119], v[70:71], v[106:107], v[118:119] op_sel:[0,0,0] op_sel_hi:[1,0,1]
  v_lshlrev_b32 v72, 16, v56
  v_and_b32 v73, 0xffff0000, v56
  v_lshlrev_b32 v74, 16, v57
  v_and_b32 v75, 0xffff0000, v57
  v_lshlrev_b32 v76, 16, v58
  v_and_b32 v77, 0xffff0000, v58
  v_lshlrev_b32 v78, 16, v59
  v_and_b32 v79, 0xffff0000, v59
  v_pk_fma_f32 v[112:113], v[72:73], v[106:107], v[112:113] op_sel:[0,1,0] op_sel_hi:[1,1,1]
  v_pk_fma_f32 v[114:115], v[74:75], v[106:107], v[114:115] op_sel:[0,1,0] op_sel_hi:[1,1,1]
  v_pk_fma_f32 v[116:117], v[76:77], v[106:107], v[116:117] op_sel:[0,1,0] op_sel_hi:[1,1,1]
  v_pk_fma_f32 v[118:119], v[78:79], v[106:107], v[118:119] op_sel:[0,1,0] op_sel_hi:[1,1,1]
  v_lshlrev_b32 v64, 16, v60
  v_and_b32 v65, 0xffff0000, v60
  v_lshlrev_b32 v66, 16, v61
  v_and_b32 v67, 0xffff0000, v61
  v_lshlrev_b32 v68, 16, v62
  v_and_b32 v69, 0xffff0000, v62
  v_lshlrev_b32 v70, 16, v63
  v_and_b32 v71, 0xffff0000, v63
  v_pk_fma_f32 v[112:113], v[64:65], v[108:109], v[112:113] op_sel:[0,0,0] op_sel_hi:[1,0,1]
  v_pk_fma_f32 v[114:115], v[66:67], v[108:109], v[114:115] op_sel:[0,0,0] op_sel_hi:[1,0,1]
  v_pk_fma_f32 v[116:117], v[68:69], v[108:109], v[116:117] op_sel:[0,0,0] op_sel_hi:[1,0,1]
  v_pk_fma_f32 v[118:119], v[70:71], v[108:109], v[118:119] op_sel:[0,0,0] op_sel_hi:[1,0,1]
  s_nop 1
  v_add_f32_dpp v112, v112, v112 row_ror:8 row_mask:0xf bank_mask:0xf
  v_add_f32_dpp v113, v113, v113 row_ror:8 row_mask:0xf bank_mask:0xf
  v_add_f32_dpp v114, v114, v114 row_ror:8 row_mask:0xf bank_mask:0xf
  v_add_f32_dpp v115, v115, v115 row_ror:8 row_mask:0xf bank_mask:0xf
  v_add_f32_dpp v116, v116, v116 row_ror:8 row_mask:0xf bank_mask:0xf
  v_add_f32_dpp v117, v117, v117 row_ror:8 row_mask:0xf bank_mask:0xf
  v_add_f32_dpp v118, v118, v118 row_ror:8 row_mask:0xf bank_mask:0xf
  v_add_f32_dpp v119, v119, v119 row_ror:8 row_mask:0xf bank_mask:0xf
  v_mov_b32 v64, v112
  v_mov_b32 v65, v113
  v_mov_b32 v66, v114
  v_mov_b32 v67, v115
  v_mov_b32 v68, v116
  v_mov_b32 v69, v117
  v_mov_b32 v70, v118
  v_mov_b32 v71, v119
  s_nop 1
  v_permlane16_swap_b32 v112, v64
  v_permlane16_swap_b32 v113, v65
  v_permlane16_swap_b32 v114, v66
  v_permlane16_swap_b32 v115, v67
  v_permlane16_swap_b32 v116, v68
  v_permlane16_swap_b32 v117, v69
  v_permlane16_swap_b32 v118, v70
  v_permlane16_swap_b32 v119, v71
  s_nop 1
  v_add_f32 v112, v112, v64
  v_add_f32 v113, v113, v65
  v_add_f32 v114, v114, v66
  v_add_f32 v115, v115, v67
  v_add_f32 v116, v116, v68
  v_add_f32 v117, v117, v69
  v_add_f32 v118, v118, v70
  v_add_f32 v119, v119, v71
  v_mov_b32 v64, v112
  v_mov_b32 v65, v113
  v_mov_b32 v66, v114
  v_mov_b32 v67, v115
  v_mov_b32 v68, v116
  v_mov_b32 v69, v117
  v_mov_b32 v70, v118
  v_mov_b32 v71, v119
  s_nop 1
  v_permlane32_swap_b32 v112, v64
  v_permlane32_swap_b32 v113, v65
  v_permlane32_swap_b32 v114, v66
  v_permlane32_swap_b32 v115, v67
  v_permlane32_swap_b32 v116, v68
  v_permlane32_swap_b32 v117, v69
  v_permlane32_swap_b32 v118, v70
  v_permlane32_swap_b32 v119, v71
  s_nop 1
  v_add_f32 v112, v112, v64
  v_add_f32 v113, v113, v65
  v_add_f32 v114, v114, v66
  v_add_f32 v115, v115, v67
  v_add_f32 v116, v116, v68
  v_add_f32 v117, v117, v69
  v_add_f32 v118, v118, v70
  v_add_f32 v119, v119, v71
  v_lshlrev_b32 v8, 8, v2
  v_lshl_add_u32 v8, v3, 5, v8
  s_mov_b64 exec, 0xff
  ds_write_b128 v8, v[112:115]
  ds_write_b128 v8, v[116:119] offset:16
  s_mov_b64 exec, -1
  s_waitcnt lgkmcnt(0)
  s_barrier
  v_lshlrev_b32 v8, 2, v1
  ds_read_b32 v10, v8
  ds_read_b32 v11, v8 offset:256
  ds_read_b32 v12, v8 offset:512
  ds_read_b32 v13, v8 offset:768
  s_lshl_b32 s3, s2, 8
  s_mul_i32 s27, s26, 13824
  s_add_u32 s3, s3, s27
  v_add_u32 v9, s3, v8
  s_waitcnt lgkmcnt(0)
  v_add_f32 v10, v10, v11
  v_add_f32 v12, v12, v13
  v_add_f32 v10, v10, v12
  v_cmp_gt_u32 vcc, 64, v0
  s_and_saveexec_b64 s[24:25], vcc
  s_cbranch_execz MOD_DONE
  buffer_store_dword v10, v9, s[12:15], 0 offen sc1
MOD_DONE:
  s_mov_b64 exec, -1
  s_endpgm
K1_END:

.globl conv_kernel
.p2align 8
.type conv_kernel,@function
conv_kernel:
L_conv_kernel:
  s_cmp_lt_u32 s2, 144
  s_cbranch_scc1 K2_CONV
  s_sub_u32 s2, s2, 144
  s_cmp_lt_u32 s2, 90
  s_cbranch_scc1 K2_W1
  s_cmp_eq_u32 s2, 90
  s_cbranch_scc1 K2_MF
  s_sub_u32 s2, s2, 91
  s_cmp_lt_u32 s2, 18
  s_cbranch_scc1 K2_WD
  s_endpgm
K2_CONV:
  s_load_dwordx2 s[4:5], s[0:1], 136
  s_load_dwordx2 s[6:7], s[0:1], 64
  s_load_dwordx2 s[88:89], s[0:1], 88
  v_and_b32 v1, 63, v0
  s_getpc_b64 s[96:97]
PFPC5:
  v_lshlrev_b32 v21, 7, v1
  v_min_u32 v21, K2_W1-PFPC5-4, v21
  global_load_dword v219, v21, s[96:97]
  v_lshrrev_b32 v2, 6, v0
  v_lshlrev_b32 v3, 4, v1
  v_readfirstlane_b32 s3, v2
  v_lshlrev_b32 v4, 4, v0
  s_lshl_b32 s16, s2, 3
  s_lshl_b32 s17, s2, 4
  s_lshl_b32 s28, s2, 14
  s_lshl_b32 s26, s2, 2
  s_add_u32 s26, s26, s3
  s_mul_i32 s26, s26, 4112
  s_mul_i32 s31, s3, 4112
  s_add_u32 s31, s31, 98816
  s_mul_i32 s27, s3, 24704
  s_waitcnt lgkmcnt(0)
  s_add_u32 s12, s4, 2527232
  s_addc_u32 s13, s5, 0
  s_mov_b32 s14, 2368512
  s_mov_b32 s15, 0x20000
  s_add_u32 m0, s31, 0
  s_add_u32 s30, s26, 0
  buffer_load_dwordx4 v3, s[12:15], s30 offen lds
  s_add_u32 m0, s31, 1024
  s_add_u32 s30, s26, 1024
  buffer_load_dwordx4 v3, s[12:15], s30 offen lds
  s_add_u32 m0, s31, 2048
  s_add_u32 s30, s26, 2048
  buffer_load_dwordx4 v3, s[12:15], s30 offen lds
  s_add_u32 m0, s31, 3072
  s_add_u32 s30, s26, 3072
  buffer_load_dwordx4 v3, s[12:15], s30 offen lds
  s_mov_b64 exec, 1
  s_add_u32 m0, s31, 4096
  s_add_u32 s30, s26, 4096
  buffer_load_dwordx4 v3, s[12:15], s30 offen lds
  s_mov_b64 exec, -1
  s_add_u32 s8, s4, 167936
  s_addc_u32 s9, s5, 0
  s_mov_b32 s10, 2359296
  s_mov_b32 s11, 0x20000
  s_add_u32 s29, s28, 0
  buffer_load_dwordx4 v[48:51], v4, s[8:11], s29 offen
  s_add_u32 s29, s28, 4096
  buffer_load_dwordx4 v[52:55], v4, s[8:11], s29 offen
  s_add_u32 s29, s28, 8192
  buffer_load_dwordx4 v[56:59], v4, s[8:11], s29 offen
  s_add_u32 s29, s28, 12288
  buffer_load_dwordx4 v[60:63], v4, s[8:11], s29 offen
  s_add_u32 s40, s4, 8192
  s_addc_u32 s41, s5, 0
  s_mov_b32 s42, 27648
  s_mov_b32 s43, 0x20000
  s_mov_b32 s36, s6
  s_mov_b32 s37, s7
  s_mov_b32 s38, 1152
  s_mov_b32 s39, 0x20000
  v_mov_b32 v19, s17
  s_mov_b32 s29, 13824
  buffer_load_dwordx4 v[76:79], v19, s[40:43], 0 offen
  buffer_load_dwordx4 v[80:83], v19, s[40:43], s29 offen
  buffer_load_dwordx4 v[84:87], v19, s[40:43], 0 offen offset:2304
  buffer_load_dwordx4 v[88:91], v19, s[40:43], s29 offen offset:2304
  s_lshl_b32 s29, s3, 1
  s_add_u32 s29, s29, s16
  v_mov_b32 v20, s29
  buffer_load_ushort v2, v20, s[36:39], 0 offen
  v_mov_b32 v8, 0
  v_mov_b32 v9, 0
  v_mov_b32 v10, 0
  v_mov_b32 v11, 0
  v_add_u32 v5, s27, v3
  ds_write_b128 v5, v[8:11] offset:17152
  ds_write_b128 v5, v[8:11] offset:18176
  s_mov_b64 exec, 0x3fffff
  ds_write_b128 v5, v[8:11] offset:19200
  s_mov_b64 exec, -1
  v_lshrrev_b32 v6, 5, v0
  v_mul_u32_u24 v6, 160, v6
  v_and_b32 v7, 31, v0
  v_lshl_add_u32 v6, v7, 2, v6
  v_add_u32 v6, 19552, v6
  v_add_u32 v7, 49408, v6
  v_and_b32 v8, 15, v1
  v_lshrrev_b32 v9, 4, v1
  v_lshrrev_b32 v10, 2, v8
  v_mul_u32_u24 v10, 4288, v10
  v_and_b32 v11, 3, v1
  v_lshl_add_u32 v10, v11, 3, v10
  v_lshlrev_b32 v11, 4, v9
  v_sub_u32 v10, v10, v11
  v_add_u32 v10, 56, v10
  v_add_u32 v10, s27, v10
  v_mul_u32_u24 v11, 160, v8
  v_lshl_add_u32 v11, v9, 4, v11
  v_add_u32 v11, 17152, v11
  v_add_u32 v11, s27, v11
  v_lshlrev_b32 v16, 4, v1
  v_add_u32 v17, s31, v16
  v_subrev_u32 v17, 8, v17
  v_add_u32 v16, s27, v16
  v_cmp_gt_u32 s[56:57], 32, v1
  v_cmp_gt_u32 s[58:59], 33, v1
  v_and_b32 v18, 1, v1
  v_cmp_eq_u32 s[44:45], 1, v18
  v_cmp_eq_u32 vcc, 0, v1
  s_waitcnt vmcnt(9)
  ds_read_u16 v96, v17 offset:0
  ds_read_u16 v97, v17 offset:2
  ds_read_u16 v98, v17 offset:4
  ds_read_u16 v99, v17 offset:6
  ds_read_u16 v100, v17 offset:8
  ds_read_u16 v101, v17 offset:10
  ds_read_u16 v102, v17 offset:12
  ds_read_u16 v103, v17 offset:14
  ds_read_u16 v104, v17 offset:16
  ds_read_u16 v105, v17 offset:18
  ds_read_u16 v106, v17 offset:20
  ds_read_u16 v107, v17 offset:22
  ds_read_u16 v108, v17 offset:24
  ds_read_u16 v110, v17 offset:1024
  ds_read_u16 v111, v17 offset:1028
  ds_read_u16 v112, v17 offset:1032
  ds_read_u16 v113, v17 offset:1040
  ds_read_u16 v114, v17 offset:1048
  ds_read_u16 v116, v17 offset:2048
  ds_read_u16 v117, v17 offset:2056
  ds_read_u16 v118, v17 offset:2072
  ds_read_u16 v120, v17 offset:3080
  ds_read_u16 v121, v17 offset:3096
  v_mov_b32 v204, 0
  v_mov_b32 v205, 0
  v_mov_b32 v206, 0
  v_mov_b32 v207, 0
  s_mov_b64 exec, 0xff
  ds_write_b128 v16, v[204:207] offset:0
  ds_write_b128 v16, v[204:207] offset:4288
  ds_write_b128 v16, v[204:207] offset:8576
  ds_write_b128 v16, v[204:207] offset:12864
  s_mov_b64 exec, -1
  s_waitcnt lgkmcnt(14)
  v_cndmask_b32_e64 v124, v96, v97, s[58:59]
  v_cndmask_b32_e64 v125, v100, v99, s[58:59]
  v_cndmask_b32_e64 v126, v100, v101, s[56:57]
  v_cndmask_b32_e64 v127, v104, v103, s[56:57]
  v_cndmask_b32_e64 v128, v104, v105, s[56:57]
  v_cndmask_b32_e64 v129, v108, v107, s[56:57]
  v_cndmask_b32_e64 v124, v124, 0, vcc
  v_cndmask_b32_e64 v125, v125, 0, vcc
  v_cndmask_b32_e64 v130, v98, 0, vcc
  v_lshl_or_b32 v204, v126, 16, v100
  v_lshl_or_b32 v205, v127, 16, v102
  v_lshl_or_b32 v206, v128, 16, v104
  v_lshl_or_b32 v207, v129, 16, v106
  ds_write_b128 v16, v[204:207] offset:128
  v_lshl_or_b32 v208, v100, 16, v125
  v_lshl_or_b32 v209, v102, 16, v126
  v_lshl_or_b32 v210, v104, 16, v127
  v_lshl_or_b32 v211, v106, 16, v128
  ds_write_b128 v16, v[208:211] offset:4416
  v_lshl_or_b32 v204, v125, 16, v130
  v_lshl_or_b32 v205, v126, 16, v100
  v_lshl_or_b32 v206, v127, 16, v102
  v_lshl_or_b32 v207, v128, 16, v104
  ds_write_b128 v16, v[204:207] offset:8704
  v_lshl_or_b32 v208, v130, 16, v124
  v_lshl_or_b32 v209, v100, 16, v125
  v_lshl_or_b32 v210, v102, 16, v126
  v_lshl_or_b32 v211, v104, 16, v127
  ds_write_b128 v16, v[208:211] offset:12992
  s_waitcnt lgkmcnt(13)
  v_cndmask_b32_e64 v131, v112, v111, vcc
  v_lshl_or_b32 v212, v112, 16, v112
  v_lshl_or_b32 v213, v113, 16, v112
  v_lshl_or_b32 v214, v113, 16, v113
  v_lshl_or_b32 v215, v114, 16, v114
  ds_write_b128 v16, v[212:215] offset:1152
  v_lshl_or_b32 v216, v112, 16, v112
  v_lshl_or_b32 v217, v112, 16, v112
  v_lshl_or_b32 v218, v113, 16, v113
  v_lshl_or_b32 v219, v114, 16, v113
  ds_write_b128 v16, v[216:219] offset:5440
  v_lshl_or_b32 v212, v112, 16, v131
  v_lshl_or_b32 v213, v112, 16, v112
  v_lshl_or_b32 v214, v113, 16, v112
  v_lshl_or_b32 v215, v113, 16, v113
  ds_write_b128 v16, v[212:215] offset:9728
  v_lshl_or_b32 v216, v131, 16, v110
  v_lshl_or_b32 v217, v112, 16, v112
  v_lshl_or_b32 v218, v112, 16, v112
  v_lshl_or_b32 v219, v113, 16, v113
  ds_write_b128 v16, v[216:219] offset:14016
  s_waitcnt lgkmcnt(12)
  v_cndmask_b32_e64 v132, v117, v118, s[44:45]
  v_cndmask_b32_e64 v133, v117, v116, vcc
  v_lshl_or_b32 v204, v117, 16, v117
  v_lshl_or_b32 v205, v117, 16, v117
  v_lshl_or_b32 v206, v118, 16, v132
  v_lshl_or_b32 v207, v118, 16, v118
  ds_write_b128 v16, v[204:207] offset:2176
  v_lshl_or_b32 v208, v117, 16, v117
  v_lshl_or_b32 v209, v117, 16, v117
  v_lshl_or_b32 v210, v132, 16, v117
  v_lshl_or_b32 v211, v118, 16, v118
  ds_write_b128 v16, v[208:211] offset:6464
  v_lshl_or_b32 v204, v117, 16, v117
  v_lshl_or_b32 v205, v117, 16, v117
  v_lshl_or_b32 v206, v117, 16, v117
  v_lshl_or_b32 v207, v118, 16, v132
  ds_write_b128 v16, v[204:207] offset:10752
  v_lshl_or_b32 v208, v117, 16, v133
  v_lshl_or_b32 v209, v117, 16, v117
  v_lshl_or_b32 v210, v117, 16, v117
  v_lshl_or_b32 v211, v132, 16, v117
  ds_write_b128 v16, v[208:211] offset:15040
  v_cndmask_b32_e64 v134, v120, v121, s[44:45]
  v_lshl_or_b32 v212, v120, 16, v120
  v_lshl_or_b32 v213, v120, 16, v120
  v_lshl_or_b32 v214, v121, 16, v134
  v_lshl_or_b32 v215, v121, 16, v121
  ds_write_b128 v16, v[212:215] offset:3200
  v_lshl_or_b32 v216, v120, 16, v120
  v_lshl_or_b32 v217, v120, 16, v120
  v_lshl_or_b32 v218, v134, 16, v120
  v_lshl_or_b32 v219, v121, 16, v121
  ds_write_b128 v16, v[216:219] offset:7488
  v_lshl_or_b32 v212, v120, 16, v120
  v_lshl_or_b32 v213, v120, 16, v120
  v_lshl_or_b32 v214, v120, 16, v120
  v_lshl_or_b32 v215, v121, 16, v134
  ds_write_b128 v16, v[212:215] offset:11776
  v_lshl_or_b32 v216, v120, 16, v120
  v_lshl_or_b32 v217, v120, 16, v120
  v_lshl_or_b32 v218, v120, 16, v120
  v_lshl_or_b32 v219, v134, 16, v120
  ds_write_b128 v16, v[216:219] offset:16064
  s_waitcnt vmcnt(1)
  v_add_f32 v12, v84, v88
  v_add_f32 v76, v76, v80
  v_add_f32 v13, v85, v89
  v_add_f32 v77, v77, v81
  v_add_f32 v14, v86, v90
  v_add_f32 v78, v78, v82
  v_add_f32 v15, v87, v91
  v_add_f32 v79, v79, v83
  v_cvt_pk_bf16_f32 v12, v12, v12
  v_lshlrev_b32 v12, 16, v12
  v_cvt_pk_bf16_f32 v76, v76, v76
  v_lshlrev_b32 v76, 16, v76
  v_cvt_pk_bf16_f32 v13, v13, v13
  v_lshlrev_b32 v13, 16, v13
  v_cvt_pk_bf16_f32 v77, v77, v77
  v_lshlrev_b32 v77, 16, v77
  v_cvt_pk_bf16_f32 v14, v14, v14
  v_lshlrev_b32 v14, 16, v14
  v_cvt_pk_bf16_f32 v78, v78, v78
  v_lshlrev_b32 v78, 16, v78
  v_cvt_pk_bf16_f32 v15, v15, v15
  v_lshlrev_b32 v15, 16, v15
  v_cvt_pk_bf16_f32 v79, v79, v79
  v_lshlrev_b32 v79, 16, v79
  v_add_f32 v12, 1.0, v12
  v_add_f32 v13, 1.0, v13
  v_add_f32 v14, 1.0, v14
  v_add_f32 v15, 1.0, v15
  v_cvt_pk_bf16_f32 v12, v12, v12
  v_lshlrev_b32 v12, 16, v12
  v_cvt_pk_bf16_f32 v13, v13, v13
  v_lshlrev_b32 v13, 16, v13
  v_cvt_pk_bf16_f32 v14, v14, v14
  v_lshlrev_b32 v14, 16, v14
  v_cvt_pk_bf16_f32 v15, v15, v15
  v_lshlrev_b32 v15, 16, v15
  v_lshlrev_b32 v64, 16, v48
  v_and_b32 v65, 0xffff0000, v48
  v_lshlrev_b32 v66, 16, v49
  v_and_b32 v67, 0xffff0000, v49
  v_lshlrev_b32 v68, 16, v50
  v_and_b32 v69, 0xffff0000, v50
  v_lshlrev_b32 v70, 16, v51
  v_and_b32 v71, 0xffff0000, v51
  v_pk_fma_f32 v[64:65], v[64:65], v[12:13], v[76:77]
  v_pk_fma_f32 v[68:69], v[68:69], v[12:13], v[76:77]
  v_pk_fma_f32 v[66:67], v[66:67], v[14:15], v[78:79]
  v_pk_fma_f32 v[70:71], v[70:71], v[14:15], v[78:79]
  v_cvt_pk_bf16_f32 v72, v64, v68
  v_cvt_pk_bf16_f32 v73, v65, v69
  v_cvt_pk_bf16_f32 v74, v66, v70
  v_cvt_pk_bf16_f32 v75, v67, v71
  ds_write_b32 v6, v72 offset:0
  ds_write_b32 v6, v73 offset:24704
  ds_write_b32 v7, v74 offset:0
  ds_write_b32 v7, v75 offset:24704
  v_lshlrev_b32 v64, 16, v52
  v_and_b32 v65, 0xffff0000, v52
  v_lshlrev_b32 v66, 16, v53
  v_and_b32 v67, 0xffff0000, v53
  v_lshlrev_b32 v68, 16, v54
  v_and_b32 v69, 0xffff0000, v54
  v_lshlrev_b32 v70, 16, v55
  v_and_b32 v71, 0xffff0000, v55
  v_pk_fma_f32 v[64:65], v[64:65], v[12:13], v[76:77]
  v_pk_fma_f32 v[68:69], v[68:69], v[12:13], v[76:77]
  v_pk_fma_f32 v[66:67], v[66:67], v[14:15], v[78:79]
  v_pk_fma_f32 v[70:71], v[70:71], v[14:15], v[78:79]
  v_cvt_pk_bf16_f32 v72, v64, v68
  v_cvt_pk_bf16_f32 v73, v65, v69
  v_cvt_pk_bf16_f32 v74, v66, v70
  v_cvt_pk_bf16_f32 v75, v67, v71
  ds_write_b32 v6, v72 offset:1280
  ds_write_b32 v6, v73 offset:25984
  ds_write_b32 v7, v74 offset:1280
  ds_write_b32 v7, v75 offset:25984
  v_lshlrev_b32 v64, 16, v56
  v_and_b32 v65, 0xffff0000, v56
  v_lshlrev_b32 v66, 16, v57
  v_and_b32 v67, 0xffff0000, v57
  v_lshlrev_b32 v68, 16, v58
  v_and_b32 v69, 0xffff0000, v58
  v_lshlrev_b32 v70, 16, v59
  v_and_b32 v71, 0xffff0000, v59
  v_pk_fma_f32 v[64:65], v[64:65], v[12:13], v[76:77]
  v_pk_fma_f32 v[68:69], v[68:69], v[12:13], v[76:77]
  v_pk_fma_f32 v[66:67], v[66:67], v[14:15], v[78:79]
  v_pk_fma_f32 v[70:71], v[70:71], v[14:15], v[78:79]
  v_cvt_pk_bf16_f32 v72, v64, v68
  v_cvt_pk_bf16_f32 v73, v65, v69
  v_cvt_pk_bf16_f32 v74, v66, v70
  v_cvt_pk_bf16_f32 v75, v67, v71
  ds_write_b32 v6, v72 offset:2560
  ds_write_b32 v6, v73 offset:27264
  ds_write_b32 v7, v74 offset:2560
  ds_write_b32 v7, v75 offset:27264
  v_lshlrev_b32 v64, 16, v60
  v_and_b32 v65, 0xffff0000, v60
  v_lshlrev_b32 v66, 16, v61
  v_and_b32 v67, 0xffff0000, v61
  v_lshlrev_b32 v68, 16, v62
  v_and_b32 v69, 0xffff0000, v62
  v_lshlrev_b32 v70, 16, v63
  v_and_b32 v71, 0xffff0000, v63
  v_pk_fma_f32 v[64:65], v[64:65], v[12:13], v[76:77]
  v_pk_fma_f32 v[68:69], v[68:69], v[12:13], v[76:77]
  v_pk_fma_f32 v[66:67], v[66:67], v[14:15], v[78:79]
  v_pk_fma_f32 v[70:71], v[70:71], v[14:15], v[78:79]
  v_cvt_pk_bf16_f32 v72, v64, v68
  v_cvt_pk_bf16_f32 v73, v65, v69
  v_cvt_pk_bf16_f32 v74, v66, v70
  v_cvt_pk_bf16_f32 v75, v67, v71
  ds_write_b32 v6, v72 offset:3840
  ds_write_b32 v6, v73 offset:28544
  ds_write_b32 v7, v74 offset:3840
  ds_write_b32 v7, v75 offset:28544
  v_add_u32 v21, 8192, v21
  v_min_u32 v21, K2_W1-PFPC5-4, v21
  global_load_dword v219, v21, s[96:97]
  ds_read_b64_tr_b16 v[80:81], v10 offset:8
  ds_read_b64_tr_b16 v[82:83], v10 offset:0
  ds_read_b64_tr_b16 v[84:85], v10 offset:40
  ds_read_b64_tr_b16 v[86:87], v10 offset:32
  ds_read_b64_tr_b16 v[48:49], v10 offset:72
  ds_read_b64_tr_b16 v[50:51], v10 offset:64
  ds_read_b64_tr_b16 v[52:53], v10 offset:104
  ds_read_b64_tr_b16 v[54:55], v10 offset:96
  ds_read_b64_tr_b16 v[56:57], v10 offset:136
  ds_read_b64_tr_b16 v[58:59], v10 offset:128
  ds_read_b64_tr_b16 v[60:61], v10 offset:168
  ds_read_b64_tr_b16 v[62:63], v10 offset:160
  ds_read_b64_tr_b16 v[96:97], v10 offset:2056
  ds_read_b64_tr_b16 v[98:99], v10 offset:2048
  ds_read_b64_tr_b16 v[100:101], v10 offset:2088
  ds_read_b64_tr_b16 v[102:103], v10 offset:2080
  ds_read_b64_tr_b16 v[104:105], v10 offset:2120
  ds_read_b64_tr_b16 v[106:107], v10 offset:2112
  ds_read_b64_tr_b16 v[108:109], v10 offset:2152
  ds_read_b64_tr_b16 v[110:111], v10 offset:2144
  ds_read_b64_tr_b16 v[112:113], v10 offset:2184
  ds_read_b64_tr_b16 v[114:115], v10 offset:2176
  ds_read_b64_tr_b16 v[116:117], v10 offset:2216
  ds_read_b64_tr_b16 v[118:119], v10 offset:2208
  s_waitcnt lgkmcnt(15)
  s_barrier
  ds_read_b128 v[128:131], v11 offset:4960
  ds_read_b128 v[136:139], v11 offset:2400
  ds_read_b128 v[132:135], v11 offset:5024
  ds_read_b128 v[140:143], v11 offset:2464
  v_mul_u32_u24 v12, 160, v8
  v_lshl_add_u32 v12, v9, 3, v12
  v_add_u32 v12, 19552, v12
  v_add_u32 v12, s27, v12
  s_waitcnt lgkmcnt(0)
  v_mfma_f32_16x16x32_bf16 v[32:35], v[48:51], v[128:131], 0
  ds_read_b64_tr_b16 v[64:65], v10 offset:200
  ds_read_b64_tr_b16 v[66:67], v10 offset:192
  v_mfma_f32_16x16x32_bf16 v[36:39], v[52:55], v[128:131], 0
  ds_read_b64_tr_b16 v[68:69], v10 offset:232
  ds_read_b64_tr_b16 v[70:71], v10 offset:224
  v_mfma_f32_16x16x32_bf16 v[40:43], v[56:59], v[128:131], 0
  ds_read_b64_tr_b16 v[72:73], v10 offset:264
  s_lshl_b32 s56, s2, 2
  s_add_u32 s56, s56, s3
  v_mfma_f32_16x16x32_bf16 v[44:47], v[60:63], v[128:131], 0
  ds_read_b64_tr_b16 v[74:75], v10 offset:256
  s_add_u32 s56, s56, 72
  s_mul_i32 s57, s56, 3641
  v_mfma_f32_16x16x32_bf16 v[32:35], v[80:83], v[132:135], v[32:35]
  ds_read_b64_tr_b16 v[76:77], v10 offset:296
  s_lshr_b32 s57, s57, 16
  s_mul_i32 s58, s57, 18
  v_mfma_f32_16x16x32_bf16 v[36:39], v[84:87], v[132:135], v[36:39]
  ds_read_b64_tr_b16 v[78:79], v10 offset:288
  s_sub_u32 s58, s56, s58
  s_mov_b32 s48, s88
  v_mfma_f32_16x16x32_bf16 v[40:43], v[48:51], v[132:135], v[40:43]
  ds_read_b128 v[144:147], v11 offset:4800
  s_mov_b32 s49, s89
  s_mov_b32 s50, 5308416
  v_mfma_f32_16x16x32_bf16 v[44:47], v[52:55], v[132:135], v[44:47]
  ds_read_b128 v[152:155], v11 offset:2240
  s_mov_b32 s51, 0x20000
  s_lshl_b32 s59, s57, 8
  v_mfma_f32_16x16x32_bf16 v[16:19], v[48:51], v[136:139], 0
  ds_read_b128 v[148:151], v11 offset:4864
  s_mul_i32 s56, s58, 294912
  s_add_u32 s59, s59, s56
  v_mfma_f32_16x16x32_bf16 v[20:23], v[52:55], v[136:139], 0
  ds_read_b128 v[156:159], v11 offset:2304
  v_lshl_add_u32 v200, v8, 4, s59
  v_mfma_f32_16x16x32_bf16 v[24:27], v[56:59], v[136:139], 0
  ds_read_b64_tr_b16 v[120:121], v10 offset:2248
  v_lshlrev_b32 v201, 3, v9
  v_mfma_f32_16x16x32_bf16 v[28:31], v[60:63], v[136:139], 0
  ds_read_b64_tr_b16 v[122:123], v10 offset:2240
  v_mul_u32_u24 v201, 9216, v201
  v_mfma_f32_16x16x32_bf16 v[16:19], v[80:83], v[140:143], v[16:19]
  ds_read_b64_tr_b16 v[124:125], v10 offset:2280
  v_add_u32 v200, v200, v201
  v_mfma_f32_16x16x32_bf16 v[20:23], v[84:87], v[140:143], v[20:23]
  ds_read_b64_tr_b16 v[126:127], v10 offset:2272
  s_mov_b32 s56, 0
  buffer_load_dwordx4 v[160:163], v200, s[48:51], s56 offen nt
  v_mfma_f32_16x16x32_bf16 v[24:27], v[48:51], v[140:143], v[24:27]
  ds_read_b64_tr_b16 v[88:89], v10 offset:2312
  s_mov_b32 s56, 9216
  buffer_load_dwordx4 v[164:167], v200, s[48:51], s56 offen nt
  v_mfma_f32_16x16x32_bf16 v[28:31], v[52:55], v[140:143], v[28:31]
  ds_read_b64_tr_b16 v[90:91], v10 offset:2304
  s_mov_b32 s56, 18432
  buffer_load_dwordx4 v[168:171], v200, s[48:51], s56 offen nt
  v_mfma_f32_16x16x32_bf16 v[32:35], v[104:107], v[136:139], v[32:35]
  ds_read_b64_tr_b16 v[92:93], v10 offset:2344
  s_mov_b32 s56, 27648
  buffer_load_dwordx4 v[172:175], v200, s[48:51], s56 offen nt
  v_mfma_f32_16x16x32_bf16 v[36:39], v[108:111], v[136:139], v[36:39]
  ds_read_b64_tr_b16 v[94:95], v10 offset:2336
  s_mov_b32 s56, 36864
  buffer_load_dwordx4 v[176:179], v200, s[48:51], s56 offen nt
  v_mfma_f32_16x16x32_bf16 v[40:43], v[112:115], v[136:139], v[40:43]
  s_mov_b32 s56, 46080
  buffer_load_dwordx4 v[180:183], v200, s[48:51], s56 offen nt
  v_mfma_f32_16x16x32_bf16 v[44:47], v[116:119], v[136:139], v[44:47]
  s_mov_b32 s56, 55296
  buffer_load_dwordx4 v[184:187], v200, s[48:51], s56 offen nt
  v_mfma_f32_16x16x32_bf16 v[32:35], v[96:99], v[140:143], v[32:35]
  s_mov_b32 s56, 64512
  buffer_load_dwordx4 v[188:191], v200, s[48:51], s56 offen nt
  v_mfma_f32_16x16x32_bf16 v[36:39], v[100:103], v[140:143], v[36:39]
  s_add_u32 s52, s4, 11976704
  s_addc_u32 s53, s5, 0
  v_mfma_f32_16x16x32_bf16 v[40:43], v[104:107], v[140:143], v[40:43]
  s_mov_b32 s54, 10616832
  s_mov_b32 s55, 0x20000
  v_mfma_f32_16x16x32_bf16 v[44:47], v[108:111], v[140:143], v[44:47]
  s_mul_i32 s59, s57, 294912
  s_lshl_b32 s56, s58, 11
  s_waitcnt lgkmcnt(0)
  v_mfma_f32_16x16x32_bf16 v[32:35], v[64:67], v[144:147], v[32:35]
  ds_read_b64_tr_b16 v[80:81], v10 offset:328
  ds_read_b64_tr_b16 v[82:83], v10 offset:320
  v_mfma_f32_16x16x32_bf16 v[36:39], v[68:71], v[144:147], v[36:39]
  ds_read_b64_tr_b16 v[84:85], v10 offset:360
  ds_read_b64_tr_b16 v[86:87], v10 offset:352
  v_mfma_f32_16x16x32_bf16 v[40:43], v[72:75], v[144:147], v[40:43]
  ds_read_b64_tr_b16 v[48:49], v10 offset:392
  s_add_u32 s59, s59, s56
  s_add_u32 s59, s59, 1024
  v_mfma_f32_16x16x32_bf16 v[44:47], v[76:79], v[144:147], v[44:47]
  ds_read_b64_tr_b16 v[50:51], v10 offset:384
  v_lshl_add_u32 v201, v1, 4, s59
  v_mfma_f32_16x16x32_bf16 v[32:35], v[56:59], v[148:151], v[32:35]
  ds_read_b64_tr_b16 v[52:53], v10 offset:424
  s_mov_b32 s46, 0x05040100
  s_mov_b32 s47, 0x07060302
  v_mfma_f32_16x16x32_bf16 v[36:39], v[60:63], v[148:151], v[36:39]
  ds_read_b64_tr_b16 v[54:55], v10 offset:416
  v_mfma_f32_16x16x32_bf16 v[40:43], v[64:67], v[148:151], v[40:43]
  ds_read_b128 v[128:131], v11 offset:4640
  v_mfma_f32_16x16x32_bf16 v[44:47], v[68:71], v[148:151], v[44:47]
  ds_read_b128 v[136:139], v11 offset:2080
  v_mfma_f32_16x16x32_bf16 v[16:19], v[64:67], v[152:155], v[16:19]
  ds_read_b128 v[132:135], v11 offset:4704
  v_mfma_f32_16x16x32_bf16 v[20:23], v[68:71], v[152:155], v[20:23]
  ds_read_b128 v[140:143], v11 offset:2144
  v_mfma_f32_16x16x32_bf16 v[24:27], v[72:75], v[152:155], v[24:27]
  ds_read_b64_tr_b16 v[96:97], v10 offset:2376
  v_mfma_f32_16x16x32_bf16 v[28:31], v[76:79], v[152:155], v[28:31]
  ds_read_b64_tr_b16 v[98:99], v10 offset:2368
  v_mfma_f32_16x16x32_bf16 v[16:19], v[56:59], v[156:159], v[16:19]
  ds_read_b64_tr_b16 v[100:101], v10 offset:2408
  v_mfma_f32_16x16x32_bf16 v[20:23], v[60:63], v[156:159], v[20:23]
  ds_read_b64_tr_b16 v[102:103], v10 offset:2400
  v_mfma_f32_16x16x32_bf16 v[24:27], v[64:67], v[156:159], v[24:27]
  ds_read_b64_tr_b16 v[104:105], v10 offset:2440
  v_mfma_f32_16x16x32_bf16 v[28:31], v[68:71], v[156:159], v[28:31]
  ds_read_b64_tr_b16 v[106:107], v10 offset:2432
  v_mfma_f32_16x16x32_bf16 v[32:35], v[120:123], v[152:155], v[32:35]
  ds_read_b64_tr_b16 v[108:109], v10 offset:2472
  v_mfma_f32_16x16x32_bf16 v[36:39], v[124:127], v[152:155], v[36:39]
  ds_read_b64_tr_b16 v[110:111], v10 offset:2464
  v_mfma_f32_16x16x32_bf16 v[40:43], v[88:91], v[152:155], v[40:43]
  v_mfma_f32_16x16x32_bf16 v[44:47], v[92:95], v[152:155], v[44:47]
  v_mfma_f32_16x16x32_bf16 v[32:35], v[112:115], v[156:159], v[32:35]
  v_mfma_f32_16x16x32_bf16 v[36:39], v[116:119], v[156:159], v[36:39]
  v_mfma_f32_16x16x32_bf16 v[40:43], v[120:123], v[156:159], v[40:43]
  v_mfma_f32_16x16x32_bf16 v[44:47], v[124:127], v[156:159], v[44:47]
  s_waitcnt lgkmcnt(0)
  v_mfma_f32_16x16x32_bf16 v[32:35], v[80:83], v[128:131], v[32:35]
  ds_read_b64_tr_b16 v[56:57], v10 offset:456
  ds_read_b64_tr_b16 v[58:59], v10 offset:448
  v_mfma_f32_16x16x32_bf16 v[36:39], v[84:87], v[128:131], v[36:39]
  ds_read_b64_tr_b16 v[60:61], v10 offset:488
  ds_read_b64_tr_b16 v[62:63], v10 offset:480
  v_mfma_f32_16x16x32_bf16 v[40:43], v[48:51], v[128:131], v[40:43]
  ds_read_b64_tr_b16 v[64:65], v10 offset:520
  v_mfma_f32_16x16x32_bf16 v[44:47], v[52:55], v[128:131], v[44:47]
  ds_read_b64_tr_b16 v[66:67], v10 offset:512
  v_mfma_f32_16x16x32_bf16 v[32:35], v[72:75], v[132:135], v[32:35]
  ds_read_b64_tr_b16 v[68:69], v10 offset:552
  v_mfma_f32_16x16x32_bf16 v[36:39], v[76:79], v[132:135], v[36:39]
  ds_read_b64_tr_b16 v[70:71], v10 offset:544
  v_mfma_f32_16x16x32_bf16 v[40:43], v[80:83], v[132:135], v[40:43]
  ds_read_b128 v[144:147], v11 offset:4480
  v_mfma_f32_16x16x32_bf16 v[44:47], v[84:87], v[132:135], v[44:47]
  ds_read_b128 v[152:155], v11 offset:1920
  v_mfma_f32_16x16x32_bf16 v[16:19], v[80:83], v[136:139], v[16:19]
  ds_read_b128 v[148:151], v11 offset:4544
  v_mfma_f32_16x16x32_bf16 v[20:23], v[84:87], v[136:139], v[20:23]
  ds_read_b128 v[156:159], v11 offset:1984
  v_mfma_f32_16x16x32_bf16 v[24:27], v[48:51], v[136:139], v[24:27]
  ds_read_b64_tr_b16 v[112:113], v10 offset:2504
  v_mfma_f32_16x16x32_bf16 v[28:31], v[52:55], v[136:139], v[28:31]
  ds_read_b64_tr_b16 v[114:115], v10 offset:2496
  v_mfma_f32_16x16x32_bf16 v[16:19], v[72:75], v[140:143], v[16:19]
  ds_read_b64_tr_b16 v[116:117], v10 offset:2536
  v_mfma_f32_16x16x32_bf16 v[20:23], v[76:79], v[140:143], v[20:23]
  ds_read_b64_tr_b16 v[118:119], v10 offset:2528
  v_mfma_f32_16x16x32_bf16 v[24:27], v[80:83], v[140:143], v[24:27]
  ds_read_b64_tr_b16 v[120:121], v10 offset:2568
  v_mfma_f32_16x16x32_bf16 v[28:31], v[84:87], v[140:143], v[28:31]
  ds_read_b64_tr_b16 v[122:123], v10 offset:2560
  v_mfma_f32_16x16x32_bf16 v[32:35], v[96:99], v[136:139], v[32:35]
  ds_read_b64_tr_b16 v[124:125], v10 offset:2600
  v_mfma_f32_16x16x32_bf16 v[36:39], v[100:103], v[136:139], v[36:39]
  ds_read_b64_tr_b16 v[126:127], v10 offset:2592
  v_mfma_f32_16x16x32_bf16 v[40:43], v[104:107], v[136:139], v[40:43]
  v_mfma_f32_16x16x32_bf16 v[44:47], v[108:111], v[136:139], v[44:47]
  v_mfma_f32_16x16x32_bf16 v[32:35], v[88:91], v[140:143], v[32:35]
  v_mfma_f32_16x16x32_bf16 v[36:39], v[92:95], v[140:143], v[36:39]
  v_mfma_f32_16x16x32_bf16 v[40:43], v[96:99], v[140:143], v[40:43]
  v_mfma_f32_16x16x32_bf16 v[44:47], v[100:103], v[140:143], v[44:47]
  s_waitcnt lgkmcnt(0)
  v_mfma_f32_16x16x32_bf16 v[32:35], v[56:59], v[144:147], v[32:35]
  ds_read_b64_tr_b16 v[72:73], v10 offset:584
  ds_read_b64_tr_b16 v[74:75], v10 offset:576
  v_mfma_f32_16x16x32_bf16 v[36:39], v[60:63], v[144:147], v[36:39]
  ds_read_b64_tr_b16 v[76:77], v10 offset:616
  ds_read_b64_tr_b16 v[78:79], v10 offset:608
  v_mfma_f32_16x16x32_bf16 v[40:43], v[64:67], v[144:147], v[40:43]
  ds_read_b64_tr_b16 v[80:81], v10 offset:648
  v_mfma_f32_16x16x32_bf16 v[44:47], v[68:71], v[144:147], v[44:47]
  ds_read_b64_tr_b16 v[82:83], v10 offset:640
  v_mfma_f32_16x16x32_bf16 v[32:35], v[48:51], v[148:151], v[32:35]
  ds_read_b64_tr_b16 v[84:85], v10 offset:680
  v_mfma_f32_16x16x32_bf16 v[36:39], v[52:55], v[148:151], v[36:39]
  ds_read_b64_tr_b16 v[86:87], v10 offset:672
  v_mfma_f32_16x16x32_bf16 v[40:43], v[56:59], v[148:151], v[40:43]
  ds_read_b128 v[128:131], v11 offset:4320
  v_mfma_f32_16x16x32_bf16 v[44:47], v[60:63], v[148:151], v[44:47]
  ds_read_b128 v[136:139], v11 offset:1760
  v_mfma_f32_16x16x32_bf16 v[16:19], v[56:59], v[152:155], v[16:19]
  ds_read_b128 v[132:135], v11 offset:4384
  v_mfma_f32_16x16x32_bf16 v[20:23], v[60:63], v[152:155], v[20:23]
  ds_read_b128 v[140:143], v11 offset:1824
  v_mfma_f32_16x16x32_bf16 v[24:27], v[64:67], v[152:155], v[24:27]
  ds_read_b64_tr_b16 v[88:89], v10 offset:2632
  v_mfma_f32_16x16x32_bf16 v[28:31], v[68:71], v[152:155], v[28:31]
  ds_read_b64_tr_b16 v[90:91], v10 offset:2624
  v_mfma_f32_16x16x32_bf16 v[16:19], v[48:51], v[156:159], v[16:19]
  ds_read_b64_tr_b16 v[92:93], v10 offset:2664
  v_mfma_f32_16x16x32_bf16 v[20:23], v[52:55], v[156:159], v[20:23]
  ds_read_b64_tr_b16 v[94:95], v10 offset:2656
  v_mfma_f32_16x16x32_bf16 v[24:27], v[56:59], v[156:159], v[24:27]
  ds_read_b64_tr_b16 v[96:97], v10 offset:2696
  v_mfma_f32_16x16x32_bf16 v[28:31], v[60:63], v[156:159], v[28:31]
  ds_read_b64_tr_b16 v[98:99], v10 offset:2688
  v_mfma_f32_16x16x32_bf16 v[32:35], v[112:115], v[152:155], v[32:35]
  ds_read_b64_tr_b16 v[100:101], v10 offset:2728
  v_mfma_f32_16x16x32_bf16 v[36:39], v[116:119], v[152:155], v[36:39]
  ds_read_b64_tr_b16 v[102:103], v10 offset:2720
  v_mfma_f32_16x16x32_bf16 v[40:43], v[120:123], v[152:155], v[40:43]
  v_mfma_f32_16x16x32_bf16 v[44:47], v[124:127], v[152:155], v[44:47]
  v_mfma_f32_16x16x32_bf16 v[32:35], v[104:107], v[156:159], v[32:35]
  v_mfma_f32_16x16x32_bf16 v[36:39], v[108:111], v[156:159], v[36:39]
  v_mfma_f32_16x16x32_bf16 v[40:43], v[112:115], v[156:159], v[40:43]
  v_mfma_f32_16x16x32_bf16 v[44:47], v[116:119], v[156:159], v[44:47]
  s_waitcnt lgkmcnt(0)
  v_mfma_f32_16x16x32_bf16 v[32:35], v[72:75], v[128:131], v[32:35]
  ds_read_b64_tr_b16 v[48:49], v10 offset:712
  ds_read_b64_tr_b16 v[50:51], v10 offset:704
  v_mfma_f32_16x16x32_bf16 v[36:39], v[76:79], v[128:131], v[36:39]
  ds_read_b64_tr_b16 v[52:53], v10 offset:744
  ds_read_b64_tr_b16 v[54:55], v10 offset:736
  v_mfma_f32_16x16x32_bf16 v[40:43], v[80:83], v[128:131], v[40:43]
  ds_read_b64_tr_b16 v[56:57], v10 offset:776
  v_mfma_f32_16x16x32_bf16 v[44:47], v[84:87], v[128:131], v[44:47]
  ds_read_b64_tr_b16 v[58:59], v10 offset:768
  v_mfma_f32_16x16x32_bf16 v[32:35], v[64:67], v[132:135], v[32:35]
  ds_read_b64_tr_b16 v[60:61], v10 offset:808
  v_mfma_f32_16x16x32_bf16 v[36:39], v[68:71], v[132:135], v[36:39]
  ds_read_b64_tr_b16 v[62:63], v10 offset:800
  v_mfma_f32_16x16x32_bf16 v[40:43], v[72:75], v[132:135], v[40:43]
  ds_read_b128 v[144:147], v11 offset:4160
  v_mfma_f32_16x16x32_bf16 v[44:47], v[76:79], v[132:135], v[44:47]
  ds_read_b128 v[152:155], v11 offset:1600
  v_mfma_f32_16x16x32_bf16 v[16:19], v[72:75], v[136:139], v[16:19]
  ds_read_b128 v[148:151], v11 offset:4224
  v_mfma_f32_16x16x32_bf16 v[20:23], v[76:79], v[136:139], v[20:23]
  ds_read_b128 v[156:159], v11 offset:1664
  v_mfma_f32_16x16x32_bf16 v[24:27], v[80:83], v[136:139], v[24:27]
  ds_read_b64_tr_b16 v[104:105], v10 offset:2760
  v_mfma_f32_16x16x32_bf16 v[28:31], v[84:87], v[136:139], v[28:31]
  ds_read_b64_tr_b16 v[106:107], v10 offset:2752
  v_mfma_f32_16x16x32_bf16 v[16:19], v[64:67], v[140:143], v[16:19]
  ds_read_b64_tr_b16 v[108:109], v10 offset:2792
  v_mfma_f32_16x16x32_bf16 v[20:23], v[68:71], v[140:143], v[20:23]
  ds_read_b64_tr_b16 v[110:111], v10 offset:2784
  v_mfma_f32_16x16x32_bf16 v[24:27], v[72:75], v[140:143], v[24:27]
  ds_read_b64_tr_b16 v[112:113], v10 offset:2824
  v_mfma_f32_16x16x32_bf16 v[28:31], v[76:79], v[140:143], v[28:31]
  ds_read_b64_tr_b16 v[114:115], v10 offset:2816
  v_mfma_f32_16x16x32_bf16 v[32:35], v[88:91], v[136:139], v[32:35]
  ds_read_b64_tr_b16 v[116:117], v10 offset:2856
  v_mfma_f32_16x16x32_bf16 v[36:39], v[92:95], v[136:139], v[36:39]
  ds_read_b64_tr_b16 v[118:119], v10 offset:2848
  v_mfma_f32_16x16x32_bf16 v[40:43], v[96:99], v[136:139], v[40:43]
  v_mfma_f32_16x16x32_bf16 v[44:47], v[100:103], v[136:139], v[44:47]
  v_mfma_f32_16x16x32_bf16 v[32:35], v[120:123], v[140:143], v[32:35]
  v_mfma_f32_16x16x32_bf16 v[36:39], v[124:127], v[140:143], v[36:39]
  v_mfma_f32_16x16x32_bf16 v[40:43], v[88:91], v[140:143], v[40:43]
  v_mfma_f32_16x16x32_bf16 v[44:47], v[92:95], v[140:143], v[44:47]
  s_waitcnt lgkmcnt(0)
  v_mfma_f32_16x16x32_bf16 v[32:35], v[48:51], v[144:147], v[32:35]
  ds_read_b64_tr_b16 v[64:65], v10 offset:840
  ds_read_b64_tr_b16 v[66:67], v10 offset:832
  v_mfma_f32_16x16x32_bf16 v[36:39], v[52:55], v[144:147], v[36:39]
  ds_read_b64_tr_b16 v[68:69], v10 offset:872
  ds_read_b64_tr_b16 v[70:71], v10 offset:864
  v_mfma_f32_16x16x32_bf16 v[40:43], v[56:59], v[144:147], v[40:43]
  ds_read_b64_tr_b16 v[72:73], v10 offset:904
  v_mfma_f32_16x16x32_bf16 v[44:47], v[60:63], v[144:147], v[44:47]
  ds_read_b64_tr_b16 v[74:75], v10 offset:896
  v_mfma_f32_16x16x32_bf16 v[32:35], v[80:83], v[148:151], v[32:35]
  ds_read_b64_tr_b16 v[76:77], v10 offset:936
  v_mfma_f32_16x16x32_bf16 v[36:39], v[84:87], v[148:151], v[36:39]
  ds_read_b64_tr_b16 v[78:79], v10 offset:928
  v_mfma_f32_16x16x32_bf16 v[40:43], v[48:51], v[148:151], v[40:43]
  ds_read_b128 v[128:131], v11 offset:4000
  v_mfma_f32_16x16x32_bf16 v[44:47], v[52:55], v[148:151], v[44:47]
  ds_read_b128 v[136:139], v11 offset:1440
  v_mfma_f32_16x16x32_bf16 v[16:19], v[48:51], v[152:155], v[16:19]
  ds_read_b128 v[132:135], v11 offset:4064
  v_mfma_f32_16x16x32_bf16 v[20:23], v[52:55], v[152:155], v[20:23]
  ds_read_b128 v[140:143], v11 offset:1504
  v_mfma_f32_16x16x32_bf16 v[24:27], v[56:59], v[152:155], v[24:27]
  ds_read_b64_tr_b16 v[120:121], v10 offset:2888
  v_mfma_f32_16x16x32_bf16 v[28:31], v[60:63], v[152:155], v[28:31]
  ds_read_b64_tr_b16 v[122:123], v10 offset:2880
  v_mfma_f32_16x16x32_bf16 v[16:19], v[80:83], v[156:159], v[16:19]
  ds_read_b64_tr_b16 v[124:125], v10 offset:2920
  v_mfma_f32_16x16x32_bf16 v[20:23], v[84:87], v[156:159], v[20:23]
  ds_read_b64_tr_b16 v[126:127], v10 offset:2912
  v_mfma_f32_16x16x32_bf16 v[24:27], v[48:51], v[156:159], v[24:27]
  ds_read_b64_tr_b16 v[88:89], v10 offset:2952
  v_mfma_f32_16x16x32_bf16 v[28:31], v[52:55], v[156:159], v[28:31]
  ds_read_b64_tr_b16 v[90:91], v10 offset:2944
  v_mfma_f32_16x16x32_bf16 v[32:35], v[104:107], v[152:155], v[32:35]
  ds_read_b64_tr_b16 v[92:93], v10 offset:2984
  v_mfma_f32_16x16x32_bf16 v[36:39], v[108:111], v[152:155], v[36:39]
  ds_read_b64_tr_b16 v[94:95], v10 offset:2976
  v_mfma_f32_16x16x32_bf16 v[40:43], v[112:115], v[152:155], v[40:43]
  v_mfma_f32_16x16x32_bf16 v[44:47], v[116:119], v[152:155], v[44:47]
  v_mfma_f32_16x16x32_bf16 v[32:35], v[96:99], v[156:159], v[32:35]
  v_mfma_f32_16x16x32_bf16 v[36:39], v[100:103], v[156:159], v[36:39]
  v_mfma_f32_16x16x32_bf16 v[40:43], v[104:107], v[156:159], v[40:43]
  v_mfma_f32_16x16x32_bf16 v[44:47], v[108:111], v[156:159], v[44:47]
  s_waitcnt lgkmcnt(0)
  v_mfma_f32_16x16x32_bf16 v[32:35], v[64:67], v[128:131], v[32:35]
  ds_read_b64_tr_b16 v[80:81], v10 offset:968
  ds_read_b64_tr_b16 v[82:83], v10 offset:960
  v_mfma_f32_16x16x32_bf16 v[36:39], v[68:71], v[128:131], v[36:39]
  ds_read_b64_tr_b16 v[84:85], v10 offset:1000
  ds_read_b64_tr_b16 v[86:87], v10 offset:992
  v_mfma_f32_16x16x32_bf16 v[40:43], v[72:75], v[128:131], v[40:43]
  ds_read_b64_tr_b16 v[48:49], v10 offset:1032
  v_mfma_f32_16x16x32_bf16 v[44:47], v[76:79], v[128:131], v[44:47]
  ds_read_b64_tr_b16 v[50:51], v10 offset:1024
  v_mfma_f32_16x16x32_bf16 v[32:35], v[56:59], v[132:135], v[32:35]
  ds_read_b64_tr_b16 v[52:53], v10 offset:1064
  v_mfma_f32_16x16x32_bf16 v[36:39], v[60:63], v[132:135], v[36:39]
  ds_read_b64_tr_b16 v[54:55], v10 offset:1056
  v_mfma_f32_16x16x32_bf16 v[40:43], v[64:67], v[132:135], v[40:43]
  ds_read_b128 v[144:147], v11 offset:3840
  v_mfma_f32_16x16x32_bf16 v[44:47], v[68:71], v[132:135], v[44:47]
  ds_read_b128 v[152:155], v11 offset:1280
  v_mfma_f32_16x16x32_bf16 v[16:19], v[64:67], v[136:139], v[16:19]
  ds_read_b128 v[148:151], v11 offset:3904
  v_mfma_f32_16x16x32_bf16 v[20:23], v[68:71], v[136:139], v[20:23]
  ds_read_b128 v[156:159], v11 offset:1344
  v_mfma_f32_16x16x32_bf16 v[24:27], v[72:75], v[136:139], v[24:27]
  ds_read_b64_tr_b16 v[96:97], v10 offset:3016
  v_mfma_f32_16x16x32_bf16 v[28:31], v[76:79], v[136:139], v[28:31]
  ds_read_b64_tr_b16 v[98:99], v10 offset:3008
  v_mfma_f32_16x16x32_bf16 v[16:19], v[56:59], v[140:143], v[16:19]
  ds_read_b64_tr_b16 v[100:101], v10 offset:3048
  v_mfma_f32_16x16x32_bf16 v[20:23], v[60:63], v[140:143], v[20:23]
  ds_read_b64_tr_b16 v[102:103], v10 offset:3040
  v_mfma_f32_16x16x32_bf16 v[24:27], v[64:67], v[140:143], v[24:27]
  ds_read_b64_tr_b16 v[104:105], v10 offset:3080
  v_mfma_f32_16x16x32_bf16 v[28:31], v[68:71], v[140:143], v[28:31]
  ds_read_b64_tr_b16 v[106:107], v10 offset:3072
  v_mfma_f32_16x16x32_bf16 v[32:35], v[120:123], v[136:139], v[32:35]
  ds_read_b64_tr_b16 v[108:109], v10 offset:3112
  v_mfma_f32_16x16x32_bf16 v[36:39], v[124:127], v[136:139], v[36:39]
  ds_read_b64_tr_b16 v[110:111], v10 offset:3104
  v_mfma_f32_16x16x32_bf16 v[40:43], v[88:91], v[136:139], v[40:43]
  v_mfma_f32_16x16x32_bf16 v[44:47], v[92:95], v[136:139], v[44:47]
  v_mfma_f32_16x16x32_bf16 v[32:35], v[112:115], v[140:143], v[32:35]
  v_mfma_f32_16x16x32_bf16 v[36:39], v[116:119], v[140:143], v[36:39]
  v_mfma_f32_16x16x32_bf16 v[40:43], v[120:123], v[140:143], v[40:43]
  v_mfma_f32_16x16x32_bf16 v[44:47], v[124:127], v[140:143], v[44:47]
  s_waitcnt lgkmcnt(0)
  v_mfma_f32_16x16x32_bf16 v[32:35], v[80:83], v[144:147], v[32:35]
  ds_read_b64_tr_b16 v[56:57], v10 offset:1096
  ds_read_b64_tr_b16 v[58:59], v10 offset:1088
  v_mfma_f32_16x16x32_bf16 v[36:39], v[84:87], v[144:147], v[36:39]
  ds_read_b64_tr_b16 v[60:61], v10 offset:1128
  ds_read_b64_tr_b16 v[62:63], v10 offset:1120
  v_mfma_f32_16x16x32_bf16 v[40:43], v[48:51], v[144:147], v[40:43]
  ds_read_b64_tr_b16 v[64:65], v10 offset:1160
  v_mfma_f32_16x16x32_bf16 v[44:47], v[52:55], v[144:147], v[44:47]
  ds_read_b64_tr_b16 v[66:67], v10 offset:1152
  v_mfma_f32_16x16x32_bf16 v[32:35], v[72:75], v[148:151], v[32:35]
  ds_read_b64_tr_b16 v[68:69], v10 offset:1192
  v_mfma_f32_16x16x32_bf16 v[36:39], v[76:79], v[148:151], v[36:39]
  ds_read_b64_tr_b16 v[70:71], v10 offset:1184
  v_mfma_f32_16x16x32_bf16 v[40:43], v[80:83], v[148:151], v[40:43]
  ds_read_b128 v[128:131], v11 offset:3680
  v_mfma_f32_16x16x32_bf16 v[44:47], v[84:87], v[148:151], v[44:47]
  ds_read_b128 v[136:139], v11 offset:1120
  v_mfma_f32_16x16x32_bf16 v[16:19], v[80:83], v[152:155], v[16:19]
  ds_read_b128 v[132:135], v11 offset:3744
  v_mfma_f32_16x16x32_bf16 v[20:23], v[84:87], v[152:155], v[20:23]
  ds_read_b128 v[140:143], v11 offset:1184
  v_mfma_f32_16x16x32_bf16 v[24:27], v[48:51], v[152:155], v[24:27]
  ds_read_b64_tr_b16 v[112:113], v10 offset:3144
  v_mfma_f32_16x16x32_bf16 v[28:31], v[52:55], v[152:155], v[28:31]
  ds_read_b64_tr_b16 v[114:115], v10 offset:3136
  v_mfma_f32_16x16x32_bf16 v[16:19], v[72:75], v[156:159], v[16:19]
  ds_read_b64_tr_b16 v[116:117], v10 offset:3176
  v_mfma_f32_16x16x32_bf16 v[20:23], v[76:79], v[156:159], v[20:23]
  ds_read_b64_tr_b16 v[118:119], v10 offset:3168
  v_mfma_f32_16x16x32_bf16 v[24:27], v[80:83], v[156:159], v[24:27]
  ds_read_b64_tr_b16 v[120:121], v10 offset:3208
  v_mfma_f32_16x16x32_bf16 v[28:31], v[84:87], v[156:159], v[28:31]
  ds_read_b64_tr_b16 v[122:123], v10 offset:3200
  v_mfma_f32_16x16x32_bf16 v[32:35], v[96:99], v[152:155], v[32:35]
  ds_read_b64_tr_b16 v[124:125], v10 offset:3240
  v_mfma_f32_16x16x32_bf16 v[36:39], v[100:103], v[152:155], v[36:39]
  ds_read_b64_tr_b16 v[126:127], v10 offset:3232
  v_mfma_f32_16x16x32_bf16 v[40:43], v[104:107], v[152:155], v[40:43]
  v_mfma_f32_16x16x32_bf16 v[44:47], v[108:111], v[152:155], v[44:47]
  v_mfma_f32_16x16x32_bf16 v[32:35], v[88:91], v[156:159], v[32:35]
  v_mfma_f32_16x16x32_bf16 v[36:39], v[92:95], v[156:159], v[36:39]
  v_mfma_f32_16x16x32_bf16 v[40:43], v[96:99], v[156:159], v[40:43]
  v_mfma_f32_16x16x32_bf16 v[44:47], v[100:103], v[156:159], v[44:47]
  s_waitcnt lgkmcnt(0)
  v_mfma_f32_16x16x32_bf16 v[32:35], v[56:59], v[128:131], v[32:35]
  ds_read_b64_tr_b16 v[72:73], v10 offset:1224
  ds_read_b64_tr_b16 v[74:75], v10 offset:1216
  v_mfma_f32_16x16x32_bf16 v[36:39], v[60:63], v[128:131], v[36:39]
  ds_read_b64_tr_b16 v[76:77], v10 offset:1256
  ds_read_b64_tr_b16 v[78:79], v10 offset:1248
  v_mfma_f32_16x16x32_bf16 v[40:43], v[64:67], v[128:131], v[40:43]
  ds_read_b64_tr_b16 v[80:81], v10 offset:1288
  v_mfma_f32_16x16x32_bf16 v[44:47], v[68:71], v[128:131], v[44:47]
  ds_read_b64_tr_b16 v[82:83], v10 offset:1280
  v_mfma_f32_16x16x32_bf16 v[32:35], v[48:51], v[132:135], v[32:35]
  ds_read_b64_tr_b16 v[84:85], v10 offset:1320
  v_mfma_f32_16x16x32_bf16 v[36:39], v[52:55], v[132:135], v[36:39]
  ds_read_b64_tr_b16 v[86:87], v10 offset:1312
  v_mfma_f32_16x16x32_bf16 v[40:43], v[56:59], v[132:135], v[40:43]
  ds_read_b128 v[144:147], v11 offset:3520
  v_mfma_f32_16x16x32_bf16 v[44:47], v[60:63], v[132:135], v[44:47]
  ds_read_b128 v[152:155], v11 offset:960
  v_mfma_f32_16x16x32_bf16 v[16:19], v[56:59], v[136:139], v[16:19]
  ds_read_b128 v[148:151], v11 offset:3584
  v_mfma_f32_16x16x32_bf16 v[20:23], v[60:63], v[136:139], v[20:23]
  ds_read_b128 v[156:159], v11 offset:1024
  v_mfma_f32_16x16x32_bf16 v[24:27], v[64:67], v[136:139], v[24:27]
  ds_read_b64_tr_b16 v[88:89], v10 offset:3272
  v_mfma_f32_16x16x32_bf16 v[28:31], v[68:71], v[136:139], v[28:31]
  ds_read_b64_tr_b16 v[90:91], v10 offset:3264
  v_mfma_f32_16x16x32_bf16 v[16:19], v[48:51], v[140:143], v[16:19]
  ds_read_b64_tr_b16 v[92:93], v10 offset:3304
  v_mfma_f32_16x16x32_bf16 v[20:23], v[52:55], v[140:143], v[20:23]
  ds_read_b64_tr_b16 v[94:95], v10 offset:3296
  v_mfma_f32_16x16x32_bf16 v[24:27], v[56:59], v[140:143], v[24:27]
  ds_read_b64_tr_b16 v[96:97], v10 offset:3336
  v_mfma_f32_16x16x32_bf16 v[28:31], v[60:63], v[140:143], v[28:31]
  ds_read_b64_tr_b16 v[98:99], v10 offset:3328
  v_mfma_f32_16x16x32_bf16 v[32:35], v[112:115], v[136:139], v[32:35]
  ds_read_b64_tr_b16 v[100:101], v10 offset:3368
  v_mfma_f32_16x16x32_bf16 v[36:39], v[116:119], v[136:139], v[36:39]
  ds_read_b64_tr_b16 v[102:103], v10 offset:3360
  v_mfma_f32_16x16x32_bf16 v[40:43], v[120:123], v[136:139], v[40:43]
  v_mfma_f32_16x16x32_bf16 v[44:47], v[124:127], v[136:139], v[44:47]
  v_mfma_f32_16x16x32_bf16 v[32:35], v[104:107], v[140:143], v[32:35]
  v_mfma_f32_16x16x32_bf16 v[36:39], v[108:111], v[140:143], v[36:39]
  v_mfma_f32_16x16x32_bf16 v[40:43], v[112:115], v[140:143], v[40:43]
  v_mfma_f32_16x16x32_bf16 v[44:47], v[116:119], v[140:143], v[44:47]
  s_waitcnt lgkmcnt(0)
  v_mfma_f32_16x16x32_bf16 v[32:35], v[72:75], v[144:147], v[32:35]
  ds_read_b64_tr_b16 v[48:49], v10 offset:1352
  ds_read_b64_tr_b16 v[50:51], v10 offset:1344
  v_mfma_f32_16x16x32_bf16 v[36:39], v[76:79], v[144:147], v[36:39]
  ds_read_b64_tr_b16 v[52:53], v10 offset:1384
  ds_read_b64_tr_b16 v[54:55], v10 offset:1376
  v_mfma_f32_16x16x32_bf16 v[40:43], v[80:83], v[144:147], v[40:43]
  ds_read_b64_tr_b16 v[56:57], v10 offset:1416
  v_mfma_f32_16x16x32_bf16 v[44:47], v[84:87], v[144:147], v[44:47]
  ds_read_b64_tr_b16 v[58:59], v10 offset:1408
  v_mfma_f32_16x16x32_bf16 v[32:35], v[64:67], v[148:151], v[32:35]
  ds_read_b64_tr_b16 v[60:61], v10 offset:1448
  v_mfma_f32_16x16x32_bf16 v[36:39], v[68:71], v[148:151], v[36:39]
  ds_read_b64_tr_b16 v[62:63], v10 offset:1440
  v_mfma_f32_16x16x32_bf16 v[40:43], v[72:75], v[148:151], v[40:43]
  ds_read_b128 v[128:131], v11 offset:3360
  v_mfma_f32_16x16x32_bf16 v[44:47], v[76:79], v[148:151], v[44:47]
  ds_read_b128 v[136:139], v11 offset:800
  v_mfma_f32_16x16x32_bf16 v[16:19], v[72:75], v[152:155], v[16:19]
  ds_read_b128 v[132:135], v11 offset:3424
  v_mfma_f32_16x16x32_bf16 v[20:23], v[76:79], v[152:155], v[20:23]
  ds_read_b128 v[140:143], v11 offset:864
  v_mfma_f32_16x16x32_bf16 v[24:27], v[80:83], v[152:155], v[24:27]
  ds_read_b64_tr_b16 v[104:105], v10 offset:3400
  v_mfma_f32_16x16x32_bf16 v[28:31], v[84:87], v[152:155], v[28:31]
  ds_read_b64_tr_b16 v[106:107], v10 offset:3392
  v_mfma_f32_16x16x32_bf16 v[16:19], v[64:67], v[156:159], v[16:19]
  ds_read_b64_tr_b16 v[108:109], v10 offset:3432
  v_mfma_f32_16x16x32_bf16 v[20:23], v[68:71], v[156:159], v[20:23]
  ds_read_b64_tr_b16 v[110:111], v10 offset:3424
  v_mfma_f32_16x16x32_bf16 v[24:27], v[72:75], v[156:159], v[24:27]
  ds_read_b64_tr_b16 v[112:113], v10 offset:3464
  v_mfma_f32_16x16x32_bf16 v[28:31], v[76:79], v[156:159], v[28:31]
  ds_read_b64_tr_b16 v[114:115], v10 offset:3456
  v_mfma_f32_16x16x32_bf16 v[32:35], v[88:91], v[152:155], v[32:35]
  ds_read_b64_tr_b16 v[116:117], v10 offset:3496
  v_mfma_f32_16x16x32_bf16 v[36:39], v[92:95], v[152:155], v[36:39]
  ds_read_b64_tr_b16 v[118:119], v10 offset:3488
  v_mfma_f32_16x16x32_bf16 v[40:43], v[96:99], v[152:155], v[40:43]
  v_mfma_f32_16x16x32_bf16 v[44:47], v[100:103], v[152:155], v[44:47]
  v_mfma_f32_16x16x32_bf16 v[32:35], v[120:123], v[156:159], v[32:35]
  v_mfma_f32_16x16x32_bf16 v[36:39], v[124:127], v[156:159], v[36:39]
  v_mfma_f32_16x16x32_bf16 v[40:43], v[88:91], v[156:159], v[40:43]
  v_mfma_f32_16x16x32_bf16 v[44:47], v[92:95], v[156:159], v[44:47]
  s_waitcnt lgkmcnt(0)
  v_mfma_f32_16x16x32_bf16 v[32:35], v[48:51], v[128:131], v[32:35]
  ds_read_b64_tr_b16 v[64:65], v10 offset:1480
  ds_read_b64_tr_b16 v[66:67], v10 offset:1472
  v_mfma_f32_16x16x32_bf16 v[36:39], v[52:55], v[128:131], v[36:39]
  ds_read_b64_tr_b16 v[68:69], v10 offset:1512
  ds_read_b64_tr_b16 v[70:71], v10 offset:1504
  v_mfma_f32_16x16x32_bf16 v[40:43], v[56:59], v[128:131], v[40:43]
  ds_read_b64_tr_b16 v[72:73], v10 offset:1544
  v_mfma_f32_16x16x32_bf16 v[44:47], v[60:63], v[128:131], v[44:47]
  ds_read_b64_tr_b16 v[74:75], v10 offset:1536
  v_mfma_f32_16x16x32_bf16 v[32:35], v[80:83], v[132:135], v[32:35]
  ds_read_b64_tr_b16 v[76:77], v10 offset:1576
  v_mfma_f32_16x16x32_bf16 v[36:39], v[84:87], v[132:135], v[36:39]
  ds_read_b64_tr_b16 v[78:79], v10 offset:1568
  v_mfma_f32_16x16x32_bf16 v[40:43], v[48:51], v[132:135], v[40:43]
  ds_read_b128 v[144:147], v11 offset:3200
  v_mfma_f32_16x16x32_bf16 v[44:47], v[52:55], v[132:135], v[44:47]
  ds_read_b128 v[152:155], v11 offset:640
  v_mfma_f32_16x16x32_bf16 v[16:19], v[48:51], v[136:139], v[16:19]
  ds_read_b128 v[148:151], v11 offset:3264
  v_mfma_f32_16x16x32_bf16 v[20:23], v[52:55], v[136:139], v[20:23]
  ds_read_b128 v[156:159], v11 offset:704
  v_mfma_f32_16x16x32_bf16 v[24:27], v[56:59], v[136:139], v[24:27]
  ds_read_b64_tr_b16 v[120:121], v10 offset:3528
  v_mfma_f32_16x16x32_bf16 v[28:31], v[60:63], v[136:139], v[28:31]
  ds_read_b64_tr_b16 v[122:123], v10 offset:3520
  v_mfma_f32_16x16x32_bf16 v[16:19], v[80:83], v[140:143], v[16:19]
  ds_read_b64_tr_b16 v[124:125], v10 offset:3560
  v_mfma_f32_16x16x32_bf16 v[20:23], v[84:87], v[140:143], v[20:23]
  ds_read_b64_tr_b16 v[126:127], v10 offset:3552
  v_mfma_f32_16x16x32_bf16 v[24:27], v[48:51], v[140:143], v[24:27]
  ds_read_b64_tr_b16 v[88:89], v10 offset:3592
  v_mfma_f32_16x16x32_bf16 v[28:31], v[52:55], v[140:143], v[28:31]
  ds_read_b64_tr_b16 v[90:91], v10 offset:3584
  v_mfma_f32_16x16x32_bf16 v[32:35], v[104:107], v[136:139], v[32:35]
  ds_read_b64_tr_b16 v[92:93], v10 offset:3624
  v_mfma_f32_16x16x32_bf16 v[36:39], v[108:111], v[136:139], v[36:39]
  ds_read_b64_tr_b16 v[94:95], v10 offset:3616
  v_mfma_f32_16x16x32_bf16 v[40:43], v[112:115], v[136:139], v[40:43]
  v_mfma_f32_16x16x32_bf16 v[44:47], v[116:119], v[136:139], v[44:47]
  v_mfma_f32_16x16x32_bf16 v[32:35], v[96:99], v[140:143], v[32:35]
  v_mfma_f32_16x16x32_bf16 v[36:39], v[100:103], v[140:143], v[36:39]
  v_mfma_f32_16x16x32_bf16 v[40:43], v[104:107], v[140:143], v[40:43]
  v_mfma_f32_16x16x32_bf16 v[44:47], v[108:111], v[140:143], v[44:47]
  s_waitcnt lgkmcnt(0)
  v_mfma_f32_16x16x32_bf16 v[32:35], v[64:67], v[144:147], v[32:35]
  ds_read_b64_tr_b16 v[80:81], v10 offset:1608
  ds_read_b64_tr_b16 v[82:83], v10 offset:1600
  v_mfma_f32_16x16x32_bf16 v[36:39], v[68:71], v[144:147], v[36:39]
  ds_read_b64_tr_b16 v[84:85], v10 offset:1640
  ds_read_b64_tr_b16 v[86:87], v10 offset:1632
  v_mfma_f32_16x16x32_bf16 v[40:43], v[72:75], v[144:147], v[40:43]
  ds_read_b64_tr_b16 v[48:49], v10 offset:1672
  v_mfma_f32_16x16x32_bf16 v[44:47], v[76:79], v[144:147], v[44:47]
  ds_read_b64_tr_b16 v[50:51], v10 offset:1664
  v_mfma_f32_16x16x32_bf16 v[32:35], v[56:59], v[148:151], v[32:35]
  ds_read_b64_tr_b16 v[52:53], v10 offset:1704
  v_mfma_f32_16x16x32_bf16 v[36:39], v[60:63], v[148:151], v[36:39]
  ds_read_b64_tr_b16 v[54:55], v10 offset:1696
  v_mfma_f32_16x16x32_bf16 v[40:43], v[64:67], v[148:151], v[40:43]
  ds_read_b128 v[128:131], v11 offset:3040
  v_mfma_f32_16x16x32_bf16 v[44:47], v[68:71], v[148:151], v[44:47]
  ds_read_b128 v[136:139], v11 offset:480
  v_mfma_f32_16x16x32_bf16 v[16:19], v[64:67], v[152:155], v[16:19]
  ds_read_b128 v[132:135], v11 offset:3104
  v_mfma_f32_16x16x32_bf16 v[20:23], v[68:71], v[152:155], v[20:23]
  ds_read_b128 v[140:143], v11 offset:544
  v_mfma_f32_16x16x32_bf16 v[24:27], v[72:75], v[152:155], v[24:27]
  ds_read_b64_tr_b16 v[96:97], v10 offset:3656
  v_mfma_f32_16x16x32_bf16 v[28:31], v[76:79], v[152:155], v[28:31]
  ds_read_b64_tr_b16 v[98:99], v10 offset:3648
  v_mfma_f32_16x16x32_bf16 v[16:19], v[56:59], v[156:159], v[16:19]
  ds_read_b64_tr_b16 v[100:101], v10 offset:3688
  v_mfma_f32_16x16x32_bf16 v[20:23], v[60:63], v[156:159], v[20:23]
  ds_read_b64_tr_b16 v[102:103], v10 offset:3680
  v_mfma_f32_16x16x32_bf16 v[24:27], v[64:67], v[156:159], v[24:27]
  ds_read_b64_tr_b16 v[104:105], v10 offset:3720
  v_mfma_f32_16x16x32_bf16 v[28:31], v[68:71], v[156:159], v[28:31]
  ds_read_b64_tr_b16 v[106:107], v10 offset:3712
  v_mfma_f32_16x16x32_bf16 v[32:35], v[120:123], v[152:155], v[32:35]
  ds_read_b64_tr_b16 v[108:109], v10 offset:3752
  v_mfma_f32_16x16x32_bf16 v[36:39], v[124:127], v[152:155], v[36:39]
  ds_read_b64_tr_b16 v[110:111], v10 offset:3744
  v_mfma_f32_16x16x32_bf16 v[40:43], v[88:91], v[152:155], v[40:43]
  v_mfma_f32_16x16x32_bf16 v[44:47], v[92:95], v[152:155], v[44:47]
  v_mfma_f32_16x16x32_bf16 v[32:35], v[112:115], v[156:159], v[32:35]
  v_mfma_f32_16x16x32_bf16 v[36:39], v[116:119], v[156:159], v[36:39]
  v_mfma_f32_16x16x32_bf16 v[40:43], v[120:123], v[156:159], v[40:43]
  v_mfma_f32_16x16x32_bf16 v[44:47], v[124:127], v[156:159], v[44:47]
  s_waitcnt lgkmcnt(0)
  v_mfma_f32_16x16x32_bf16 v[32:35], v[80:83], v[128:131], v[32:35]
  ds_read_b64_tr_b16 v[56:57], v10 offset:1736
  ds_read_b64_tr_b16 v[58:59], v10 offset:1728
  v_mfma_f32_16x16x32_bf16 v[36:39], v[84:87], v[128:131], v[36:39]
  ds_read_b64_tr_b16 v[60:61], v10 offset:1768
  ds_read_b64_tr_b16 v[62:63], v10 offset:1760
  v_mfma_f32_16x16x32_bf16 v[40:43], v[48:51], v[128:131], v[40:43]
  ds_read_b64_tr_b16 v[64:65], v10 offset:1800
  v_mfma_f32_16x16x32_bf16 v[44:47], v[52:55], v[128:131], v[44:47]
  ds_read_b64_tr_b16 v[66:67], v10 offset:1792
  v_mfma_f32_16x16x32_bf16 v[32:35], v[72:75], v[132:135], v[32:35]
  ds_read_b64_tr_b16 v[68:69], v10 offset:1832
  v_mfma_f32_16x16x32_bf16 v[36:39], v[76:79], v[132:135], v[36:39]
  ds_read_b64_tr_b16 v[70:71], v10 offset:1824
  v_mfma_f32_16x16x32_bf16 v[40:43], v[80:83], v[132:135], v[40:43]
  ds_read_b128 v[144:147], v11 offset:2880
  v_mfma_f32_16x16x32_bf16 v[44:47], v[84:87], v[132:135], v[44:47]
  ds_read_b128 v[152:155], v11 offset:320
  v_mfma_f32_16x16x32_bf16 v[16:19], v[80:83], v[136:139], v[16:19]
  ds_read_b128 v[148:151], v11 offset:2944
  v_mfma_f32_16x16x32_bf16 v[20:23], v[84:87], v[136:139], v[20:23]
  ds_read_b128 v[156:159], v11 offset:384
  v_mfma_f32_16x16x32_bf16 v[24:27], v[48:51], v[136:139], v[24:27]
  ds_read_b64_tr_b16 v[112:113], v10 offset:3784
  v_mfma_f32_16x16x32_bf16 v[28:31], v[52:55], v[136:139], v[28:31]
  ds_read_b64_tr_b16 v[114:115], v10 offset:3776
  v_mfma_f32_16x16x32_bf16 v[16:19], v[72:75], v[140:143], v[16:19]
  ds_read_b64_tr_b16 v[116:117], v10 offset:3816
  v_mfma_f32_16x16x32_bf16 v[20:23], v[76:79], v[140:143], v[20:23]
  ds_read_b64_tr_b16 v[118:119], v10 offset:3808
  v_mfma_f32_16x16x32_bf16 v[24:27], v[80:83], v[140:143], v[24:27]
  ds_read_b64_tr_b16 v[120:121], v10 offset:3848
  v_mfma_f32_16x16x32_bf16 v[28:31], v[84:87], v[140:143], v[28:31]
  ds_read_b64_tr_b16 v[122:123], v10 offset:3840
  v_mfma_f32_16x16x32_bf16 v[32:35], v[96:99], v[136:139], v[32:35]
  ds_read_b64_tr_b16 v[124:125], v10 offset:3880
  v_mfma_f32_16x16x32_bf16 v[36:39], v[100:103], v[136:139], v[36:39]
  ds_read_b64_tr_b16 v[126:127], v10 offset:3872
  v_mfma_f32_16x16x32_bf16 v[40:43], v[104:107], v[136:139], v[40:43]
  v_mfma_f32_16x16x32_bf16 v[44:47], v[108:111], v[136:139], v[44:47]
  v_mfma_f32_16x16x32_bf16 v[32:35], v[88:91], v[140:143], v[32:35]
  v_mfma_f32_16x16x32_bf16 v[36:39], v[92:95], v[140:143], v[36:39]
  v_mfma_f32_16x16x32_bf16 v[40:43], v[96:99], v[140:143], v[40:43]
  v_mfma_f32_16x16x32_bf16 v[44:47], v[100:103], v[140:143], v[44:47]
  s_waitcnt lgkmcnt(0)
  v_mfma_f32_16x16x32_bf16 v[32:35], v[56:59], v[144:147], v[32:35]
  ds_read_b64_tr_b16 v[72:73], v10 offset:1864
  ds_read_b64_tr_b16 v[74:75], v10 offset:1856
  v_mfma_f32_16x16x32_bf16 v[36:39], v[60:63], v[144:147], v[36:39]
  ds_read_b64_tr_b16 v[76:77], v10 offset:1896
  ds_read_b64_tr_b16 v[78:79], v10 offset:1888
  v_mfma_f32_16x16x32_bf16 v[40:43], v[64:67], v[144:147], v[40:43]
  ds_read_b64_tr_b16 v[80:81], v10 offset:1928
  v_mfma_f32_16x16x32_bf16 v[44:47], v[68:71], v[144:147], v[44:47]
  ds_read_b64_tr_b16 v[82:83], v10 offset:1920
  v_mfma_f32_16x16x32_bf16 v[32:35], v[48:51], v[148:151], v[32:35]
  ds_read_b64_tr_b16 v[84:85], v10 offset:1960
  v_mfma_f32_16x16x32_bf16 v[36:39], v[52:55], v[148:151], v[36:39]
  ds_read_b64_tr_b16 v[86:87], v10 offset:1952
  v_mfma_f32_16x16x32_bf16 v[40:43], v[56:59], v[148:151], v[40:43]
  ds_read_b128 v[128:131], v11 offset:2720
  v_mfma_f32_16x16x32_bf16 v[44:47], v[60:63], v[148:151], v[44:47]
  ds_read_b128 v[136:139], v11 offset:160
  v_mfma_f32_16x16x32_bf16 v[16:19], v[56:59], v[152:155], v[16:19]
  ds_read_b128 v[132:135], v11 offset:2784
  v_mfma_f32_16x16x32_bf16 v[20:23], v[60:63], v[152:155], v[20:23]
  ds_read_b128 v[140:143], v11 offset:224
  v_mfma_f32_16x16x32_bf16 v[24:27], v[64:67], v[152:155], v[24:27]
  ds_read_b64_tr_b16 v[88:89], v10 offset:3912
  v_mfma_f32_16x16x32_bf16 v[28:31], v[68:71], v[152:155], v[28:31]
  ds_read_b64_tr_b16 v[90:91], v10 offset:3904
  v_mfma_f32_16x16x32_bf16 v[16:19], v[48:51], v[156:159], v[16:19]
  ds_read_b64_tr_b16 v[92:93], v10 offset:3944
  v_mfma_f32_16x16x32_bf16 v[20:23], v[52:55], v[156:159], v[20:23]
  ds_read_b64_tr_b16 v[94:95], v10 offset:3936
  v_mfma_f32_16x16x32_bf16 v[24:27], v[56:59], v[156:159], v[24:27]
  ds_read_b64_tr_b16 v[96:97], v10 offset:3976
  v_mfma_f32_16x16x32_bf16 v[28:31], v[60:63], v[156:159], v[28:31]
  ds_read_b64_tr_b16 v[98:99], v10 offset:3968
  v_mfma_f32_16x16x32_bf16 v[32:35], v[112:115], v[152:155], v[32:35]
  ds_read_b64_tr_b16 v[100:101], v10 offset:4008
  v_mfma_f32_16x16x32_bf16 v[36:39], v[116:119], v[152:155], v[36:39]
  ds_read_b64_tr_b16 v[102:103], v10 offset:4000
  v_mfma_f32_16x16x32_bf16 v[40:43], v[120:123], v[152:155], v[40:43]
  v_mfma_f32_16x16x32_bf16 v[44:47], v[124:127], v[152:155], v[44:47]
  v_mfma_f32_16x16x32_bf16 v[32:35], v[104:107], v[156:159], v[32:35]
  v_mfma_f32_16x16x32_bf16 v[36:39], v[108:111], v[156:159], v[36:39]
  v_mfma_f32_16x16x32_bf16 v[40:43], v[112:115], v[156:159], v[40:43]
  v_mfma_f32_16x16x32_bf16 v[44:47], v[116:119], v[156:159], v[44:47]
  s_waitcnt lgkmcnt(0)
  v_mfma_f32_16x16x32_bf16 v[32:35], v[72:75], v[128:131], v[32:35]
  ds_read_b64_tr_b16 v[48:49], v10 offset:1992
  ds_read_b64_tr_b16 v[50:51], v10 offset:1984
  v_mfma_f32_16x16x32_bf16 v[36:39], v[76:79], v[128:131], v[36:39]
  ds_read_b64_tr_b16 v[52:53], v10 offset:2024
  ds_read_b64_tr_b16 v[54:55], v10 offset:2016
  v_mfma_f32_16x16x32_bf16 v[40:43], v[80:83], v[128:131], v[40:43]
  ds_read_b64_tr_b16 v[56:57], v10 offset:2056
  v_mfma_f32_16x16x32_bf16 v[44:47], v[84:87], v[128:131], v[44:47]
  ds_read_b64_tr_b16 v[58:59], v10 offset:2048
  v_mfma_f32_16x16x32_bf16 v[32:35], v[64:67], v[132:135], v[32:35]
  ds_read_b64_tr_b16 v[60:61], v10 offset:2088
  v_mfma_f32_16x16x32_bf16 v[36:39], v[68:71], v[132:135], v[36:39]
  ds_read_b64_tr_b16 v[62:63], v10 offset:2080
  v_mfma_f32_16x16x32_bf16 v[40:43], v[72:75], v[132:135], v[40:43]
  ds_read_b128 v[144:147], v11 offset:2560
  v_mfma_f32_16x16x32_bf16 v[44:47], v[76:79], v[132:135], v[44:47]
  ds_read_b128 v[152:155], v11 offset:0
  v_mfma_f32_16x16x32_bf16 v[16:19], v[72:75], v[136:139], v[16:19]
  ds_read_b128 v[148:151], v11 offset:2624
  v_mfma_f32_16x16x32_bf16 v[20:23], v[76:79], v[136:139], v[20:23]
  ds_read_b128 v[156:159], v11 offset:64
  v_mfma_f32_16x16x32_bf16 v[24:27], v[80:83], v[136:139], v[24:27]
  ds_read_b64_tr_b16 v[104:105], v10 offset:4040
  v_mfma_f32_16x16x32_bf16 v[28:31], v[84:87], v[136:139], v[28:31]
  ds_read_b64_tr_b16 v[106:107], v10 offset:4032
  v_mfma_f32_16x16x32_bf16 v[16:19], v[64:67], v[140:143], v[16:19]
  ds_read_b64_tr_b16 v[108:109], v10 offset:4072
  v_mfma_f32_16x16x32_bf16 v[20:23], v[68:71], v[140:143], v[20:23]
  ds_read_b64_tr_b16 v[110:111], v10 offset:4064
  v_mfma_f32_16x16x32_bf16 v[24:27], v[72:75], v[140:143], v[24:27]
  ds_read_b64_tr_b16 v[112:113], v10 offset:4104
  v_mfma_f32_16x16x32_bf16 v[28:31], v[76:79], v[140:143], v[28:31]
  ds_read_b64_tr_b16 v[114:115], v10 offset:4096
  v_mfma_f32_16x16x32_bf16 v[32:35], v[88:91], v[136:139], v[32:35]
  ds_read_b64_tr_b16 v[116:117], v10 offset:4136
  v_mfma_f32_16x16x32_bf16 v[36:39], v[92:95], v[136:139], v[36:39]
  ds_read_b64_tr_b16 v[118:119], v10 offset:4128
  v_mfma_f32_16x16x32_bf16 v[40:43], v[96:99], v[136:139], v[40:43]
  v_mfma_f32_16x16x32_bf16 v[44:47], v[100:103], v[136:139], v[44:47]
  v_mfma_f32_16x16x32_bf16 v[32:35], v[120:123], v[140:143], v[32:35]
  v_mfma_f32_16x16x32_bf16 v[36:39], v[124:127], v[140:143], v[36:39]
  v_mfma_f32_16x16x32_bf16 v[40:43], v[88:91], v[140:143], v[40:43]
  v_mfma_f32_16x16x32_bf16 v[44:47], v[92:95], v[140:143], v[44:47]
  s_waitcnt lgkmcnt(0)
  s_waitcnt vmcnt(0)
  v_mfma_f32_16x16x32_bf16 v[16:19], v[48:51], v[152:155], v[16:19]
  ds_read_b64 v[202:203], v12 offset:0
  ds_read_b64 v[204:205], v12 offset:32
  v_mfma_f32_16x16x32_bf16 v[20:23], v[52:55], v[152:155], v[20:23]
  ds_read_b64 v[206:207], v12 offset:64
  ds_read_b64 v[208:209], v12 offset:96
  v_mfma_f32_16x16x32_bf16 v[24:27], v[56:59], v[152:155], v[24:27]
  ds_read_b64 v[210:211], v12 offset:2560
  v_perm_b32 v192, v164, v160, s46
  v_mfma_f32_16x16x32_bf16 v[28:31], v[60:63], v[152:155], v[28:31]
  ds_read_b64 v[212:213], v12 offset:2592
  v_perm_b32 v193, v172, v168, s46
  v_mfma_f32_16x16x32_bf16 v[16:19], v[80:83], v[156:159], v[16:19]
  ds_read_b64 v[214:215], v12 offset:2624
  v_perm_b32 v194, v180, v176, s46
  v_mfma_f32_16x16x32_bf16 v[20:23], v[84:87], v[156:159], v[20:23]
  ds_read_b64 v[216:217], v12 offset:2656
  v_perm_b32 v195, v188, v184, s46
  v_mfma_f32_16x16x32_bf16 v[24:27], v[48:51], v[156:159], v[24:27]
  s_mov_b32 s56, 0
  buffer_store_dwordx4 v[192:195], v201, s[52:55], s56 offen sc1
  v_mfma_f32_16x16x32_bf16 v[28:31], v[52:55], v[156:159], v[28:31]
  v_perm_b32 v196, v164, v160, s47
  v_perm_b32 v197, v172, v168, s47
  v_mfma_f32_16x16x32_bf16 v[32:35], v[48:51], v[144:147], v[32:35]
  v_perm_b32 v198, v180, v176, s47
  v_perm_b32 v199, v188, v184, s47
  v_mfma_f32_16x16x32_bf16 v[36:39], v[52:55], v[144:147], v[36:39]
  s_mov_b32 s56, 36864
  buffer_store_dwordx4 v[196:199], v201, s[52:55], s56 offen sc1
  v_mfma_f32_16x16x32_bf16 v[40:43], v[56:59], v[144:147], v[40:43]
  v_perm_b32 v192, v165, v161, s46
  v_perm_b32 v193, v173, v169, s46
  v_mfma_f32_16x16x32_bf16 v[44:47], v[60:63], v[144:147], v[44:47]
  v_perm_b32 v194, v181, v177, s46
  v_perm_b32 v195, v189, v185, s46
  v_mfma_f32_16x16x32_bf16 v[32:35], v[80:83], v[148:151], v[32:35]
  s_mov_b32 s56, 73728
  buffer_store_dwordx4 v[192:195], v201, s[52:55], s56 offen sc1
  v_mfma_f32_16x16x32_bf16 v[36:39], v[84:87], v[148:151], v[36:39]
  v_perm_b32 v196, v165, v161, s47
  v_perm_b32 v197, v173, v169, s47
  v_mfma_f32_16x16x32_bf16 v[40:43], v[48:51], v[148:151], v[40:43]
  v_perm_b32 v198, v181, v177, s47
  v_perm_b32 v199, v189, v185, s47
  v_mfma_f32_16x16x32_bf16 v[44:47], v[52:55], v[148:151], v[44:47]
  s_mov_b32 s56, 110592
  buffer_store_dwordx4 v[196:199], v201, s[52:55], s56 offen sc1
  v_mfma_f32_16x16x32_bf16 v[32:35], v[104:107], v[152:155], v[32:35]
  v_perm_b32 v192, v166, v162, s46
  v_perm_b32 v193, v174, v170, s46
  v_mfma_f32_16x16x32_bf16 v[36:39], v[108:111], v[152:155], v[36:39]
  v_perm_b32 v194, v182, v178, s46
  v_perm_b32 v195, v190, v186, s46
  v_mfma_f32_16x16x32_bf16 v[40:43], v[112:115], v[152:155], v[40:43]
  s_mov_b32 s56, 147456
  buffer_store_dwordx4 v[192:195], v201, s[52:55], s56 offen sc1
  v_mfma_f32_16x16x32_bf16 v[44:47], v[116:119], v[152:155], v[44:47]
  v_perm_b32 v196, v166, v162, s47
  v_perm_b32 v197, v174, v170, s47
  v_mfma_f32_16x16x32_bf16 v[32:35], v[96:99], v[156:159], v[32:35]
  v_perm_b32 v198, v182, v178, s47
  v_perm_b32 v199, v190, v186, s47
  v_mfma_f32_16x16x32_bf16 v[36:39], v[100:103], v[156:159], v[36:39]
  s_mov_b32 s56, 184320
  buffer_store_dwordx4 v[196:199], v201, s[52:55], s56 offen sc1
  v_mfma_f32_16x16x32_bf16 v[40:43], v[104:107], v[156:159], v[40:43]
  v_perm_b32 v192, v167, v163, s46
  v_perm_b32 v193, v175, v171, s46
  v_mfma_f32_16x16x32_bf16 v[44:47], v[108:111], v[156:159], v[44:47]
  v_perm_b32 v194, v183, v179, s46
  v_perm_b32 v195, v191, v187, s46
  s_mov_b32 s56, 221184
  buffer_store_dwordx4 v[192:195], v201, s[52:55], s56 offen sc1
  v_perm_b32 v196, v167, v163, s47
  v_perm_b32 v197, v175, v171, s47
  v_perm_b32 v198, v183, v179, s47
  v_perm_b32 v199, v191, v187, s47
  s_mov_b32 s56, 258048
  buffer_store_dwordx4 v[196:199], v201, s[52:55], s56 offen sc1
  v_lshlrev_b32 v13, 16, v2
  s_waitcnt lgkmcnt(0)
  v_lshlrev_b32 v96, 16, v202
  v_and_b32 v97, 0xffff0000, v202
  v_lshlrev_b32 v98, 16, v203
  v_and_b32 v99, 0xffff0000, v203
  v_lshlrev_b32 v100, 16, v204
  v_and_b32 v101, 0xffff0000, v204
  v_lshlrev_b32 v102, 16, v205
  v_and_b32 v103, 0xffff0000, v205
  v_fma_f32 v96, v96, v13, v16
  v_fma_f32 v97, v97, v13, v17
  v_fma_f32 v98, v98, v13, v18
  v_fma_f32 v99, v99, v13, v19
  v_fma_f32 v100, v100, v13, v20
  v_fma_f32 v101, v101, v13, v21
  v_fma_f32 v102, v102, v13, v22
  v_fma_f32 v103, v103, v13, v23
  v_cvt_pk_bf16_f32 v64, v96, v97
  v_cvt_pk_bf16_f32 v65, v98, v99
  v_cvt_pk_bf16_f32 v66, v100, v101
  v_cvt_pk_bf16_f32 v67, v102, v103
  ds_write_b64 v12, v[64:65] offset:0
  ds_write_b64 v12, v[66:67] offset:32
  v_lshlrev_b32 v96, 16, v206
  v_and_b32 v97, 0xffff0000, v206
  v_lshlrev_b32 v98, 16, v207
  v_and_b32 v99, 0xffff0000, v207
  v_lshlrev_b32 v100, 16, v208
  v_and_b32 v101, 0xffff0000, v208
  v_lshlrev_b32 v102, 16, v209
  v_and_b32 v103, 0xffff0000, v209
  v_fma_f32 v96, v96, v13, v24
  v_fma_f32 v97, v97, v13, v25
  v_fma_f32 v98, v98, v13, v26
  v_fma_f32 v99, v99, v13, v27
  v_fma_f32 v100, v100, v13, v28
  v_fma_f32 v101, v101, v13, v29
  v_fma_f32 v102, v102, v13, v30
  v_fma_f32 v103, v103, v13, v31
  v_cvt_pk_bf16_f32 v68, v96, v97
  v_cvt_pk_bf16_f32 v69, v98, v99
  v_cvt_pk_bf16_f32 v70, v100, v101
  v_cvt_pk_bf16_f32 v71, v102, v103
  ds_write_b64 v12, v[68:69] offset:64
  ds_write_b64 v12, v[70:71] offset:96
  v_lshlrev_b32 v96, 16, v210
  v_and_b32 v97, 0xffff0000, v210
  v_lshlrev_b32 v98, 16, v211
  v_and_b32 v99, 0xffff0000, v211
  v_lshlrev_b32 v100, 16, v212
  v_and_b32 v101, 0xffff0000, v212
  v_lshlrev_b32 v102, 16, v213
  v_and_b32 v103, 0xffff0000, v213
  v_fma_f32 v96, v96, v13, v32
  v_fma_f32 v97, v97, v13, v33
  v_fma_f32 v98, v98, v13, v34
  v_fma_f32 v99, v99, v13, v35
  v_fma_f32 v100, v100, v13, v36
  v_fma_f32 v101, v101, v13, v37
  v_fma_f32 v102, v102, v13, v38
  v_fma_f32 v103, v103, v13, v39
  v_cvt_pk_bf16_f32 v72, v96, v97
  v_cvt_pk_bf16_f32 v73, v98, v99
  v_cvt_pk_bf16_f32 v74, v100, v101
  v_cvt_pk_bf16_f32 v75, v102, v103
  ds_write_b64 v12, v[72:73] offset:2560
  ds_write_b64 v12, v[74:75] offset:2592
  v_lshlrev_b32 v96, 16, v214
  v_and_b32 v97, 0xffff0000, v214
  v_lshlrev_b32 v98, 16, v215
  v_and_b32 v99, 0xffff0000, v215
  v_lshlrev_b32 v100, 16, v216
  v_and_b32 v101, 0xffff0000, v216
  v_lshlrev_b32 v102, 16, v217
  v_and_b32 v103, 0xffff0000, v217
  v_fma_f32 v96, v96, v13, v40
  v_fma_f32 v97, v97, v13, v41
  v_fma_f32 v98, v98, v13, v42
  v_fma_f32 v99, v99, v13, v43
  v_fma_f32 v100, v100, v13, v44
  v_fma_f32 v101, v101, v13, v45
  v_fma_f32 v102, v102, v13, v46
  v_fma_f32 v103, v103, v13, v47
  v_cvt_pk_bf16_f32 v76, v96, v97
  v_cvt_pk_bf16_f32 v77, v98, v99
  v_cvt_pk_bf16_f32 v78, v100, v101
  v_cvt_pk_bf16_f32 v79, v102, v103
  ds_write_b64 v12, v[76:77] offset:2624
  ds_write_b64 v12, v[78:79] offset:2656
  s_waitcnt lgkmcnt(0)
  s_barrier
  ds_read_b32 v16, v6 offset:0
  ds_read_b32 v17, v6 offset:24704
  ds_read_b32 v18, v7 offset:0
  ds_read_b32 v19, v7 offset:24704
  ds_read_b32 v20, v6 offset:1280
  ds_read_b32 v21, v6 offset:25984
  ds_read_b32 v22, v7 offset:1280
  ds_read_b32 v23, v7 offset:25984
  ds_read_b32 v24, v6 offset:2560
  ds_read_b32 v25, v6 offset:27264
  ds_read_b32 v26, v7 offset:2560
  ds_read_b32 v27, v7 offset:27264
  ds_read_b32 v28, v6 offset:3840
  ds_read_b32 v29, v6 offset:28544
  ds_read_b32 v30, v7 offset:3840
  ds_read_b32 v31, v7 offset:28544
  s_add_u32 s8, s4, 4898816
  s_addc_u32 s9, s5, 0
  s_mov_b32 s10, 2359296
  s_mov_b32 s11, 0x20000
  s_mov_b32 s26, 0x05040100
  s_mov_b32 s27, 0x07060302
  s_waitcnt lgkmcnt(12)
  v_perm_b32 v48, v17, v16, s26
  v_perm_b32 v49, v19, v18, s26
  v_perm_b32 v50, v17, v16, s27
  v_perm_b32 v51, v19, v18, s27
  s_add_u32 s29, s28, 0
  buffer_store_dwordx4 v[48:51], v4, s[8:11], s29 offen sc1
  s_waitcnt lgkmcnt(8)
  v_perm_b32 v52, v21, v20, s26
  v_perm_b32 v53, v23, v22, s26
  v_perm_b32 v54, v21, v20, s27
  v_perm_b32 v55, v23, v22, s27
  s_add_u32 s29, s28, 4096
  buffer_store_dwordx4 v[52:55], v4, s[8:11], s29 offen sc1
  s_waitcnt lgkmcnt(4)
  v_perm_b32 v56, v25, v24, s26
  v_perm_b32 v57, v27, v26, s26
  v_perm_b32 v58, v25, v24, s27
  v_perm_b32 v59, v27, v26, s27
  s_add_u32 s29, s28, 8192
  buffer_store_dwordx4 v[56:59], v4, s[8:11], s29 offen sc1
  s_waitcnt lgkmcnt(0)
  v_perm_b32 v60, v29, v28, s26
  v_perm_b32 v61, v31, v30, s26
  v_perm_b32 v62, v29, v28, s27
  v_perm_b32 v63, v31, v30, s27
  s_add_u32 s29, s28, 12288
  buffer_store_dwordx4 v[60:63], v4, s[8:11], s29 offen sc1
  s_endpgm
K2_W1:
  s_load_dwordx4 s[4:7], s[0:1], 80
  s_load_dwordx2 s[16:17], s[0:1], 136
  v_and_b32 v1, 63, v0
  s_getpc_b64 s[96:97]
PFPC6:
  v_lshlrev_b32 v16, 7, v1
  v_min_u32 v16, K2_END-PFPC6-4, v16
  global_load_dword v150, v16, s[96:97]
  v_lshrrev_b32 v2, 6, v0
  s_lshl_b32 s18, s2, 2
  v_readfirstlane_b32 s3, v2
  s_add_u32 s18, s18, s3
  s_mul_i32 s18, s18, 2
  s_cmp_ge_u32 s18, 648
  s_cselect_b32 s19, 1, 0
  s_mul_i32 s20, s19, 648
  s_sub_u32 s18, s18, s20
  s_mul_i32 s20, s18, 3641
  s_lshr_b32 s20, s20, 16
  s_mul_i32 s21, s20, 18
  s_sub_u32 s21, s18, s21
  v_and_b32 v3, 15, v1
  v_lshrrev_b32 v4, 4, v1
  s_waitcnt lgkmcnt(0)
  s_cmp_eq_u32 s19, 0
  s_cselect_b32 s24, s4, s6
  s_cselect_b32 s25, s5, s7
  s_mov_b32 s8, s24
  s_mov_b32 s9, s25
  s_mov_b32 s10, 5308416
  s_mov_b32 s11, 0x20000
  s_add_u32 s12, s16, 11976704
  s_addc_u32 s13, s17, 0
  s_mov_b32 s14, 10616832
  s_mov_b32 s15, 0x20000
  s_mov_b32 s26, 0x05040100
  s_mov_b32 s27, 0x07060302
  s_lshl_b32 s22, s20, 8
  v_lshl_add_u32 v6, v3, 4, s22
  v_lshlrev_b32 v7, 3, v4
  v_mul_u32_u24 v7, 9216, v7
  v_add_u32 v6, v6, v7
  s_lshl_b32 s23, s19, 10
  s_mul_i32 s22, s20, 294912
  s_add_u32 s22, s22, s23
  v_lshl_add_u32 v8, v1, 4, s22
  s_add_u32 s28, s21, 0
  s_mul_i32 s29, s28, 294912
  v_add_u32 v9, s29, v6
  s_lshl_b32 s29, s28, 11
  v_add_u32 v12, s29, v8
  s_mov_b32 s30, 0
  buffer_load_dwordx4 v[16:19], v9, s[8:11], s30 offen nt
  s_mov_b32 s30, 9216
  buffer_load_dwordx4 v[20:23], v9, s[8:11], s30 offen nt
  s_mov_b32 s30, 18432
  buffer_load_dwordx4 v[24:27], v9, s[8:11], s30 offen nt
  s_mov_b32 s30, 27648
  buffer_load_dwordx4 v[28:31], v9, s[8:11], s30 offen nt
  s_mov_b32 s30, 36864
  buffer_load_dwordx4 v[32:35], v9, s[8:11], s30 offen nt
  s_mov_b32 s30, 46080
  buffer_load_dwordx4 v[36:39], v9, s[8:11], s30 offen nt
  s_mov_b32 s30, 55296
  buffer_load_dwordx4 v[40:43], v9, s[8:11], s30 offen nt
  s_mov_b32 s30, 64512
  buffer_load_dwordx4 v[44:47], v9, s[8:11], s30 offen nt
  s_add_u32 s28, s21, 1
  s_mul_i32 s29, s28, 294912
  v_add_u32 v10, s29, v6
  s_lshl_b32 s29, s28, 11
  v_add_u32 v13, s29, v8
  s_mov_b32 s30, 0
  buffer_load_dwordx4 v[48:51], v10, s[8:11], s30 offen nt
  s_mov_b32 s30, 9216
  buffer_load_dwordx4 v[52:55], v10, s[8:11], s30 offen nt
  s_mov_b32 s30, 18432
  buffer_load_dwordx4 v[56:59], v10, s[8:11], s30 offen nt
  s_mov_b32 s30, 27648
  buffer_load_dwordx4 v[60:63], v10, s[8:11], s30 offen nt
  s_mov_b32 s30, 36864
  buffer_load_dwordx4 v[64:67], v10, s[8:11], s30 offen nt
  s_mov_b32 s30, 46080
  buffer_load_dwordx4 v[68:71], v10, s[8:11], s30 offen nt
  s_mov_b32 s30, 55296
  buffer_load_dwordx4 v[72:75], v10, s[8:11], s30 offen nt
  s_mov_b32 s30, 64512
  buffer_load_dwordx4 v[76:79], v10, s[8:11], s30 offen nt
  s_waitcnt vmcnt(8)
  v_perm_b32 v112, v20, v16, s26
  v_perm_b32 v113, v28, v24, s26
  v_perm_b32 v114, v36, v32, s26
  v_perm_b32 v115, v44, v40, s26
  v_perm_b32 v116, v20, v16, s27
  v_perm_b32 v117, v28, v24, s27
  v_perm_b32 v118, v36, v32, s27
  v_perm_b32 v119, v44, v40, s27
  v_perm_b32 v120, v21, v17, s26
  v_perm_b32 v121, v29, v25, s26
  v_perm_b32 v122, v37, v33, s26
  v_perm_b32 v123, v45, v41, s26
  v_perm_b32 v124, v21, v17, s27
  v_perm_b32 v125, v29, v25, s27
  v_perm_b32 v126, v37, v33, s27
  v_perm_b32 v127, v45, v41, s27
  v_perm_b32 v128, v22, v18, s26
  v_perm_b32 v129, v30, v26, s26
  v_perm_b32 v130, v38, v34, s26
  v_perm_b32 v131, v46, v42, s26
  v_perm_b32 v132, v22, v18, s27
  v_perm_b32 v133, v30, v26, s27
  v_perm_b32 v134, v38, v34, s27
  v_perm_b32 v135, v46, v42, s27
  v_perm_b32 v136, v23, v19, s26
  v_perm_b32 v137, v31, v27, s26
  v_perm_b32 v138, v39, v35, s26
  v_perm_b32 v139, v47, v43, s26
  v_perm_b32 v140, v23, v19, s27
  v_perm_b32 v141, v31, v27, s27
  v_perm_b32 v142, v39, v35, s27
  v_perm_b32 v143, v47, v43, s27
  s_mov_b32 s30, 0
  buffer_store_dwordx4 v[112:115], v12, s[12:15], s30 offen sc1
  s_mov_b32 s30, 36864
  buffer_store_dwordx4 v[116:119], v12, s[12:15], s30 offen sc1
  s_mov_b32 s30, 73728
  buffer_store_dwordx4 v[120:123], v12, s[12:15], s30 offen sc1
  s_mov_b32 s30, 110592
  buffer_store_dwordx4 v[124:127], v12, s[12:15], s30 offen sc1
  s_mov_b32 s30, 147456
  buffer_store_dwordx4 v[128:131], v12, s[12:15], s30 offen sc1
  s_mov_b32 s30, 184320
  buffer_store_dwordx4 v[132:135], v12, s[12:15], s30 offen sc1
  s_mov_b32 s30, 221184
  buffer_store_dwordx4 v[136:139], v12, s[12:15], s30 offen sc1
  s_mov_b32 s30, 258048
  buffer_store_dwordx4 v[140:143], v12, s[12:15], s30 offen sc1
  s_nop 1
  s_waitcnt vmcnt(8)
  v_perm_b32 v112, v52, v48, s26
  v_perm_b32 v113, v60, v56, s26
  v_perm_b32 v114, v68, v64, s26
  v_perm_b32 v115, v76, v72, s26
  v_perm_b32 v116, v52, v48, s27
  v_perm_b32 v117, v60, v56, s27
  v_perm_b32 v118, v68, v64, s27
  v_perm_b32 v119, v76, v72, s27
  v_perm_b32 v120, v53, v49, s26
  v_perm_b32 v121, v61, v57, s26
  v_perm_b32 v122, v69, v65, s26
  v_perm_b32 v123, v77, v73, s26
  v_perm_b32 v124, v53, v49, s27
  v_perm_b32 v125, v61, v57, s27
  v_perm_b32 v126, v69, v65, s27
  v_perm_b32 v127, v77, v73, s27
  v_perm_b32 v128, v54, v50, s26
  v_perm_b32 v129, v62, v58, s26
  v_perm_b32 v130, v70, v66, s26
  v_perm_b32 v131, v78, v74, s26
  v_perm_b32 v132, v54, v50, s27
  v_perm_b32 v133, v62, v58, s27
  v_perm_b32 v134, v70, v66, s27
  v_perm_b32 v135, v78, v74, s27
  v_perm_b32 v136, v55, v51, s26
  v_perm_b32 v137, v63, v59, s26
  v_perm_b32 v138, v71, v67, s26
  v_perm_b32 v139, v79, v75, s26
  v_perm_b32 v140, v55, v51, s27
  v_perm_b32 v141, v63, v59, s27
  v_perm_b32 v142, v71, v67, s27
  v_perm_b32 v143, v79, v75, s27
  s_mov_b32 s30, 0
  buffer_store_dwordx4 v[112:115], v13, s[12:15], s30 offen sc1
  s_mov_b32 s30, 36864
  buffer_store_dwordx4 v[116:119], v13, s[12:15], s30 offen sc1
  s_mov_b32 s30, 73728
  buffer_store_dwordx4 v[120:123], v13, s[12:15], s30 offen sc1
  s_mov_b32 s30, 110592
  buffer_store_dwordx4 v[124:127], v13, s[12:15], s30 offen sc1
  s_mov_b32 s30, 147456
  buffer_store_dwordx4 v[128:131], v13, s[12:15], s30 offen sc1
  s_mov_b32 s30, 184320
  buffer_store_dwordx4 v[132:135], v13, s[12:15], s30 offen sc1
  s_mov_b32 s30, 221184
  buffer_store_dwordx4 v[136:139], v13, s[12:15], s30 offen sc1
  s_mov_b32 s30, 258048
  buffer_store_dwordx4 v[140:143], v13, s[12:15], s30 offen sc1
  s_endpgm
K2_MF:
  s_load_dwordx2 s[4:5], s[0:1], 136
  v_lshlrev_b32 v1, 4, v0
  s_waitcnt lgkmcnt(0)
  s_add_u32 s8, s4, 8192
  s_addc_u32 s9, s5, 0
  s_mov_b32 s10, 27648
  s_mov_b32 s11, 0x20000
  s_mov_b32 s12, s4
  s_mov_b32 s13, s5
  s_mov_b32 s14, 6912
  s_mov_b32 s15, 0x20000
  s_mov_b32 s16, 13824
  v_add_u32 v2, 0, v1
  v_min_u32 v2, 13808, v2
  buffer_load_dwordx4 v[8:11], v2, s[8:11], 0 offen
  buffer_load_dwordx4 v[12:15], v2, s[8:11], s16 offen
  v_add_u32 v3, 4096, v1
  v_min_u32 v3, 13808, v3
  buffer_load_dwordx4 v[16:19], v3, s[8:11], 0 offen
  buffer_load_dwordx4 v[20:23], v3, s[8:11], s16 offen
  v_add_u32 v4, 8192, v1
  v_min_u32 v4, 13808, v4
  buffer_load_dwordx4 v[24:27], v4, s[8:11], 0 offen
  buffer_load_dwordx4 v[28:31], v4, s[8:11], s16 offen
  v_add_u32 v5, 12288, v1
  v_min_u32 v5, 13808, v5
  buffer_load_dwordx4 v[32:35], v5, s[8:11], 0 offen
  buffer_load_dwordx4 v[36:39], v5, s[8:11], s16 offen
  s_waitcnt vmcnt(0)
  v_add_f32 v8, v8, v12
  v_add_f32 v9, v9, v13
  v_add_f32 v10, v10, v14
  v_add_f32 v11, v11, v15
  v_cvt_pk_bf16_f32 v8, v8, v9
  v_cvt_pk_bf16_f32 v9, v10, v11
  v_lshrrev_b32 v2, 1, v2
  buffer_store_dwordx2 v[8:9], v2, s[12:15], 0 offen sc1
  v_add_f32 v16, v16, v20
  v_add_f32 v17, v17, v21
  v_add_f32 v18, v18, v22
  v_add_f32 v19, v19, v23
  v_cvt_pk_bf16_f32 v16, v16, v17
  v_cvt_pk_bf16_f32 v17, v18, v19
  v_lshrrev_b32 v3, 1, v3
  buffer_store_dwordx2 v[16:17], v3, s[12:15], 0 offen sc1
  v_add_f32 v24, v24, v28
  v_add_f32 v25, v25, v29
  v_add_f32 v26, v26, v30
  v_add_f32 v27, v27, v31
  v_cvt_pk_bf16_f32 v24, v24, v25
  v_cvt_pk_bf16_f32 v25, v26, v27
  v_lshrrev_b32 v4, 1, v4
  buffer_store_dwordx2 v[24:25], v4, s[12:15], 0 offen sc1
  v_add_f32 v32, v32, v36
  v_add_f32 v33, v33, v37
  v_add_f32 v34, v34, v38
  v_add_f32 v35, v35, v39
  v_cvt_pk_bf16_f32 v32, v32, v33
  v_cvt_pk_bf16_f32 v33, v34, v35
  v_lshrrev_b32 v5, 1, v5
  buffer_store_dwordx2 v[32:33], v5, s[12:15], 0 offen sc1
  s_endpgm
K2_WD:
  s_load_dwordx2 s[4:5], s[0:1], 96
  s_load_dwordx2 s[6:7], s[0:1], 136
  v_and_b32 v1, 63, v0
  s_getpc_b64 s[96:97]
PFPC7:
  v_lshlrev_b32 v16, 7, v1
  v_min_u32 v16, K2_END-PFPC7-4, v16
  global_load_dword v120, v16, s[96:97]
  v_lshrrev_b32 v2, 6, v0
  s_lshl_b32 s16, s2, 2
  v_readfirstlane_b32 s3, v2
  s_add_u32 s16, s16, s3
  s_mul_i32 s17, s16, 3641
  s_lshr_b32 s17, s17, 16
  s_mul_i32 s18, s17, 18
  s_sub_u32 s18, s16, s18
  v_and_b32 v3, 1, v1
  v_bfe_u32 v4, v1, 1, 2
  v_lshrrev_b32 v5, 3, v1
  s_lshl_b32 s18, s18, 3
  v_add_u32 v5, s18, v5
  v_lshrrev_b32 v6, 1, v4
  v_lshl_add_u32 v6, v5, 1, v6
  v_lshrrev_b32 v7, 3, v6
  v_lshlrev_b32 v7, 7, v7
  v_and_b32 v6, 7, v6
  v_add_u32 v7, v7, v6
  v_and_b32 v6, 1, v4
  v_lshl_add_u32 v7, v6, 6, v7
  v_mul_u32_u24 v7, 1152, v7
  v_lshl_add_u32 v7, v3, 4, v7
  s_mul_i32 s19, s17, 288
  s_add_u32 s19, s19, 256
  v_add_u32 v7, s19, v7
  s_mul_i32 s19, s17, 144
  v_add_u32 v8, s19, v5
  v_mul_u32_u24 v8, 9, v8
  v_add_u32 v8, 8, v8
  v_lshlrev_b32 v8, 10, v8
  v_lshl_add_u32 v8, v4, 8, v8
  v_lshl_add_u32 v8, v3, 7, v8
  s_waitcnt lgkmcnt(0)
  s_mov_b32 s8, s4
  s_mov_b32 s9, s5
  s_mov_b32 s10, 5308416
  s_mov_b32 s11, 0x20000
  s_add_u32 s12, s6, 22593536
  s_addc_u32 s13, s7, 0
  s_mov_b32 s14, 5308416
  s_mov_b32 s15, 0x20000
  s_mov_b32 s26, 0x05040100
  s_mov_b32 s27, 0x07060302
  s_mov_b32 s30, 0
  buffer_load_dwordx4 v[16:19], v7, s[8:11], s30 offen nt
  s_mov_b32 s30, 9216
  buffer_load_dwordx4 v[20:23], v7, s[8:11], s30 offen nt
  s_mov_b32 s30, 18432
  buffer_load_dwordx4 v[24:27], v7, s[8:11], s30 offen nt
  s_mov_b32 s30, 27648
  buffer_load_dwordx4 v[28:31], v7, s[8:11], s30 offen nt
  s_mov_b32 s30, 36864
  buffer_load_dwordx4 v[32:35], v7, s[8:11], s30 offen nt
  s_mov_b32 s30, 46080
  buffer_load_dwordx4 v[36:39], v7, s[8:11], s30 offen nt
  s_mov_b32 s30, 55296
  buffer_load_dwordx4 v[40:43], v7, s[8:11], s30 offen nt
  s_mov_b32 s30, 64512
  buffer_load_dwordx4 v[44:47], v7, s[8:11], s30 offen nt
  s_waitcnt vmcnt(0)
  v_perm_b32 v48, v20, v16, s26
  v_perm_b32 v49, v28, v24, s26
  v_perm_b32 v50, v36, v32, s26
  v_perm_b32 v51, v44, v40, s26
  v_perm_b32 v52, v20, v16, s27
  v_perm_b32 v53, v28, v24, s27
  v_perm_b32 v54, v36, v32, s27
  v_perm_b32 v55, v44, v40, s27
  v_perm_b32 v56, v21, v17, s26
  v_perm_b32 v57, v29, v25, s26
  v_perm_b32 v58, v37, v33, s26
  v_perm_b32 v59, v45, v41, s26
  v_perm_b32 v60, v21, v17, s27
  v_perm_b32 v61, v29, v25, s27
  v_perm_b32 v62, v37, v33, s27
  v_perm_b32 v63, v45, v41, s27
  v_perm_b32 v64, v22, v18, s26
  v_perm_b32 v65, v30, v26, s26
  v_perm_b32 v66, v38, v34, s26
  v_perm_b32 v67, v46, v42, s26
  v_perm_b32 v68, v22, v18, s27
  v_perm_b32 v69, v30, v26, s27
  v_perm_b32 v70, v38, v34, s27
  v_perm_b32 v71, v46, v42, s27
  v_perm_b32 v72, v23, v19, s26
  v_perm_b32 v73, v31, v27, s26
  v_perm_b32 v74, v39, v35, s26
  v_perm_b32 v75, v47, v43, s26
  v_perm_b32 v76, v23, v19, s27
  v_perm_b32 v77, v31, v27, s27
  v_perm_b32 v78, v39, v35, s27
  v_perm_b32 v79, v47, v43, s27
  v_lshrrev_b32 v9, 3, v1
  v_lshlrev_b32 v9, 10, v9
  v_lshl_add_u32 v9, v4, 8, v9
  v_lshl_add_u32 v9, v3, 7, v9
  s_lshl_b32 s20, s3, 13
  v_add_u32 v9, s20, v9
  ds_write_b128 v9, v[48:51] offset:0
  ds_write_b128 v9, v[52:55] offset:16
  ds_write_b128 v9, v[56:59] offset:32
  ds_write_b128 v9, v[60:63] offset:48
  ds_write_b128 v9, v[64:67] offset:64
  ds_write_b128 v9, v[68:71] offset:80
  ds_write_b128 v9, v[72:75] offset:96
  ds_write_b128 v9, v[76:79] offset:112
  v_lshl_add_u32 v10, v1, 4, s20
  ds_read_b128 v[16:19], v10 offset:0
  ds_read_b128 v[20:23], v10 offset:1024
  ds_read_b128 v[24:27], v10 offset:2048
  ds_read_b128 v[28:31], v10 offset:3072
  ds_read_b128 v[32:35], v10 offset:4096
  ds_read_b128 v[36:39], v10 offset:5120
  ds_read_b128 v[40:43], v10 offset:6144
  ds_read_b128 v[44:47], v10 offset:7168
  s_mul_i32 s21, s17, 144
  s_add_u32 s21, s21, s18
  s_mul_i32 s21, s21, 9216
  s_add_u32 s21, s21, 8192
  v_lshlrev_b32 v11, 4, v1
  s_waitcnt lgkmcnt(7)
  s_add_u32 s30, s21, 0
  buffer_store_dwordx4 v[16:19], v11, s[12:15], s30 offen sc1
  s_waitcnt lgkmcnt(6)
  s_add_u32 s30, s21, 9216
  buffer_store_dwordx4 v[20:23], v11, s[12:15], s30 offen sc1
  s_waitcnt lgkmcnt(5)
  s_add_u32 s30, s21, 18432
  buffer_store_dwordx4 v[24:27], v11, s[12:15], s30 offen sc1
  s_waitcnt lgkmcnt(4)
  s_add_u32 s30, s21, 27648
  buffer_store_dwordx4 v[28:31], v11, s[12:15], s30 offen sc1
  s_waitcnt lgkmcnt(3)
  s_add_u32 s30, s21, 36864
  buffer_store_dwordx4 v[32:35], v11, s[12:15], s30 offen sc1
  s_waitcnt lgkmcnt(2)
  s_add_u32 s30, s21, 46080
  buffer_store_dwordx4 v[36:39], v11, s[12:15], s30 offen sc1
  s_waitcnt lgkmcnt(1)
  s_add_u32 s30, s21, 55296
  buffer_store_dwordx4 v[40:43], v11, s[12:15], s30 offen sc1
  s_waitcnt lgkmcnt(0)
  s_add_u32 s30, s21, 64512
  buffer_store_dwordx4 v[44:47], v11, s[12:15], s30 offen sc1
  s_endpgm
K2_END:

.globl gemm1_kernel
.p2align 8
.type gemm1_kernel,@function
gemm1_kernel:
L_gemm1_kernel:
  s_cmp_ge_u32 s2, 256
  s_cbranch_scc1 K4_END
  s_load_dwordx2 s[4:5], s[0:1], 136
  s_load_dwordx2 s[36:37], s[0:1], 0
  s_load_dwordx2 s[46:47], s[0:1], 96
  v_and_b32 v9, 63, v0
  s_getpc_b64 s[96:97]
PFPC8:
  v_lshlrev_b32 v13, 7, v9
  v_min_u32 v13, K4_END-PFPC8-4, v13
  global_load_dword v14, v13, s[96:97]
  v_lshrrev_b32 v10, 6, v0
  v_lshlrev_b32 v1, 4, v9
  v_readfirstlane_b32 s3, v10
  s_and_b32 s6, s2, 7
  s_lshr_b32 s7, s2, 3
  s_and_b32 s16, s7, 3
  s_lshl_b32 s6, s6, 2
  s_add_u32 s6, s6, s16
  s_lshr_b32 s7, s7, 2
  v_and_b32 v10, 7, v9
  v_lshrrev_b32 v11, 3, v9
  s_lshl_b32 s20, s7, 8
  s_lshl_b32 s21, s6, 3
  s_add_u32 s20, s20, s21
  v_add_u32 v12, s20, v10
  s_lshl_b32 s21, s3, 3
  v_add_u32 v11, s21, v11
  s_cmp_eq_u32 s3, 0
  s_cselect_b32 s22, 0, 0x40000000
  v_mul_u32_u24 v15, 1152, v12
  v_lshlrev_b32 v16, 3, v12
  v_lshrrev_b32 v17, 4, v12
  v_mul_u32_u24 v17, 18, v17
  v_and_b32 v18, 15, v12
  v_add_u32 v19, 0, v11
  v_lshlrev_b32 v154, 4, v19
  v_add_u32 v148, v15, v154
  v_lshl_add_u32 v151, v19, 15, v16
  v_lshrrev_b32 v20, 2, v19
  v_add_u32 v20, v17, v20
  v_lshlrev_b32 v20, 10, v20
  v_and_b32 v21, 3, v19
  v_lshl_add_u32 v21, v21, 4, v18
  v_lshl_add_u32 v157, v21, 4, v20
  v_add_u32 v19, 32, v11
  v_lshlrev_b32 v155, 4, v19
  v_add_u32 v149, v15, v155
  v_lshl_add_u32 v152, v19, 15, v16
  v_lshrrev_b32 v20, 2, v19
  v_add_u32 v20, v17, v20
  v_lshlrev_b32 v20, 10, v20
  v_and_b32 v21, 3, v19
  v_lshl_add_u32 v21, v21, 4, v18
  v_lshl_add_u32 v158, v21, 4, v20
  v_add_u32 v19, 64, v11
  v_lshlrev_b32 v156, 4, v19
  v_add_u32 v150, v15, v156
  v_lshl_add_u32 v153, v19, 15, v16
  v_lshrrev_b32 v20, 2, v19
  v_add_u32 v20, v17, v20
  v_lshlrev_b32 v20, 10, v20
  v_and_b32 v21, 3, v19
  v_lshl_add_u32 v21, v21, 4, v18
  v_lshl_add_u32 v159, v21, 4, v20
  v_add_u32 v156, s22, v156
  v_add_u32 v150, s22, v150
  v_add_u32 v153, s22, v153
  v_add_u32 v159, s22, v159
  s_mul_i32 s20, s6, 331776
  s_mul_i32 s23, s3, 9216
  s_add_u32 s24, s20, s23
  s_lshl_b32 s25, s7, 4
  s_lshl_b32 s26, s3, 2
  s_add_u32 s45, s25, s26
  s_mul_i32 s25, s45, 18432
  s_waitcnt lgkmcnt(0)
  s_mov_b32 s48, s36
  s_mov_b32 s49, s37
  s_mov_b32 s50, 2359296
  s_mov_b32 s51, 0x20000
  s_add_u32 s52, s4, 4898816
  s_addc_u32 s53, s5, 0
  s_mov_b32 s54, 2359296
  s_mov_b32 s55, 0x20000
  s_mov_b32 s56, s4
  s_mov_b32 s57, s5
  s_mov_b32 s58, 6912
  s_mov_b32 s59, 0x20000
  s_mov_b32 s29, 4608
  buffer_load_dwordx4 v[96:99], v154, s[56:59], s29 offen
  buffer_load_dwordx4 v[100:103], v154, s[56:59], 0 offen offset:3456
  buffer_load_dwordx4 v[116:119], v155, s[56:59], s29 offen
  buffer_load_dwordx4 v[120:123], v155, s[56:59], 0 offen offset:3456
  buffer_load_dwordx4 v[136:139], v156, s[56:59], s29 offen
  buffer_load_dwordx4 v[140:143], v156, s[56:59], 0 offen offset:3456
  s_mov_b32 s28, 16384
  buffer_load_dwordx2 v[88:89], v151, s[52:55], 0 offen
  buffer_load_dwordx2 v[90:91], v151, s[52:55], s28 offen
  buffer_load_dwordx4 v[84:87], v148, s[48:51], 0 offen
  buffer_load_dwordx4 v[92:95], v154, s[56:59], 0 offen offset:2304
  buffer_load_dwordx2 v[108:109], v152, s[52:55], 0 offen
  buffer_load_dwordx2 v[110:111], v152, s[52:55], s28 offen
  buffer_load_dwordx4 v[104:107], v149, s[48:51], 0 offen
  buffer_load_dwordx4 v[112:115], v155, s[56:59], 0 offen offset:2304
  buffer_load_dwordx2 v[128:129], v153, s[52:55], 0 offen
  buffer_load_dwordx2 v[130:131], v153, s[52:55], s28 offen
  buffer_load_dwordx4 v[124:127], v150, s[48:51], 0 offen
  buffer_load_dwordx4 v[132:135], v156, s[56:59], 0 offen offset:2304
  s_add_u32 s8, s4, 11976704
  s_addc_u32 s9, s5, 0
  s_mov_b32 s10, 10616832
  s_mov_b32 s11, 0x20000
  s_add_u32 s12, s4, 9617408
  s_addc_u32 s13, s5, 0
  s_mov_b32 s14, 2359296
  s_mov_b32 s15, 0x20000
  s_add_u32 s16, s4, 7258112
  s_addc_u32 s17, s5, 0
  s_mov_b32 s18, 2359296
  s_mov_b32 s19, 0x20000
  s_add_u32 s32, s4, 36864
  s_addc_u32 s33, s5, 0
  s_mov_b32 s34, 32768
  s_mov_b32 s35, 0x20000
  s_add_u32 m0, s23, 0
  s_add_u32 s27, s24, 0
  buffer_load_dwordx4 v1, s[8:11], s27 offen offset:0 lds
  buffer_load_dwordx4 v1, s[8:11], s27 offen offset:1024 lds
  buffer_load_dwordx4 v1, s[8:11], s27 offen offset:2048 lds
  buffer_load_dwordx4 v1, s[8:11], s27 offen offset:3072 lds
  s_add_u32 m0, s23, 4096
  s_add_u32 s27, s24, 4096
  buffer_load_dwordx4 v1, s[8:11], s27 offen offset:0 lds
  buffer_load_dwordx4 v1, s[8:11], s27 offen offset:1024 lds
  buffer_load_dwordx4 v1, s[8:11], s27 offen offset:2048 lds
  buffer_load_dwordx4 v1, s[8:11], s27 offen offset:3072 lds
  s_add_u32 m0, s23, 8192
  s_add_u32 s27, s24, 8192
  buffer_load_dwordx4 v1, s[8:11], s27 offen offset:0 lds
  s_waitcnt vmcnt(21)
  v_mov_b32 v206, 0x3eeff558
  v_lshlrev_b32 v208, 16, v96
  v_and_b32 v209, 0xffff0000, v96
  v_lshlrev_b32 v232, 16, v100
  v_and_b32 v233, 0xffff0000, v100
  v_lshlrev_b32 v210, 16, v97
  v_and_b32 v211, 0xffff0000, v97
  v_lshlrev_b32 v234, 16, v101
  v_and_b32 v235, 0xffff0000, v101
  v_lshlrev_b32 v212, 16, v98
  v_and_b32 v213, 0xffff0000, v98
  v_lshlrev_b32 v236, 16, v102
  v_and_b32 v237, 0xffff0000, v102
  v_lshlrev_b32 v214, 16, v99
  v_and_b32 v215, 0xffff0000, v99
  v_lshlrev_b32 v238, 16, v103
  v_and_b32 v239, 0xffff0000, v103
  v_pk_add_f32 v[208:209], v[208:209], 1.0 op_sel_hi:[1,0]
  v_pk_add_f32 v[210:211], v[210:211], 1.0 op_sel_hi:[1,0]
  v_pk_add_f32 v[212:213], v[212:213], 1.0 op_sel_hi:[1,0]
  v_pk_add_f32 v[214:215], v[214:215], 1.0 op_sel_hi:[1,0]
  v_cvt_pk_bf16_f32 v96, v208, v209
  v_cvt_pk_bf16_f32 v97, v210, v211
  v_cvt_pk_bf16_f32 v98, v212, v213
  v_cvt_pk_bf16_f32 v99, v214, v215
  v_lshlrev_b32 v208, 16, v96
  v_and_b32 v209, 0xffff0000, v96
  v_lshlrev_b32 v210, 16, v97
  v_and_b32 v211, 0xffff0000, v97
  v_lshlrev_b32 v212, 16, v98
  v_and_b32 v213, 0xffff0000, v98
  v_lshlrev_b32 v214, 16, v99
  v_and_b32 v215, 0xffff0000, v99
  v_pk_mul_f32 v[208:209], v[208:209], v[206:207] op_sel_hi:[1,0]
  v_pk_mul_f32 v[232:233], v[232:233], v[206:207] op_sel_hi:[1,0]
  v_pk_mul_f32 v[210:211], v[210:211], v[206:207] op_sel_hi:[1,0]
  v_pk_mul_f32 v[234:235], v[234:235], v[206:207] op_sel_hi:[1,0]
  v_pk_mul_f32 v[212:213], v[212:213], v[206:207] op_sel_hi:[1,0]
  v_pk_mul_f32 v[236:237], v[236:237], v[206:207] op_sel_hi:[1,0]
  v_pk_mul_f32 v[214:215], v[214:215], v[206:207] op_sel_hi:[1,0]
  v_pk_mul_f32 v[238:239], v[238:239], v[206:207] op_sel_hi:[1,0]
  v_lshlrev_b32 v216, 16, v116
  v_and_b32 v217, 0xffff0000, v116
  v_lshlrev_b32 v240, 16, v120
  v_and_b32 v241, 0xffff0000, v120
  v_lshlrev_b32 v218, 16, v117
  v_and_b32 v219, 0xffff0000, v117
  v_lshlrev_b32 v242, 16, v121
  v_and_b32 v243, 0xffff0000, v121
  v_lshlrev_b32 v220, 16, v118
  v_and_b32 v221, 0xffff0000, v118
  v_lshlrev_b32 v244, 16, v122
  v_and_b32 v245, 0xffff0000, v122
  v_lshlrev_b32 v222, 16, v119
  v_and_b32 v223, 0xffff0000, v119
  v_lshlrev_b32 v246, 16, v123
  v_and_b32 v247, 0xffff0000, v123
  v_pk_add_f32 v[216:217], v[216:217], 1.0 op_sel_hi:[1,0]
  v_pk_add_f32 v[218:219], v[218:219], 1.0 op_sel_hi:[1,0]
  v_pk_add_f32 v[220:221], v[220:221], 1.0 op_sel_hi:[1,0]
  v_pk_add_f32 v[222:223], v[222:223], 1.0 op_sel_hi:[1,0]
  v_cvt_pk_bf16_f32 v116, v216, v217
  v_cvt_pk_bf16_f32 v117, v218, v219
  v_cvt_pk_bf16_f32 v118, v220, v221
  v_cvt_pk_bf16_f32 v119, v222, v223
  v_lshlrev_b32 v216, 16, v116
  v_and_b32 v217, 0xffff0000, v116
  v_lshlrev_b32 v218, 16, v117
  v_and_b32 v219, 0xffff0000, v117
  v_lshlrev_b32 v220, 16, v118
  v_and_b32 v221, 0xffff0000, v118
  v_lshlrev_b32 v222, 16, v119
  v_and_b32 v223, 0xffff0000, v119
  v_pk_mul_f32 v[216:217], v[216:217], v[206:207] op_sel_hi:[1,0]
  v_pk_mul_f32 v[240:241], v[240:241], v[206:207] op_sel_hi:[1,0]
  v_pk_mul_f32 v[218:219], v[218:219], v[206:207] op_sel_hi:[1,0]
  v_pk_mul_f32 v[242:243], v[242:243], v[206:207] op_sel_hi:[1,0]
  v_pk_mul_f32 v[220:221], v[220:221], v[206:207] op_sel_hi:[1,0]
  v_pk_mul_f32 v[244:245], v[244:245], v[206:207] op_sel_hi:[1,0]
  v_pk_mul_f32 v[222:223], v[222:223], v[206:207] op_sel_hi:[1,0]
  v_pk_mul_f32 v[246:247], v[246:247], v[206:207] op_sel_hi:[1,0]
  v_lshlrev_b32 v224, 16, v136
  v_and_b32 v225, 0xffff0000, v136
  v_lshlrev_b32 v248, 16, v140
  v_and_b32 v249, 0xffff0000, v140
  v_lshlrev_b32 v226, 16, v137
  v_and_b32 v227, 0xffff0000, v137
  v_lshlrev_b32 v250, 16, v141
  v_and_b32 v251, 0xffff0000, v141
  v_lshlrev_b32 v228, 16, v138
  v_and_b32 v229, 0xffff0000, v138
  v_lshlrev_b32 v252, 16, v142
  v_and_b32 v253, 0xffff0000, v142
  v_lshlrev_b32 v230, 16, v139
  v_and_b32 v231, 0xffff0000, v139
  v_lshlrev_b32 v254, 16, v143
  v_and_b32 v255, 0xffff0000, v143
  v_pk_add_f32 v[224:225], v[224:225], 1.0 op_sel_hi:[1,0]
  v_pk_add_f32 v[226:227], v[226:227], 1.0 op_sel_hi:[1,0]
  v_pk_add_f32 v[228:229], v[228:229], 1.0 op_sel_hi:[1,0]
  v_pk_add_f32 v[230:231], v[230:231], 1.0 op_sel_hi:[1,0]
  v_cvt_pk_bf16_f32 v136, v224, v225
  v_cvt_pk_bf16_f32 v137, v226, v227
  v_cvt_pk_bf16_f32 v138, v228, v229
  v_cvt_pk_bf16_f32 v139, v230, v231
  v_lshlrev_b32 v224, 16, v136
  v_and_b32 v225, 0xffff0000, v136
  v_lshlrev_b32 v226, 16, v137
  v_and_b32 v227, 0xffff0000, v137
  v_lshlrev_b32 v228, 16, v138
  v_and_b32 v229, 0xffff0000, v138
  v_lshlrev_b32 v230, 16, v139
  v_and_b32 v231, 0xffff0000, v139
  v_pk_mul_f32 v[224:225], v[224:225], v[206:207] op_sel_hi:[1,0]
  v_pk_mul_f32 v[248:249], v[248:249], v[206:207] op_sel_hi:[1,0]
  v_pk_mul_f32 v[226:227], v[226:227], v[206:207] op_sel_hi:[1,0]
  v_pk_mul_f32 v[250:251], v[250:251], v[206:207] op_sel_hi:[1,0]
  v_pk_mul_f32 v[228:229], v[228:229], v[206:207] op_sel_hi:[1,0]
  v_pk_mul_f32 v[252:253], v[252:253], v[206:207] op_sel_hi:[1,0]
  v_pk_mul_f32 v[230:231], v[230:231], v[206:207] op_sel_hi:[1,0]
  v_pk_mul_f32 v[254:255], v[254:255], v[206:207] op_sel_hi:[1,0]
  v_mov_b32 v200, 0
  v_mov_b32 v201, 0
  v_mov_b32 v202, 0
  v_mov_b32 v203, 0
  s_waitcnt vmcnt(17)
  v_lshlrev_b32 v160, 16, v84
  v_and_b32 v161, 0xffff0000, v84
  v_lshlrev_b32 v184, 16, v88
  v_and_b32 v185, 0xffff0000, v88
  v_lshlrev_b32 v192, 16, v92
  v_and_b32 v193, 0xffff0000, v92
  v_lshlrev_b32 v162, 16, v85
  v_and_b32 v163, 0xffff0000, v85
  v_lshlrev_b32 v186, 16, v89
  v_and_b32 v187, 0xffff0000, v89
  v_lshlrev_b32 v194, 16, v93
  v_and_b32 v195, 0xffff0000, v93
  v_lshlrev_b32 v164, 16, v86
  v_and_b32 v165, 0xffff0000, v86
  v_lshlrev_b32 v188, 16, v90
  v_and_b32 v189, 0xffff0000, v90
  v_lshlrev_b32 v196, 16, v94
  v_and_b32 v197, 0xffff0000, v94
  v_lshlrev_b32 v166, 16, v87
  v_and_b32 v167, 0xffff0000, v87
  v_lshlrev_b32 v190, 16, v91
  v_and_b32 v191, 0xffff0000, v91
  v_lshlrev_b32 v198, 16, v95
  v_and_b32 v199, 0xffff0000, v95
  v_pk_fma_f32 v[160:161], v[184:185], v[192:193], v[160:161]
  v_pk_fma_f32 v[162:163], v[186:187], v[194:195], v[162:163]
  v_pk_fma_f32 v[164:165], v[188:189], v[196:197], v[164:165]
  v_pk_fma_f32 v[166:167], v[190:191], v[198:199], v[166:167]
  v_cvt_pk_bf16_f32 v84, v160, v161
  v_cvt_pk_bf16_f32 v85, v162, v163
  v_cvt_pk_bf16_f32 v86, v164, v165
  v_cvt_pk_bf16_f32 v87, v166, v167
  v_lshlrev_b32 v160, 16, v84
  v_and_b32 v161, 0xffff0000, v84
  v_lshlrev_b32 v162, 16, v85
  v_and_b32 v163, 0xffff0000, v85
  v_lshlrev_b32 v164, 16, v86
  v_and_b32 v165, 0xffff0000, v86
  v_lshlrev_b32 v166, 16, v87
  v_and_b32 v167, 0xffff0000, v87
  v_pk_add_f32 v[200:201], v[200:201], v[160:161]
  v_pk_fma_f32 v[202:203], v[160:161], v[160:161], v[202:203]
  v_pk_add_f32 v[200:201], v[200:201], v[162:163]
  v_pk_fma_f32 v[202:203], v[162:163], v[162:163], v[202:203]
  v_pk_add_f32 v[200:201], v[200:201], v[164:165]
  v_pk_fma_f32 v[202:203], v[164:165], v[164:165], v[202:203]
  v_pk_add_f32 v[200:201], v[200:201], v[166:167]
  v_pk_fma_f32 v[202:203], v[166:167], v[166:167], v[202:203]
  s_waitcnt vmcnt(13)
  v_lshlrev_b32 v168, 16, v104
  v_and_b32 v169, 0xffff0000, v104
  v_lshlrev_b32 v184, 16, v108
  v_and_b32 v185, 0xffff0000, v108
  v_lshlrev_b32 v192, 16, v112
  v_and_b32 v193, 0xffff0000, v112
  v_lshlrev_b32 v170, 16, v105
  v_and_b32 v171, 0xffff0000, v105
  v_lshlrev_b32 v186, 16, v109
  v_and_b32 v187, 0xffff0000, v109
  v_lshlrev_b32 v194, 16, v113
  v_and_b32 v195, 0xffff0000, v113
  v_lshlrev_b32 v172, 16, v106
  v_and_b32 v173, 0xffff0000, v106
  v_lshlrev_b32 v188, 16, v110
  v_and_b32 v189, 0xffff0000, v110
  v_lshlrev_b32 v196, 16, v114
  v_and_b32 v197, 0xffff0000, v114
  v_lshlrev_b32 v174, 16, v107
  v_and_b32 v175, 0xffff0000, v107
  v_lshlrev_b32 v190, 16, v111
  v_and_b32 v191, 0xffff0000, v111
  v_lshlrev_b32 v198, 16, v115
  v_and_b32 v199, 0xffff0000, v115
  v_pk_fma_f32 v[168:169], v[184:185], v[192:193], v[168:169]
  v_pk_fma_f32 v[170:171], v[186:187], v[194:195], v[170:171]
  v_pk_fma_f32 v[172:173], v[188:189], v[196:197], v[172:173]
  v_pk_fma_f32 v[174:175], v[190:191], v[198:199], v[174:175]
  v_cvt_pk_bf16_f32 v104, v168, v169
  v_cvt_pk_bf16_f32 v105, v170, v171
  v_cvt_pk_bf16_f32 v106, v172, v173
  v_cvt_pk_bf16_f32 v107, v174, v175
  v_lshlrev_b32 v168, 16, v104
  v_and_b32 v169, 0xffff0000, v104
  v_lshlrev_b32 v170, 16, v105
  v_and_b32 v171, 0xffff0000, v105
  v_lshlrev_b32 v172, 16, v106
  v_and_b32 v173, 0xffff0000, v106
  v_lshlrev_b32 v174, 16, v107
  v_and_b32 v175, 0xffff0000, v107
  v_pk_add_f32 v[200:201], v[200:201], v[168:169]
  v_pk_fma_f32 v[202:203], v[168:169], v[168:169], v[202:203]
  v_pk_add_f32 v[200:201], v[200:201], v[170:171]
  v_pk_fma_f32 v[202:203], v[170:171], v[170:171], v[202:203]
  v_pk_add_f32 v[200:201], v[200:201], v[172:173]
  v_pk_fma_f32 v[202:203], v[172:173], v[172:173], v[202:203]
  v_pk_add_f32 v[200:201], v[200:201], v[174:175]
  v_pk_fma_f32 v[202:203], v[174:175], v[174:175], v[202:203]
  s_waitcnt vmcnt(9)
  v_lshlrev_b32 v176, 16, v124
  v_and_b32 v177, 0xffff0000, v124
  v_lshlrev_b32 v184, 16, v128
  v_and_b32 v185, 0xffff0000, v128
  v_lshlrev_b32 v192, 16, v132
  v_and_b32 v193, 0xffff0000, v132
  v_lshlrev_b32 v178, 16, v125
  v_and_b32 v179, 0xffff0000, v125
  v_lshlrev_b32 v186, 16, v129
  v_and_b32 v187, 0xffff0000, v129
  v_lshlrev_b32 v194, 16, v133
  v_and_b32 v195, 0xffff0000, v133
  v_lshlrev_b32 v180, 16, v126
  v_and_b32 v181, 0xffff0000, v126
  v_lshlrev_b32 v188, 16, v130
  v_and_b32 v189, 0xffff0000, v130
  v_lshlrev_b32 v196, 16, v134
  v_and_b32 v197, 0xffff0000, v134
  v_lshlrev_b32 v182, 16, v127
  v_and_b32 v183, 0xffff0000, v127
  v_lshlrev_b32 v190, 16, v131
  v_and_b32 v191, 0xffff0000, v131
  v_lshlrev_b32 v198, 16, v135
  v_and_b32 v199, 0xffff0000, v135
  v_pk_fma_f32 v[176:177], v[184:185], v[192:193], v[176:177]
  v_pk_fma_f32 v[178:179], v[186:187], v[194:195], v[178:179]
  v_pk_fma_f32 v[180:181], v[188:189], v[196:197], v[180:181]
  v_pk_fma_f32 v[182:183], v[190:191], v[198:199], v[182:183]
  v_cvt_pk_bf16_f32 v124, v176, v177
  v_cvt_pk_bf16_f32 v125, v178, v179
  v_cvt_pk_bf16_f32 v126, v180, v181
  v_cvt_pk_bf16_f32 v127, v182, v183
  v_lshlrev_b32 v176, 16, v124
  v_and_b32 v177, 0xffff0000, v124
  v_lshlrev_b32 v178, 16, v125
  v_and_b32 v179, 0xffff0000, v125
  v_lshlrev_b32 v180, 16, v126
  v_and_b32 v181, 0xffff0000, v126
  v_lshlrev_b32 v182, 16, v127
  v_and_b32 v183, 0xffff0000, v127
  v_pk_add_f32 v[200:201], v[200:201], v[176:177]
  v_pk_fma_f32 v[202:203], v[176:177], v[176:177], v[202:203]
  v_pk_add_f32 v[200:201], v[200:201], v[178:179]
  v_pk_fma_f32 v[202:203], v[178:179], v[178:179], v[202:203]
  v_pk_add_f32 v[200:201], v[200:201], v[180:181]
  v_pk_fma_f32 v[202:203], v[180:181], v[180:181], v[202:203]
  v_pk_add_f32 v[200:201], v[200:201], v[182:183]
  v_pk_fma_f32 v[202:203], v[182:183], v[182:183], v[202:203]
  v_add_f32 v200, v200, v201
  v_add_f32 v201, v202, v203
  s_nop 1
  v_add_f32_dpp v200, v200, v200 row_ror:8 row_mask:0xf bank_mask:0xf
  v_add_f32_dpp v201, v201, v201 row_ror:8 row_mask:0xf bank_mask:0xf
  v_mov_b32 v204, v200
  v_mov_b32 v205, v201
  s_nop 1
  v_permlane16_swap_b32 v200, v204
  v_permlane16_swap_b32 v201, v205
  s_nop 1
  v_add_f32 v200, v200, v204
  v_add_f32 v201, v201, v205
  v_mov_b32 v204, v200
  v_mov_b32 v205, v201
  s_nop 1
  v_permlane32_swap_b32 v200, v204
  v_permlane32_swap_b32 v201, v205
  s_nop 1
  v_add_f32 v200, v200, v204
  v_add_f32 v201, v201, v205
  v_and_b32 v10, 7, v9
  v_lshlrev_b32 v10, 3, v10
  v_add_u32 v10, 147456, v10
  s_lshl_b32 s28, s3, 6
  v_add_u32 v11, s28, v10
  s_mov_b64 exec, 0xff
  ds_write_b64 v11, v[200:201]
  s_mov_b64 exec, -1
  s_waitcnt lgkmcnt(0)
  s_barrier
  ds_read_b64 v[184:185], v10 offset:0
  ds_read_b64 v[186:187], v10 offset:64
  ds_read_b64 v[188:189], v10 offset:128
  ds_read_b64 v[190:191], v10 offset:192
  s_waitcnt lgkmcnt(0)
  v_pk_add_f32 v[184:185], v[184:185], v[186:187]
  v_pk_add_f32 v[184:185], v[184:185], v[188:189]
  v_pk_add_f32 v[184:185], v[184:185], v[190:191]
  v_mul_f32 v184, 0x3ae38e39, v184
  v_mul_f32 v185, 0x3ae38e39, v185
  v_fma_f32 v185, -v184, v184, v185
  v_max_f32 v185, 0, v185
  v_cvt_pk_bf16_f32 v196, v185, v185
  v_lshlrev_b32 v196, 16, v196
  v_add_f32 v196, 0x3727c5ac, v196
  v_cvt_pk_bf16_f32 v196, v196, v196
  v_lshlrev_b32 v196, 16, v196
  v_sqrt_f32 v196, v196
  v_cvt_pk_bf16_f32 v197, v184, v184
  v_lshlrev_b32 v197, 16, v197
  v_cvt_pk_bf16_f32 v196, v196, v196
  v_lshlrev_b32 v196, 16, v196
  v_rcp_f32 v192, v196
  s_nop 0
  v_mul_f32 v194, v197, v192
  v_sub_f32 v194, 0, v194
  v_pk_fma_f32 v[160:161], v[160:161], v[192:193], v[194:195] op_sel_hi:[1,0,0]
  v_pk_fma_f32 v[162:163], v[162:163], v[192:193], v[194:195] op_sel_hi:[1,0,0]
  v_pk_fma_f32 v[164:165], v[164:165], v[192:193], v[194:195] op_sel_hi:[1,0,0]
  v_pk_fma_f32 v[166:167], v[166:167], v[192:193], v[194:195] op_sel_hi:[1,0,0]
  v_pk_fma_f32 v[160:161], v[160:161], v[208:209], v[232:233]
  v_pk_fma_f32 v[162:163], v[162:163], v[210:211], v[234:235]
  v_pk_fma_f32 v[164:165], v[164:165], v[212:213], v[236:237]
  v_pk_fma_f32 v[166:167], v[166:167], v[214:215], v[238:239]
  v_cvt_pk_bf16_f32 v88, v160, v161
  v_cvt_pk_bf16_f32 v89, v162, v163
  v_cvt_pk_bf16_f32 v90, v164, v165
  v_cvt_pk_bf16_f32 v91, v166, v167
  buffer_store_dwordx4 v[88:91], v157, s[12:15], 0 offen sc1
  v_pk_fma_f32 v[168:169], v[168:169], v[192:193], v[194:195] op_sel_hi:[1,0,0]
  v_pk_fma_f32 v[170:171], v[170:171], v[192:193], v[194:195] op_sel_hi:[1,0,0]
  v_pk_fma_f32 v[172:173], v[172:173], v[192:193], v[194:195] op_sel_hi:[1,0,0]
  v_pk_fma_f32 v[174:175], v[174:175], v[192:193], v[194:195] op_sel_hi:[1,0,0]
  v_pk_fma_f32 v[168:169], v[168:169], v[216:217], v[240:241]
  v_pk_fma_f32 v[170:171], v[170:171], v[218:219], v[242:243]
  v_pk_fma_f32 v[172:173], v[172:173], v[220:221], v[244:245]
  v_pk_fma_f32 v[174:175], v[174:175], v[222:223], v[246:247]
  v_cvt_pk_bf16_f32 v108, v168, v169
  v_cvt_pk_bf16_f32 v109, v170, v171
  v_cvt_pk_bf16_f32 v110, v172, v173
  v_cvt_pk_bf16_f32 v111, v174, v175
  buffer_store_dwordx4 v[108:111], v158, s[12:15], 0 offen sc1
  v_pk_fma_f32 v[176:177], v[176:177], v[192:193], v[194:195] op_sel_hi:[1,0,0]
  v_pk_fma_f32 v[178:179], v[178:179], v[192:193], v[194:195] op_sel_hi:[1,0,0]
  v_pk_fma_f32 v[180:181], v[180:181], v[192:193], v[194:195] op_sel_hi:[1,0,0]
  v_pk_fma_f32 v[182:183], v[182:183], v[192:193], v[194:195] op_sel_hi:[1,0,0]
  v_pk_fma_f32 v[176:177], v[176:177], v[224:225], v[248:249]
  v_pk_fma_f32 v[178:179], v[178:179], v[226:227], v[250:251]
  v_pk_fma_f32 v[180:181], v[180:181], v[228:229], v[252:253]
  v_pk_fma_f32 v[182:183], v[182:183], v[230:231], v[254:255]
  v_cvt_pk_bf16_f32 v128, v176, v177
  v_cvt_pk_bf16_f32 v129, v178, v179
  v_cvt_pk_bf16_f32 v130, v180, v181
  v_cvt_pk_bf16_f32 v131, v182, v183
  buffer_store_dwordx4 v[128:131], v159, s[12:15], 0 offen sc1
  s_waitcnt vmcnt(0)
  s_barrier
  s_lshl_b32 s28, s7, 5
  s_add_u32 s29, s28, s6
  s_lshl_b32 s29, s29, 7
  s_cmp_eq_u32 s3, 0
  s_cbranch_scc0 K4_NOFLAG
  v_mov_b32 v10, 1
  v_mov_b32 v11, 0
  s_mov_b64 exec, 1
  buffer_store_dword v10, v11, s[32:35], s29 offen sc1
  s_mov_b64 exec, -1
  v_and_b32 v11, 31, v9
  v_lshlrev_b32 v11, 7, v11
  s_lshl_b32 s28, s28, 7
  s_mov_b32 s29, 0
K4_POLL:
  buffer_load_dword v12, v11, s[32:35], s28 offen sc1
  s_add_u32 s29, s29, 1
  s_waitcnt vmcnt(0)
  v_cmp_eq_u32 vcc, 1, v12
  s_cmp_gt_u32 s29, 400000
  s_cbranch_scc1 K4_NOPOLL
  s_cmp_eq_u64 vcc, exec
  s_cbranch_scc0 K4_POLL
  s_branch K4_NOPOLL
K4_NOFLAG:
  s_sub_u32 s28, s3, 1
  s_mul_i32 s28, s28, 12288
  s_add_u32 s29, s28, s20
  s_add_u32 m0, s28, 36864
  s_add_u32 s27, s29, 36864
  buffer_load_dwordx4 v1, s[8:11], s27 offen offset:0 lds
  buffer_load_dwordx4 v1, s[8:11], s27 offen offset:1024 lds
  buffer_load_dwordx4 v1, s[8:11], s27 offen offset:2048 lds
  buffer_load_dwordx4 v1, s[8:11], s27 offen offset:3072 lds
  s_add_u32 m0, s28, 40960
  s_add_u32 s27, s29, 40960
  buffer_load_dwordx4 v1, s[8:11], s27 offen offset:0 lds
  buffer_load_dwordx4 v1, s[8:11], s27 offen offset:1024 lds
  buffer_load_dwordx4 v1, s[8:11], s27 offen offset:2048 lds
  buffer_load_dwordx4 v1, s[8:11], s27 offen offset:3072 lds
  s_add_u32 m0, s28, 45056
  s_add_u32 s27, s29, 45056
  buffer_load_dwordx4 v1, s[8:11], s27 offen offset:0 lds
  buffer_load_dwordx4 v1, s[8:11], s27 offen offset:1024 lds
  buffer_load_dwordx4 v1, s[8:11], s27 offen offset:2048 lds
  buffer_load_dwordx4 v1, s[8:11], s27 offen offset:3072 lds
  s_add_u32 m0, s28, 73728
  s_add_u32 s27, s29, 73728
  buffer_load_dwordx4 v1, s[8:11], s27 offen offset:0 lds
  buffer_load_dwordx4 v1, s[8:11], s27 offen offset:1024 lds
  buffer_load_dwordx4 v1, s[8:11], s27 offen offset:2048 lds
  buffer_load_dwordx4 v1, s[8:11], s27 offen offset:3072 lds
  s_add_u32 m0, s28, 77824
  s_add_u32 s27, s29, 77824
  buffer_load_dwordx4 v1, s[8:11], s27 offen offset:0 lds
  buffer_load_dwordx4 v1, s[8:11], s27 offen offset:1024 lds
  buffer_load_dwordx4 v1, s[8:11], s27 offen offset:2048 lds
  buffer_load_dwordx4 v1, s[8:11], s27 offen offset:3072 lds
  s_add_u32 m0, s28, 81920
  s_add_u32 s27, s29, 81920
  buffer_load_dwordx4 v1, s[8:11], s27 offen offset:0 lds
  buffer_load_dwordx4 v1, s[8:11], s27 offen offset:1024 lds
  buffer_load_dwordx4 v1, s[8:11], s27 offen offset:2048 lds
  buffer_load_dwordx4 v1, s[8:11], s27 offen offset:3072 lds
  v_add_u32 v13, 8192, v13
  v_min_u32 v13, K4_END-PFPC8-4, v13
  global_load_dword v14, v13, s[96:97]
  v_add_u32 v13, 8192, v13
  v_min_u32 v13, K4_END-PFPC8-4, v13
  global_load_dword v14, v13, s[96:97]
  v_add_u32 v13, 8192, v13
  v_min_u32 v13, K4_END-PFPC8-4, v13
  global_load_dword v14, v13, s[96:97]
K4_NOPOLL:
  s_barrier
  s_add_u32 s28, s25, 0
  buffer_load_dwordx4 a[0:3], v1, s[12:15], s28 offen offset:0 sc1
  buffer_load_dwordx4 a[16:19], v1, s[12:15], s28 offen offset:1024 sc1
  s_add_u32 s28, s25, 18432
  buffer_load_dwordx4 a[4:7], v1, s[12:15], s28 offen offset:0 sc1
  buffer_load_dwordx4 a[20:23], v1, s[12:15], s28 offen offset:1024 sc1
  s_add_u32 s28, s25, 36864
  buffer_load_dwordx4 a[8:11], v1, s[12:15], s28 offen offset:0 sc1
  buffer_load_dwordx4 a[24:27], v1, s[12:15], s28 offen offset:1024 sc1
  s_add_u32 s28, s25, 55296
  buffer_load_dwordx4 a[12:15], v1, s[12:15], s28 offen offset:0 sc1
  buffer_load_dwordx4 a[28:31], v1, s[12:15], s28 offen offset:1024 sc1
  s_add_u32 s28, s25, 2048
  buffer_load_dwordx4 a[32:35], v1, s[12:15], s28 offen offset:0 sc1
  buffer_load_dwordx4 a[48:51], v1, s[12:15], s28 offen offset:1024 sc1
  s_add_u32 s28, s25, 20480
  buffer_load_dwordx4 a[36:39], v1, s[12:15], s28 offen offset:0 sc1
  buffer_load_dwordx4 a[52:55], v1, s[12:15], s28 offen offset:1024 sc1
  s_add_u32 s28, s25, 38912
  buffer_load_dwordx4 a[40:43], v1, s[12:15], s28 offen offset:0 sc1
  buffer_load_dwordx4 a[56:59], v1, s[12:15], s28 offen offset:1024 sc1
  s_add_u32 s28, s25, 57344
  buffer_load_dwordx4 a[44:47], v1, s[12:15], s28 offen offset:0 sc1
  buffer_load_dwordx4 a[60:63], v1, s[12:15], s28 offen offset:1024 sc1
  buffer_store_dwordx4 v[84:87], v148, s[16:19], 0 offen sc1
  buffer_store_dwordx4 v[104:107], v149, s[16:19], 0 offen sc1
  buffer_store_dwordx4 v[124:127], v150, s[16:19], 0 offen sc1
  s_add_u32 s16, s4, 27901952
  s_addc_u32 s17, s5, 0
  s_mov_b32 s18, 18874368
  s_mov_b32 s19, 0x20000
  v_add_u32 v2, 0, v1
  v_add_u32 v3, 36864, v1
  v_add_u32 v4, 73728, v1
  v_add_u32 v5, 110592, v1
  v_and_b32 v10, 15, v9
  v_lshrrev_b32 v11, 4, v9
  v_and_b32 v12, 1, v11
  v_add_u32 v12, s45, v12
  v_mul_u32_u24 v12, 144, v12
  v_lshlrev_b32 v12, 10, v12
  v_lshrrev_b32 v11, 1, v11
  v_lshl_add_u32 v10, v11, 4, v10
  v_lshl_add_u32 v6, v10, 4, v12
  s_mul_i32 s26, s6, 4608
  s_mov_b32 s43, 0x409d30fc
  s_waitcnt vmcnt(11)
  s_barrier
  ds_read_b128 v[28:31], v2 offset:0
  ds_read_b128 v[32:35], v2 offset:1024
  ds_read_b128 v[36:39], v3 offset:0
  ds_read_b128 v[40:43], v3 offset:1024
  s_waitcnt lgkmcnt(2)
  v_mfma_f32_16x16x32_bf16 v[84:87], v[28:31], a[0:3], 0
  s_add_u32 s28, s25, 4096
  buffer_load_dwordx4 a[64:67], v1, s[12:15], s28 offen offset:0 sc1
  v_mfma_f32_16x16x32_bf16 v[92:95], v[28:31], a[4:7], 0
  ds_read_b128 v[44:47], v2 offset:2048
  v_mfma_f32_16x16x32_bf16 v[100:103], v[28:31], a[8:11], 0
  v_mfma_f32_16x16x32_bf16 v[108:111], v[28:31], a[12:15], 0
  buffer_load_dwordx4 a[80:83], v1, s[12:15], s28 offen offset:1024 sc1
  v_mfma_f32_16x16x32_bf16 v[88:91], v[32:35], a[0:3], 0
  v_mfma_f32_16x16x32_bf16 v[96:99], v[32:35], a[4:7], 0
  ds_read_b128 v[48:51], v2 offset:3072
  v_mfma_f32_16x16x32_bf16 v[104:107], v[32:35], a[8:11], 0
  v_mfma_f32_16x16x32_bf16 v[112:115], v[32:35], a[12:15], 0
  s_add_u32 s28, s25, 22528
  s_waitcnt lgkmcnt(2)
  v_mfma_f32_16x16x32_bf16 v[116:119], v[36:39], a[0:3], 0
  buffer_load_dwordx4 a[68:71], v1, s[12:15], s28 offen offset:0 sc1
  v_mfma_f32_16x16x32_bf16 v[124:127], v[36:39], a[4:7], 0
  ds_read_b128 v[28:31], v3 offset:2048
  v_mfma_f32_16x16x32_bf16 v[132:135], v[36:39], a[8:11], 0
  v_mfma_f32_16x16x32_bf16 v[140:143], v[36:39], a[12:15], 0
  buffer_load_dwordx4 a[84:87], v1, s[12:15], s28 offen offset:1024 sc1
  v_mfma_f32_16x16x32_bf16 v[120:123], v[40:43], a[0:3], 0
  v_mfma_f32_16x16x32_bf16 v[128:131], v[40:43], a[4:7], 0
  ds_read_b128 v[32:35], v3 offset:3072
  v_mfma_f32_16x16x32_bf16 v[136:139], v[40:43], a[8:11], 0
  v_mfma_f32_16x16x32_bf16 v[144:147], v[40:43], a[12:15], 0
  s_add_u32 s28, s25, 40960
  s_waitcnt lgkmcnt(2)
  v_mfma_f32_16x16x32_bf16 v[84:87], v[44:47], a[16:19], v[84:87]
  buffer_load_dwordx4 a[72:75], v1, s[12:15], s28 offen offset:0 sc1
  v_mfma_f32_16x16x32_bf16 v[92:95], v[44:47], a[20:23], v[92:95]
  ds_read_b128 v[36:39], v2 offset:4096
  v_mfma_f32_16x16x32_bf16 v[100:103], v[44:47], a[24:27], v[100:103]
  v_mfma_f32_16x16x32_bf16 v[108:111], v[44:47], a[28:31], v[108:111]
  buffer_load_dwordx4 a[88:91], v1, s[12:15], s28 offen offset:1024 sc1
  v_mfma_f32_16x16x32_bf16 v[88:91], v[48:51], a[16:19], v[88:91]
  v_mfma_f32_16x16x32_bf16 v[96:99], v[48:51], a[20:23], v[96:99]
  ds_read_b128 v[40:43], v2 offset:5120
  v_mfma_f32_16x16x32_bf16 v[104:107], v[48:51], a[24:27], v[104:107]
  v_mfma_f32_16x16x32_bf16 v[112:115], v[48:51], a[28:31], v[112:115]
  s_add_u32 s28, s25, 59392
  s_waitcnt lgkmcnt(2)
  v_mfma_f32_16x16x32_bf16 v[116:119], v[28:31], a[16:19], v[116:119]
  buffer_load_dwordx4 a[76:79], v1, s[12:15], s28 offen offset:0 sc1
  v_mfma_f32_16x16x32_bf16 v[124:127], v[28:31], a[20:23], v[124:127]
  ds_read_b128 v[44:47], v3 offset:4096
  v_mfma_f32_16x16x32_bf16 v[132:135], v[28:31], a[24:27], v[132:135]
  v_mfma_f32_16x16x32_bf16 v[140:143], v[28:31], a[28:31], v[140:143]
  buffer_load_dwordx4 a[92:95], v1, s[12:15], s28 offen offset:1024 sc1
  v_mfma_f32_16x16x32_bf16 v[120:123], v[32:35], a[16:19], v[120:123]
  v_mfma_f32_16x16x32_bf16 v[128:131], v[32:35], a[20:23], v[128:131]
  ds_read_b128 v[48:51], v3 offset:5120
  v_mfma_f32_16x16x32_bf16 v[136:139], v[32:35], a[24:27], v[136:139]
  v_mfma_f32_16x16x32_bf16 v[144:147], v[32:35], a[28:31], v[144:147]
  s_waitcnt lgkmcnt(2)
  s_waitcnt vmcnt(11)
  v_mfma_f32_16x16x32_bf16 v[84:87], v[36:39], a[32:35], v[84:87]
  s_add_u32 s28, s25, 6144
  buffer_load_dwordx4 a[96:99], v1, s[12:15], s28 offen offset:0 sc1
  v_mfma_f32_16x16x32_bf16 v[92:95], v[36:39], a[36:39], v[92:95]
  ds_read_b128 v[28:31], v2 offset:6144
  v_mfma_f32_16x16x32_bf16 v[100:103], v[36:39], a[40:43], v[100:103]
  v_mfma_f32_16x16x32_bf16 v[108:111], v[36:39], a[44:47], v[108:111]
  buffer_load_dwordx4 a[112:115], v1, s[12:15], s28 offen offset:1024 sc1
  v_mfma_f32_16x16x32_bf16 v[88:91], v[40:43], a[32:35], v[88:91]
  v_mfma_f32_16x16x32_bf16 v[96:99], v[40:43], a[36:39], v[96:99]
  ds_read_b128 v[32:35], v2 offset:7168
  v_mfma_f32_16x16x32_bf16 v[104:107], v[40:43], a[40:43], v[104:107]
  v_mfma_f32_16x16x32_bf16 v[112:115], v[40:43], a[44:47], v[112:115]
  s_add_u32 s28, s25, 24576
  s_waitcnt lgkmcnt(2)
  v_mfma_f32_16x16x32_bf16 v[116:119], v[44:47], a[32:35], v[116:119]
  buffer_load_dwordx4 a[100:103], v1, s[12:15], s28 offen offset:0 sc1
  v_mfma_f32_16x16x32_bf16 v[124:127], v[44:47], a[36:39], v[124:127]
  ds_read_b128 v[36:39], v3 offset:6144
  v_mfma_f32_16x16x32_bf16 v[132:135], v[44:47], a[40:43], v[132:135]
  s_add_u32 s48, s4, 22593536
  s_addc_u32 s49, s5, 0
  v_mfma_f32_16x16x32_bf16 v[140:143], v[44:47], a[44:47], v[140:143]
  buffer_load_dwordx4 a[116:119], v1, s[12:15], s28 offen offset:1024 sc1
  s_mov_b32 s50, 5308416
  v_mfma_f32_16x16x32_bf16 v[120:123], v[48:51], a[32:35], v[120:123]
  s_mov_b32 s51, 0x20000
  s_mov_b32 s52, s46
  v_mfma_f32_16x16x32_bf16 v[128:131], v[48:51], a[36:39], v[128:131]
  ds_read_b128 v[40:43], v3 offset:7168
  s_mov_b32 s53, s47
  v_mfma_f32_16x16x32_bf16 v[136:139], v[48:51], a[40:43], v[136:139]
  s_mov_b32 s54, 5308416
  s_mov_b32 s55, 0x20000
  v_mfma_f32_16x16x32_bf16 v[144:147], v[48:51], a[44:47], v[144:147]
  s_add_u32 s28, s25, 43008
  s_waitcnt lgkmcnt(2)
  v_mfma_f32_16x16x32_bf16 v[84:87], v[28:31], a[48:51], v[84:87]
  buffer_load_dwordx4 a[104:107], v1, s[12:15], s28 offen offset:0 sc1
  s_lshl_b32 s44, s3, 8
  v_mfma_f32_16x16x32_bf16 v[92:95], v[28:31], a[52:55], v[92:95]
  ds_read_b128 v[44:47], v2 offset:8192
  s_add_u32 s44, s44, s2
  v_mfma_f32_16x16x32_bf16 v[100:103], v[28:31], a[56:59], v[100:103]
  s_cmp_ge_u32 s44, 576
  s_cselect_b32 s57, 0x40000000, 0
  v_mfma_f32_16x16x32_bf16 v[108:111], v[28:31], a[60:63], v[108:111]
  buffer_load_dwordx4 a[120:123], v1, s[12:15], s28 offen offset:1024 sc1
  s_mul_i32 s45, s44, 7282
  v_mfma_f32_16x16x32_bf16 v[88:91], v[32:35], a[48:51], v[88:91]
  s_lshr_b32 s45, s45, 20
  s_mul_i32 s56, s45, 144
  v_mfma_f32_16x16x32_bf16 v[96:99], v[32:35], a[52:55], v[96:99]
  ds_read_b128 v[48:51], v2 offset:9216
  s_sub_u32 s56, s44, s56
  v_mfma_f32_16x16x32_bf16 v[104:107], v[32:35], a[56:59], v[104:107]
  s_mul_i32 s45, s45, 288
  s_mul_i32 s44, s44, 9216
  v_mfma_f32_16x16x32_bf16 v[112:115], v[32:35], a[60:63], v[112:115]
  s_add_u32 s28, s25, 61440
  s_waitcnt lgkmcnt(2)
  v_mfma_f32_16x16x32_bf16 v[116:119], v[36:39], a[48:51], v[116:119]
  buffer_load_dwordx4 a[108:111], v1, s[12:15], s28 offen offset:0 sc1
  s_add_u32 s44, s44, s57
  v_mfma_f32_16x16x32_bf16 v[124:127], v[36:39], a[52:55], v[124:127]
  ds_read_b128 v[28:31], v3 offset:8192
  v_and_b32 v212, 15, v9
  v_mfma_f32_16x16x32_bf16 v[132:135], v[36:39], a[56:59], v[132:135]
  v_lshrrev_b32 v213, 4, v9
  v_lshrrev_b32 v214, 1, v213
  v_mfma_f32_16x16x32_bf16 v[140:143], v[36:39], a[60:63], v[140:143]
  buffer_load_dwordx4 a[124:127], v1, s[12:15], s28 offen offset:1024 sc1
  s_lshl_b32 s56, s56, 1
  v_mfma_f32_16x16x32_bf16 v[120:123], v[40:43], a[48:51], v[120:123]
  v_add_u32 v214, s56, v214
  v_lshrrev_b32 v215, 3, v214
  v_mfma_f32_16x16x32_bf16 v[128:131], v[40:43], a[52:55], v[128:131]
  ds_read_b128 v[32:35], v3 offset:9216
  v_lshlrev_b32 v215, 7, v215
  v_mfma_f32_16x16x32_bf16 v[136:139], v[40:43], a[56:59], v[136:139]
  v_and_b32 v214, 7, v214
  v_add_u32 v215, v215, v214
  v_mfma_f32_16x16x32_bf16 v[144:147], v[40:43], a[60:63], v[144:147]
  v_and_b32 v214, 1, v213
  s_waitcnt lgkmcnt(2)
  s_waitcnt vmcnt(8)
  v_mfma_f32_16x16x32_bf16 v[84:87], v[44:47], a[64:67], v[84:87]
  s_add_u32 s28, s25, 8192
  buffer_load_dwordx4 a[128:131], v1, s[12:15], s28 offen offset:0 sc1
  v_mfma_f32_16x16x32_bf16 v[92:95], v[44:47], a[68:71], v[92:95]
  ds_read_b128 v[36:39], v2 offset:10240
  v_lshl_add_u32 v215, v214, 6, v215
  v_mfma_f32_16x16x32_bf16 v[100:103], v[44:47], a[72:75], v[100:103]
  v_mul_u32_u24 v215, 1152, v215
  v_lshl_add_u32 v215, v212, 4, v215
  v_mfma_f32_16x16x32_bf16 v[108:111], v[44:47], a[76:79], v[108:111]
  buffer_load_dwordx4 a[144:147], v1, s[12:15], s28 offen offset:1024 sc1
  v_add_u32 v215, s45, v215
  v_mfma_f32_16x16x32_bf16 v[88:91], v[48:51], a[64:67], v[88:91]
  v_add_u32 v252, s57, v215
  v_add_u32 v253, s44, v1
  v_mfma_f32_16x16x32_bf16 v[96:99], v[48:51], a[68:71], v[96:99]
  ds_read_b128 v[40:43], v2 offset:11264
  s_mov_b32 s58, 0x05040100
  v_mfma_f32_16x16x32_bf16 v[104:107], v[48:51], a[72:75], v[104:107]
  s_mov_b32 s59, 0x07060302
  v_mfma_f32_16x16x32_bf16 v[112:115], v[48:51], a[76:79], v[112:115]
  s_add_u32 s28, s25, 26624
  s_waitcnt lgkmcnt(2)
  v_mfma_f32_16x16x32_bf16 v[116:119], v[28:31], a[64:67], v[116:119]
  buffer_load_dwordx4 a[132:135], v1, s[12:15], s28 offen offset:0 sc1
  v_mfma_f32_16x16x32_bf16 v[124:127], v[28:31], a[68:71], v[124:127]
  ds_read_b128 v[44:47], v3 offset:10240
  v_mfma_f32_16x16x32_bf16 v[132:135], v[28:31], a[72:75], v[132:135]
  v_mfma_f32_16x16x32_bf16 v[140:143], v[28:31], a[76:79], v[140:143]
  buffer_load_dwordx4 a[148:151], v1, s[12:15], s28 offen offset:1024 sc1
  v_mfma_f32_16x16x32_bf16 v[120:123], v[32:35], a[64:67], v[120:123]
  v_mfma_f32_16x16x32_bf16 v[128:131], v[32:35], a[68:71], v[128:131]
  ds_read_b128 v[48:51], v3 offset:11264
  v_mfma_f32_16x16x32_bf16 v[136:139], v[32:35], a[72:75], v[136:139]
  v_mfma_f32_16x16x32_bf16 v[144:147], v[32:35], a[76:79], v[144:147]
  s_add_u32 s28, s25, 45056
  s_waitcnt lgkmcnt(2)
  v_mfma_f32_16x16x32_bf16 v[84:87], v[36:39], a[80:83], v[84:87]
  buffer_load_dwordx4 a[136:139], v1, s[12:15], s28 offen offset:0 sc1
  v_mfma_f32_16x16x32_bf16 v[92:95], v[36:39], a[84:87], v[92:95]
  ds_read_b128 v[28:31], v2 offset:12288
  v_mfma_f32_16x16x32_bf16 v[100:103], v[36:39], a[88:91], v[100:103]
  v_mfma_f32_16x16x32_bf16 v[108:111], v[36:39], a[92:95], v[108:111]
  buffer_load_dwordx4 a[152:155], v1, s[12:15], s28 offen offset:1024 sc1
  v_mfma_f32_16x16x32_bf16 v[88:91], v[40:43], a[80:83], v[88:91]
  v_mfma_f32_16x16x32_bf16 v[96:99], v[40:43], a[84:87], v[96:99]
  ds_read_b128 v[32:35], v2 offset:13312
  v_mfma_f32_16x16x32_bf16 v[104:107], v[40:43], a[88:91], v[104:107]
  v_mfma_f32_16x16x32_bf16 v[112:115], v[40:43], a[92:95], v[112:115]
  s_add_u32 s28, s25, 63488
  s_waitcnt lgkmcnt(2)
  v_mfma_f32_16x16x32_bf16 v[116:119], v[44:47], a[80:83], v[116:119]
  buffer_load_dwordx4 a[140:143], v1, s[12:15], s28 offen offset:0 sc1
  v_mfma_f32_16x16x32_bf16 v[124:127], v[44:47], a[84:87], v[124:127]
  ds_read_b128 v[36:39], v3 offset:12288
  v_mfma_f32_16x16x32_bf16 v[132:135], v[44:47], a[88:91], v[132:135]
  v_mfma_f32_16x16x32_bf16 v[140:143], v[44:47], a[92:95], v[140:143]
  buffer_load_dwordx4 a[156:159], v1, s[12:15], s28 offen offset:1024 sc1
  v_mfma_f32_16x16x32_bf16 v[120:123], v[48:51], a[80:83], v[120:123]
  v_mfma_f32_16x16x32_bf16 v[128:131], v[48:51], a[84:87], v[128:131]
  ds_read_b128 v[40:43], v3 offset:13312
  v_mfma_f32_16x16x32_bf16 v[136:139], v[48:51], a[88:91], v[136:139]
  v_mfma_f32_16x16x32_bf16 v[144:147], v[48:51], a[92:95], v[144:147]
  s_waitcnt lgkmcnt(2)
  s_waitcnt vmcnt(8)
  v_mfma_f32_16x16x32_bf16 v[84:87], v[28:31], a[96:99], v[84:87]
  s_add_u32 s28, s25, 10240
  buffer_load_dwordx4 a[160:163], v1, s[12:15], s28 offen offset:0 sc1
  v_mfma_f32_16x16x32_bf16 v[92:95], v[28:31], a[100:103], v[92:95]
  ds_read_b128 v[44:47], v2 offset:14336
  v_mfma_f32_16x16x32_bf16 v[100:103], v[28:31], a[104:107], v[100:103]
  v_mfma_f32_16x16x32_bf16 v[108:111], v[28:31], a[108:111], v[108:111]
  buffer_load_dwordx4 a[176:179], v1, s[12:15], s28 offen offset:1024 sc1
  v_mfma_f32_16x16x32_bf16 v[88:91], v[32:35], a[96:99], v[88:91]
  v_mfma_f32_16x16x32_bf16 v[96:99], v[32:35], a[100:103], v[96:99]
  ds_read_b128 v[48:51], v2 offset:15360
  v_mfma_f32_16x16x32_bf16 v[104:107], v[32:35], a[104:107], v[104:107]
  v_mfma_f32_16x16x32_bf16 v[112:115], v[32:35], a[108:111], v[112:115]
  s_add_u32 s28, s25, 28672
  s_waitcnt lgkmcnt(2)
  v_mfma_f32_16x16x32_bf16 v[116:119], v[36:39], a[96:99], v[116:119]
  buffer_load_dwordx4 a[164:167], v1, s[12:15], s28 offen offset:0 sc1
  v_mfma_f32_16x16x32_bf16 v[124:127], v[36:39], a[100:103], v[124:127]
  ds_read_b128 v[28:31], v3 offset:14336
  v_mfma_f32_16x16x32_bf16 v[132:135], v[36:39], a[104:107], v[132:135]
  v_mfma_f32_16x16x32_bf16 v[140:143], v[36:39], a[108:111], v[140:143]
  buffer_load_dwordx4 a[180:183], v1, s[12:15], s28 offen offset:1024 sc1
  v_mfma_f32_16x16x32_bf16 v[120:123], v[40:43], a[96:99], v[120:123]
  v_mfma_f32_16x16x32_bf16 v[128:131], v[40:43], a[100:103], v[128:131]
  ds_read_b128 v[32:35], v3 offset:15360
  v_mfma_f32_16x16x32_bf16 v[136:139], v[40:43], a[104:107], v[136:139]
  v_mfma_f32_16x16x32_bf16 v[144:147], v[40:43], a[108:111], v[144:147]
  s_add_u32 s28, s25, 47104
  s_waitcnt lgkmcnt(2)
  v_mfma_f32_16x16x32_bf16 v[84:87], v[44:47], a[112:115], v[84:87]
  buffer_load_dwordx4 a[168:171], v1, s[12:15], s28 offen offset:0 sc1
  v_mfma_f32_16x16x32_bf16 v[92:95], v[44:47], a[116:119], v[92:95]
  ds_read_b128 v[36:39], v2 offset:16384
  v_mfma_f32_16x16x32_bf16 v[100:103], v[44:47], a[120:123], v[100:103]
  v_mfma_f32_16x16x32_bf16 v[108:111], v[44:47], a[124:127], v[108:111]
  buffer_load_dwordx4 a[184:187], v1, s[12:15], s28 offen offset:1024 sc1
  v_mfma_f32_16x16x32_bf16 v[88:91], v[48:51], a[112:115], v[88:91]
  v_mfma_f32_16x16x32_bf16 v[96:99], v[48:51], a[116:119], v[96:99]
  ds_read_b128 v[40:43], v2 offset:17408
  v_mfma_f32_16x16x32_bf16 v[104:107], v[48:51], a[120:123], v[104:107]
  v_mfma_f32_16x16x32_bf16 v[112:115], v[48:51], a[124:127], v[112:115]
  s_add_u32 s28, s25, 65536
  s_waitcnt lgkmcnt(2)
  v_mfma_f32_16x16x32_bf16 v[116:119], v[28:31], a[112:115], v[116:119]
  buffer_load_dwordx4 a[172:175], v1, s[12:15], s28 offen offset:0 sc1
  v_mfma_f32_16x16x32_bf16 v[124:127], v[28:31], a[116:119], v[124:127]
  ds_read_b128 v[44:47], v3 offset:16384
  v_mfma_f32_16x16x32_bf16 v[132:135], v[28:31], a[120:123], v[132:135]
  v_mfma_f32_16x16x32_bf16 v[140:143], v[28:31], a[124:127], v[140:143]
  buffer_load_dwordx4 a[188:191], v1, s[12:15], s28 offen offset:1024 sc1
  v_mfma_f32_16x16x32_bf16 v[120:123], v[32:35], a[112:115], v[120:123]
  v_mfma_f32_16x16x32_bf16 v[128:131], v[32:35], a[116:119], v[128:131]
  ds_read_b128 v[48:51], v3 offset:17408
  v_mfma_f32_16x16x32_bf16 v[136:139], v[32:35], a[120:123], v[136:139]
  v_mfma_f32_16x16x32_bf16 v[144:147], v[32:35], a[124:127], v[144:147]
  s_waitcnt lgkmcnt(2)
  s_waitcnt vmcnt(8)
  v_mfma_f32_16x16x32_bf16 v[84:87], v[36:39], a[128:131], v[84:87]
  s_add_u32 s28, s25, 12288
  buffer_load_dwordx4 a[192:195], v1, s[12:15], s28 offen offset:0 sc1
  v_mfma_f32_16x16x32_bf16 v[92:95], v[36:39], a[132:135], v[92:95]
  ds_read_b128 v[28:31], v2 offset:18432
  v_mfma_f32_16x16x32_bf16 v[100:103], v[36:39], a[136:139], v[100:103]
  v_mfma_f32_16x16x32_bf16 v[108:111], v[36:39], a[140:143], v[108:111]
  buffer_load_dwordx4 a[208:211], v1, s[12:15], s28 offen offset:1024 sc1
  v_mfma_f32_16x16x32_bf16 v[88:91], v[40:43], a[128:131], v[88:91]
  v_mfma_f32_16x16x32_bf16 v[96:99], v[40:43], a[132:135], v[96:99]
  ds_read_b128 v[32:35], v2 offset:19456
  v_mfma_f32_16x16x32_bf16 v[104:107], v[40:43], a[136:139], v[104:107]
  v_mfma_f32_16x16x32_bf16 v[112:115], v[40:43], a[140:143], v[112:115]
  s_add_u32 s28, s25, 30720
  s_waitcnt lgkmcnt(2)
  v_mfma_f32_16x16x32_bf16 v[116:119], v[44:47], a[128:131], v[116:119]
  buffer_load_dwordx4 a[196:199], v1, s[12:15], s28 offen offset:0 sc1
  v_mfma_f32_16x16x32_bf16 v[124:127], v[44:47], a[132:135], v[124:127]
  ds_read_b128 v[36:39], v3 offset:18432
  v_mfma_f32_16x16x32_bf16 v[132:135], v[44:47], a[136:139], v[132:135]
  v_mfma_f32_16x16x32_bf16 v[140:143], v[44:47], a[140:143], v[140:143]
  buffer_load_dwordx4 a[212:215], v1, s[12:15], s28 offen offset:1024 sc1
  v_mfma_f32_16x16x32_bf16 v[120:123], v[48:51], a[128:131], v[120:123]
  v_mfma_f32_16x16x32_bf16 v[128:131], v[48:51], a[132:135], v[128:131]
  ds_read_b128 v[40:43], v3 offset:19456
  v_mfma_f32_16x16x32_bf16 v[136:139], v[48:51], a[136:139], v[136:139]
  v_mfma_f32_16x16x32_bf16 v[144:147], v[48:51], a[140:143], v[144:147]
  s_add_u32 s28, s25, 49152
  s_waitcnt lgkmcnt(2)
  v_mfma_f32_16x16x32_bf16 v[84:87], v[28:31], a[144:147], v[84:87]
  buffer_load_dwordx4 a[200:203], v1, s[12:15], s28 offen offset:0 sc1
  v_mfma_f32_16x16x32_bf16 v[92:95], v[28:31], a[148:151], v[92:95]
  ds_read_b128 v[44:47], v2 offset:20480
  v_mfma_f32_16x16x32_bf16 v[100:103], v[28:31], a[152:155], v[100:103]
  v_mfma_f32_16x16x32_bf16 v[108:111], v[28:31], a[156:159], v[108:111]
  buffer_load_dwordx4 a[216:219], v1, s[12:15], s28 offen offset:1024 sc1
  v_mfma_f32_16x16x32_bf16 v[88:91], v[32:35], a[144:147], v[88:91]
  v_mfma_f32_16x16x32_bf16 v[96:99], v[32:35], a[148:151], v[96:99]
  ds_read_b128 v[48:51], v2 offset:21504
  v_mfma_f32_16x16x32_bf16 v[104:107], v[32:35], a[152:155], v[104:107]
  v_mfma_f32_16x16x32_bf16 v[112:115], v[32:35], a[156:159], v[112:115]
  s_add_u32 s28, s25, 67584
  s_waitcnt lgkmcnt(2)
  v_mfma_f32_16x16x32_bf16 v[116:119], v[36:39], a[144:147], v[116:119]
  buffer_load_dwordx4 a[204:207], v1, s[12:15], s28 offen offset:0 sc1
  v_mfma_f32_16x16x32_bf16 v[124:127], v[36:39], a[148:151], v[124:127]
  ds_read_b128 v[28:31], v3 offset:20480
  v_mfma_f32_16x16x32_bf16 v[132:135], v[36:39], a[152:155], v[132:135]
  v_mfma_f32_16x16x32_bf16 v[140:143], v[36:39], a[156:159], v[140:143]
  buffer_load_dwordx4 a[220:223], v1, s[12:15], s28 offen offset:1024 sc1
  v_mfma_f32_16x16x32_bf16 v[120:123], v[40:43], a[144:147], v[120:123]
  v_mfma_f32_16x16x32_bf16 v[128:131], v[40:43], a[148:151], v[128:131]
  ds_read_b128 v[32:35], v3 offset:21504
  v_mfma_f32_16x16x32_bf16 v[136:139], v[40:43], a[152:155], v[136:139]
  v_mfma_f32_16x16x32_bf16 v[144:147], v[40:43], a[156:159], v[144:147]
  s_waitcnt lgkmcnt(2)
  s_waitcnt vmcnt(8)
  v_mfma_f32_16x16x32_bf16 v[84:87], v[44:47], a[160:163], v[84:87]
  s_add_u32 s28, s25, 14336
  buffer_load_dwordx4 a[224:227], v1, s[12:15], s28 offen offset:0 sc1
  v_mfma_f32_16x16x32_bf16 v[92:95], v[44:47], a[164:167], v[92:95]
  ds_read_b128 v[36:39], v2 offset:22528
  v_mfma_f32_16x16x32_bf16 v[100:103], v[44:47], a[168:171], v[100:103]
  v_mfma_f32_16x16x32_bf16 v[108:111], v[44:47], a[172:175], v[108:111]
  buffer_load_dwordx4 a[240:243], v1, s[12:15], s28 offen offset:1024 sc1
  v_mfma_f32_16x16x32_bf16 v[88:91], v[48:51], a[160:163], v[88:91]
  v_mfma_f32_16x16x32_bf16 v[96:99], v[48:51], a[164:167], v[96:99]
  ds_read_b128 v[40:43], v2 offset:23552
  v_mfma_f32_16x16x32_bf16 v[104:107], v[48:51], a[168:171], v[104:107]
  v_mfma_f32_16x16x32_bf16 v[112:115], v[48:51], a[172:175], v[112:115]
  s_add_u32 s28, s25, 32768
  s_waitcnt lgkmcnt(2)
  v_mfma_f32_16x16x32_bf16 v[116:119], v[28:31], a[160:163], v[116:119]
  buffer_load_dwordx4 a[228:231], v1, s[12:15], s28 offen offset:0 sc1
  v_mfma_f32_16x16x32_bf16 v[124:127], v[28:31], a[164:167], v[124:127]
  ds_read_b128 v[44:47], v3 offset:22528
  v_mfma_f32_16x16x32_bf16 v[132:135], v[28:31], a[168:171], v[132:135]
  v_mfma_f32_16x16x32_bf16 v[140:143], v[28:31], a[172:175], v[140:143]
  buffer_load_dwordx4 a[244:247], v1, s[12:15], s28 offen offset:1024 sc1
  v_mfma_f32_16x16x32_bf16 v[120:123], v[32:35], a[160:163], v[120:123]
  v_mfma_f32_16x16x32_bf16 v[128:131], v[32:35], a[164:167], v[128:131]
  ds_read_b128 v[48:51], v3 offset:23552
  v_mfma_f32_16x16x32_bf16 v[136:139], v[32:35], a[168:171], v[136:139]
  v_mfma_f32_16x16x32_bf16 v[144:147], v[32:35], a[172:175], v[144:147]
  s_add_u32 s28, s25, 51200
  s_waitcnt lgkmcnt(2)
  v_mfma_f32_16x16x32_bf16 v[84:87], v[36:39], a[176:179], v[84:87]
  buffer_load_dwordx4 a[232:235], v1, s[12:15], s28 offen offset:0 sc1
  v_mfma_f32_16x16x32_bf16 v[92:95], v[36:39], a[180:183], v[92:95]
  ds_read_b128 v[28:31], v2 offset:24576
  v_mfma_f32_16x16x32_bf16 v[100:103], v[36:39], a[184:187], v[100:103]
  v_mfma_f32_16x16x32_bf16 v[108:111], v[36:39], a[188:191], v[108:111]
  buffer_load_dwordx4 a[248:251], v1, s[12:15], s28 offen offset:1024 sc1
  v_mfma_f32_16x16x32_bf16 v[88:91], v[40:43], a[176:179], v[88:91]
  v_mfma_f32_16x16x32_bf16 v[96:99], v[40:43], a[180:183], v[96:99]
  ds_read_b128 v[32:35], v2 offset:25600
  v_mfma_f32_16x16x32_bf16 v[104:107], v[40:43], a[184:187], v[104:107]
  v_mfma_f32_16x16x32_bf16 v[112:115], v[40:43], a[188:191], v[112:115]
  s_add_u32 s28, s25, 69632
  s_waitcnt lgkmcnt(2)
  v_mfma_f32_16x16x32_bf16 v[116:119], v[44:47], a[176:179], v[116:119]
  buffer_load_dwordx4 a[236:239], v1, s[12:15], s28 offen offset:0 sc1
  v_mfma_f32_16x16x32_bf16 v[124:127], v[44:47], a[180:183], v[124:127]
  ds_read_b128 v[36:39], v3 offset:24576
  v_mfma_f32_16x16x32_bf16 v[132:135], v[44:47], a[184:187], v[132:135]
  v_mfma_f32_16x16x32_bf16 v[140:143], v[44:47], a[188:191], v[140:143]
  buffer_load_dwordx4 a[252:255], v1, s[12:15], s28 offen offset:1024 sc1
  v_mfma_f32_16x16x32_bf16 v[120:123], v[48:51], a[176:179], v[120:123]
  v_mfma_f32_16x16x32_bf16 v[128:131], v[48:51], a[180:183], v[128:131]
  ds_read_b128 v[40:43], v3 offset:25600
  v_mfma_f32_16x16x32_bf16 v[136:139], v[48:51], a[184:187], v[136:139]
  v_mfma_f32_16x16x32_bf16 v[144:147], v[48:51], a[188:191], v[144:147]
  s_waitcnt lgkmcnt(2)
  s_waitcnt vmcnt(8)
  v_mfma_f32_16x16x32_bf16 v[84:87], v[28:31], a[192:195], v[84:87]
  s_add_u32 s28, s25, 16384
  buffer_load_dwordx4 v[52:55], v1, s[12:15], s28 offen offset:0 sc1
  v_mfma_f32_16x16x32_bf16 v[92:95], v[28:31], a[196:199], v[92:95]
  ds_read_b128 v[44:47], v2 offset:26624
  v_mfma_f32_16x16x32_bf16 v[100:103], v[28:31], a[200:203], v[100:103]
  v_mfma_f32_16x16x32_bf16 v[108:111], v[28:31], a[204:207], v[108:111]
  buffer_load_dwordx4 v[68:71], v1, s[12:15], s28 offen offset:1024 sc1
  v_mfma_f32_16x16x32_bf16 v[88:91], v[32:35], a[192:195], v[88:91]
  v_mfma_f32_16x16x32_bf16 v[96:99], v[32:35], a[196:199], v[96:99]
  ds_read_b128 v[48:51], v2 offset:27648
  v_mfma_f32_16x16x32_bf16 v[104:107], v[32:35], a[200:203], v[104:107]
  v_mfma_f32_16x16x32_bf16 v[112:115], v[32:35], a[204:207], v[112:115]
  s_add_u32 s28, s25, 34816
  s_waitcnt lgkmcnt(2)
  v_mfma_f32_16x16x32_bf16 v[116:119], v[36:39], a[192:195], v[116:119]
  buffer_load_dwordx4 v[56:59], v1, s[12:15], s28 offen offset:0 sc1
  v_mfma_f32_16x16x32_bf16 v[124:127], v[36:39], a[196:199], v[124:127]
  ds_read_b128 v[28:31], v3 offset:26624
  v_mfma_f32_16x16x32_bf16 v[132:135], v[36:39], a[200:203], v[132:135]
  v_mfma_f32_16x16x32_bf16 v[140:143], v[36:39], a[204:207], v[140:143]
  buffer_load_dwordx4 v[72:75], v1, s[12:15], s28 offen offset:1024 sc1
  v_mfma_f32_16x16x32_bf16 v[120:123], v[40:43], a[192:195], v[120:123]
  v_mfma_f32_16x16x32_bf16 v[128:131], v[40:43], a[196:199], v[128:131]
  ds_read_b128 v[32:35], v3 offset:27648
  v_mfma_f32_16x16x32_bf16 v[136:139], v[40:43], a[200:203], v[136:139]
  v_mfma_f32_16x16x32_bf16 v[144:147], v[40:43], a[204:207], v[144:147]
  s_add_u32 s28, s25, 53248
  s_waitcnt lgkmcnt(2)
  v_mfma_f32_16x16x32_bf16 v[84:87], v[44:47], a[208:211], v[84:87]
  buffer_load_dwordx4 v[60:63], v1, s[12:15], s28 offen offset:0 sc1
  v_mfma_f32_16x16x32_bf16 v[92:95], v[44:47], a[212:215], v[92:95]
  ds_read_b128 v[36:39], v2 offset:28672
  v_mfma_f32_16x16x32_bf16 v[100:103], v[44:47], a[216:219], v[100:103]
  v_mfma_f32_16x16x32_bf16 v[108:111], v[44:47], a[220:223], v[108:111]
  buffer_load_dwordx4 v[76:79], v1, s[12:15], s28 offen offset:1024 sc1
  v_mfma_f32_16x16x32_bf16 v[88:91], v[48:51], a[208:211], v[88:91]
  v_mfma_f32_16x16x32_bf16 v[96:99], v[48:51], a[212:215], v[96:99]
  ds_read_b128 v[40:43], v2 offset:29696
  v_mfma_f32_16x16x32_bf16 v[104:107], v[48:51], a[216:219], v[104:107]
  v_mfma_f32_16x16x32_bf16 v[112:115], v[48:51], a[220:223], v[112:115]
  s_add_u32 s28, s25, 71680
  s_waitcnt lgkmcnt(2)
  v_mfma_f32_16x16x32_bf16 v[116:119], v[28:31], a[208:211], v[116:119]
  buffer_load_dwordx4 v[64:67], v1, s[12:15], s28 offen offset:0 sc1
  v_mfma_f32_16x16x32_bf16 v[124:127], v[28:31], a[212:215], v[124:127]
  ds_read_b128 v[44:47], v3 offset:28672
  v_mfma_f32_16x16x32_bf16 v[132:135], v[28:31], a[216:219], v[132:135]
  v_mfma_f32_16x16x32_bf16 v[140:143], v[28:31], a[220:223], v[140:143]
  buffer_load_dwordx4 v[80:83], v1, s[12:15], s28 offen offset:1024 sc1
  v_mfma_f32_16x16x32_bf16 v[120:123], v[32:35], a[208:211], v[120:123]
  v_mfma_f32_16x16x32_bf16 v[128:131], v[32:35], a[212:215], v[128:131]
  ds_read_b128 v[48:51], v3 offset:29696
  v_mfma_f32_16x16x32_bf16 v[136:139], v[32:35], a[216:219], v[136:139]
  v_mfma_f32_16x16x32_bf16 v[144:147], v[32:35], a[220:223], v[144:147]
  s_waitcnt lgkmcnt(2)
  s_waitcnt vmcnt(8)
  v_mfma_f32_16x16x32_bf16 v[84:87], v[36:39], a[224:227], v[84:87]
  v_mfma_f32_16x16x32_bf16 v[92:95], v[36:39], a[228:231], v[92:95]
  ds_read_b128 v[28:31], v2 offset:30720
  v_mfma_f32_16x16x32_bf16 v[100:103], v[36:39], a[232:235], v[100:103]
  v_mfma_f32_16x16x32_bf16 v[108:111], v[36:39], a[236:239], v[108:111]
  v_mfma_f32_16x16x32_bf16 v[88:91], v[40:43], a[224:227], v[88:91]
  v_mfma_f32_16x16x32_bf16 v[96:99], v[40:43], a[228:231], v[96:99]
  ds_read_b128 v[32:35], v2 offset:31744
  v_mfma_f32_16x16x32_bf16 v[104:107], v[40:43], a[232:235], v[104:107]
  v_mfma_f32_16x16x32_bf16 v[112:115], v[40:43], a[236:239], v[112:115]
  s_waitcnt lgkmcnt(2)
  v_mfma_f32_16x16x32_bf16 v[116:119], v[44:47], a[224:227], v[116:119]
  v_mfma_f32_16x16x32_bf16 v[124:127], v[44:47], a[228:231], v[124:127]
  ds_read_b128 v[36:39], v3 offset:30720
  v_mfma_f32_16x16x32_bf16 v[132:135], v[44:47], a[232:235], v[132:135]
  v_mfma_f32_16x16x32_bf16 v[140:143], v[44:47], a[236:239], v[140:143]
  v_mfma_f32_16x16x32_bf16 v[120:123], v[48:51], a[224:227], v[120:123]
  v_mfma_f32_16x16x32_bf16 v[128:131], v[48:51], a[228:231], v[128:131]
  ds_read_b128 v[40:43], v3 offset:31744
  v_mfma_f32_16x16x32_bf16 v[136:139], v[48:51], a[232:235], v[136:139]
  v_mfma_f32_16x16x32_bf16 v[144:147], v[48:51], a[236:239], v[144:147]
  s_waitcnt lgkmcnt(2)
  v_mfma_f32_16x16x32_bf16 v[84:87], v[28:31], a[240:243], v[84:87]
  v_mfma_f32_16x16x32_bf16 v[92:95], v[28:31], a[244:247], v[92:95]
  ds_read_b128 v[44:47], v2 offset:32768
  v_mfma_f32_16x16x32_bf16 v[100:103], v[28:31], a[248:251], v[100:103]
  v_mfma_f32_16x16x32_bf16 v[108:111], v[28:31], a[252:255], v[108:111]
  v_mfma_f32_16x16x32_bf16 v[88:91], v[32:35], a[240:243], v[88:91]
  v_mfma_f32_16x16x32_bf16 v[96:99], v[32:35], a[244:247], v[96:99]
  ds_read_b128 v[48:51], v2 offset:33792
  v_mfma_f32_16x16x32_bf16 v[104:107], v[32:35], a[248:251], v[104:107]
  v_mfma_f32_16x16x32_bf16 v[112:115], v[32:35], a[252:255], v[112:115]
  s_waitcnt lgkmcnt(2)
  v_mfma_f32_16x16x32_bf16 v[116:119], v[36:39], a[240:243], v[116:119]
  v_mfma_f32_16x16x32_bf16 v[124:127], v[36:39], a[244:247], v[124:127]
  ds_read_b128 v[28:31], v3 offset:32768
  v_mfma_f32_16x16x32_bf16 v[132:135], v[36:39], a[248:251], v[132:135]
  v_mfma_f32_16x16x32_bf16 v[140:143], v[36:39], a[252:255], v[140:143]
  v_mfma_f32_16x16x32_bf16 v[120:123], v[40:43], a[240:243], v[120:123]
  v_mfma_f32_16x16x32_bf16 v[128:131], v[40:43], a[244:247], v[128:131]
  ds_read_b128 v[32:35], v3 offset:33792
  v_mfma_f32_16x16x32_bf16 v[136:139], v[40:43], a[248:251], v[136:139]
  v_mfma_f32_16x16x32_bf16 v[144:147], v[40:43], a[252:255], v[144:147]
  s_waitcnt lgkmcnt(2)
  s_waitcnt vmcnt(0)
  v_mfma_f32_16x16x32_bf16 v[84:87], v[44:47], v[52:55], v[84:87]
  v_mfma_f32_16x16x32_bf16 v[92:95], v[44:47], v[56:59], v[92:95]
  ds_read_b128 v[36:39], v2 offset:34816
  v_mfma_f32_16x16x32_bf16 v[100:103], v[44:47], v[60:63], v[100:103]
  v_mfma_f32_16x16x32_bf16 v[108:111], v[44:47], v[64:67], v[108:111]
  v_mfma_f32_16x16x32_bf16 v[88:91], v[48:51], v[52:55], v[88:91]
  v_mfma_f32_16x16x32_bf16 v[96:99], v[48:51], v[56:59], v[96:99]
  ds_read_b128 v[40:43], v2 offset:35840
  v_mfma_f32_16x16x32_bf16 v[104:107], v[48:51], v[60:63], v[104:107]
  v_mfma_f32_16x16x32_bf16 v[112:115], v[48:51], v[64:67], v[112:115]
  s_waitcnt lgkmcnt(2)
  v_mfma_f32_16x16x32_bf16 v[116:119], v[28:31], v[52:55], v[116:119]
  v_mfma_f32_16x16x32_bf16 v[124:127], v[28:31], v[56:59], v[124:127]
  ds_read_b128 v[44:47], v3 offset:34816
  v_mfma_f32_16x16x32_bf16 v[132:135], v[28:31], v[60:63], v[132:135]
  v_mfma_f32_16x16x32_bf16 v[140:143], v[28:31], v[64:67], v[140:143]
  v_mfma_f32_16x16x32_bf16 v[120:123], v[32:35], v[52:55], v[120:123]
  v_mfma_f32_16x16x32_bf16 v[128:131], v[32:35], v[56:59], v[128:131]
  ds_read_b128 v[48:51], v3 offset:35840
  v_mfma_f32_16x16x32_bf16 v[136:139], v[32:35], v[60:63], v[136:139]
  v_mfma_f32_16x16x32_bf16 v[144:147], v[32:35], v[64:67], v[144:147]
  s_waitcnt lgkmcnt(2)
  s_waitcnt lgkmcnt(0)
  s_barrier
  v_mfma_f32_16x16x32_bf16 v[84:87], v[36:39], v[68:71], v[84:87]
  s_add_u32 m0, s23, 110592
  s_add_u32 s27, s24, 110592
  v_mfma_f32_16x16x32_bf16 v[92:95], v[36:39], v[72:75], v[92:95]
  ds_read_b128 v[28:31], v4 offset:0
  buffer_load_dwordx4 v1, s[8:11], s27 offen offset:0 lds
  v_mfma_f32_16x16x32_bf16 v[100:103], v[36:39], v[76:79], v[100:103]
  v_mfma_f32_16x16x32_bf16 v[108:111], v[36:39], v[80:83], v[108:111]
  v_mfma_f32_16x16x32_bf16 v[88:91], v[40:43], v[68:71], v[88:91]
  v_mfma_f32_16x16x32_bf16 v[96:99], v[40:43], v[72:75], v[96:99]
  ds_read_b128 v[32:35], v4 offset:1024
  v_mfma_f32_16x16x32_bf16 v[104:107], v[40:43], v[76:79], v[104:107]
  v_mfma_f32_16x16x32_bf16 v[112:115], v[40:43], v[80:83], v[112:115]
  s_waitcnt lgkmcnt(2)
  v_mfma_f32_16x16x32_bf16 v[116:119], v[44:47], v[68:71], v[116:119]
  v_mfma_f32_16x16x32_bf16 v[124:127], v[44:47], v[72:75], v[124:127]
  ds_read_b128 v[36:39], v4 offset:2048
  buffer_load_dwordx4 v1, s[8:11], s27 offen offset:1024 lds
  v_mfma_f32_16x16x32_bf16 v[132:135], v[44:47], v[76:79], v[132:135]
  v_mfma_f32_16x16x32_bf16 v[140:143], v[44:47], v[80:83], v[140:143]
  v_mfma_f32_16x16x32_bf16 v[120:123], v[48:51], v[68:71], v[120:123]
  v_mfma_f32_16x16x32_bf16 v[128:131], v[48:51], v[72:75], v[128:131]
  ds_read_b128 v[40:43], v4 offset:3072
  v_mfma_f32_16x16x32_bf16 v[136:139], v[48:51], v[76:79], v[136:139]
  v_mfma_f32_16x16x32_bf16 v[144:147], v[48:51], v[80:83], v[144:147]
  s_waitcnt lgkmcnt(2)
  v_mfma_f32_16x16x32_bf16 v[148:151], v[28:31], a[0:3], 0
  v_mfma_f32_16x16x32_bf16 v[156:159], v[28:31], a[4:7], 0
  ds_read_b128 v[44:47], v4 offset:4096
  v_mfma_f32_16x16x32_bf16 v[164:167], v[28:31], a[8:11], 0
  v_mfma_f32_16x16x32_bf16 v[172:175], v[28:31], a[12:15], 0
  buffer_load_dwordx4 v1, s[8:11], s27 offen offset:2048 lds
  v_mfma_f32_16x16x32_bf16 v[152:155], v[32:35], a[0:3], 0
  v_mfma_f32_16x16x32_bf16 v[160:163], v[32:35], a[4:7], 0
  ds_read_b128 v[48:51], v4 offset:5120
  v_mfma_f32_16x16x32_bf16 v[168:171], v[32:35], a[8:11], 0
  v_mfma_f32_16x16x32_bf16 v[176:179], v[32:35], a[12:15], 0
  v_fma_f32 v20, v84, v84, s43
  s_waitcnt lgkmcnt(2)
  v_mfma_f32_16x16x32_bf16 v[148:151], v[36:39], a[16:19], v[148:151]
  v_fma_f32 v21, v85, v85, s43
  v_fma_f32 v22, v86, v86, s43
  v_mfma_f32_16x16x32_bf16 v[156:159], v[36:39], a[20:23], v[156:159]
  ds_read_b128 v[28:31], v4 offset:6144
  v_fma_f32 v23, v87, v87, s43
  v_mfma_f32_16x16x32_bf16 v[164:167], v[36:39], a[24:27], v[164:167]
  v_fma_f32 v24, v92, v92, s43
  v_fma_f32 v25, v93, v93, s43
  v_mfma_f32_16x16x32_bf16 v[172:175], v[36:39], a[28:31], v[172:175]
  v_fma_f32 v26, v94, v94, s43
  v_fma_f32 v27, v95, v95, s43
  v_mfma_f32_16x16x32_bf16 v[152:155], v[40:43], a[16:19], v[152:155]
  v_mul_f32 v20, v20, v84
  v_mul_f32 v21, v21, v85
  v_mfma_f32_16x16x32_bf16 v[160:163], v[40:43], a[20:23], v[160:163]
  ds_read_b128 v[32:35], v4 offset:7168
  buffer_load_dwordx4 v1, s[8:11], s27 offen offset:3072 lds
  v_mfma_f32_16x16x32_bf16 v[168:171], v[40:43], a[24:27], v[168:171]
  v_mul_f32 v22, v22, v86
  v_mul_f32 v23, v23, v87
  v_mfma_f32_16x16x32_bf16 v[176:179], v[40:43], a[28:31], v[176:179]
  v_mul_f32 v24, v24, v92
  s_waitcnt lgkmcnt(2)
  v_mfma_f32_16x16x32_bf16 v[148:151], v[44:47], a[32:35], v[148:151]
  v_mul_f32 v25, v25, v93
  v_mul_f32 v26, v26, v94
  v_mfma_f32_16x16x32_bf16 v[156:159], v[44:47], a[36:39], v[156:159]
  ds_read_b128 v[36:39], v4 offset:8192
  v_mul_f32 v27, v27, v95
  v_mfma_f32_16x16x32_bf16 v[164:167], v[44:47], a[40:43], v[164:167]
  v_exp_f32_e64 v20, -v20
  v_mfma_f32_16x16x32_bf16 v[172:175], v[44:47], a[44:47], v[172:175]
  v_mul_f32 v88, v84, v88
  v_mfma_f32_16x16x32_bf16 v[152:155], v[48:51], a[32:35], v[152:155]
  v_exp_f32_e64 v21, -v21
  v_mfma_f32_16x16x32_bf16 v[160:163], v[48:51], a[36:39], v[160:163]
  ds_read_b128 v[40:43], v4 offset:9216
  v_mul_f32 v89, v85, v89
  v_mfma_f32_16x16x32_bf16 v[168:171], v[48:51], a[40:43], v[168:171]
  v_exp_f32_e64 v22, -v22
  v_mfma_f32_16x16x32_bf16 v[176:179], v[48:51], a[44:47], v[176:179]
  s_add_u32 m0, s23, 114688
  s_waitcnt lgkmcnt(2)
  v_mfma_f32_16x16x32_bf16 v[148:151], v[28:31], a[48:51], v[148:151]
  s_add_u32 s27, s24, 114688
  buffer_load_dwordx4 v1, s[8:11], s27 offen offset:0 lds
  v_mfma_f32_16x16x32_bf16 v[156:159], v[28:31], a[52:55], v[156:159]
  ds_read_b128 v[44:47], v4 offset:10240
  v_mul_f32 v90, v86, v90
  v_mfma_f32_16x16x32_bf16 v[164:167], v[28:31], a[56:59], v[164:167]
  v_exp_f32_e64 v23, -v23
  v_mfma_f32_16x16x32_bf16 v[172:175], v[28:31], a[60:63], v[172:175]
  v_mul_f32 v91, v87, v91
  v_mfma_f32_16x16x32_bf16 v[152:155], v[32:35], a[48:51], v[152:155]
  v_exp_f32_e64 v24, -v24
  v_mfma_f32_16x16x32_bf16 v[160:163], v[32:35], a[52:55], v[160:163]
  ds_read_b128 v[48:51], v4 offset:11264
  v_mul_f32 v96, v92, v96
  v_mfma_f32_16x16x32_bf16 v[168:171], v[32:35], a[56:59], v[168:171]
  v_exp_f32_e64 v25, -v25
  v_mfma_f32_16x16x32_bf16 v[176:179], v[32:35], a[60:63], v[176:179]
  v_mul_f32 v97, v93, v97
  s_waitcnt lgkmcnt(2)
  v_mfma_f32_16x16x32_bf16 v[148:151], v[36:39], a[64:67], v[148:151]
  v_exp_f32_e64 v26, -v26
  v_mfma_f32_16x16x32_bf16 v[156:159], v[36:39], a[68:71], v[156:159]
  ds_read_b128 v[28:31], v4 offset:12288
  buffer_load_dwordx4 v1, s[8:11], s27 offen offset:1024 lds
  v_mfma_f32_16x16x32_bf16 v[164:167], v[36:39], a[72:75], v[164:167]
  v_mul_f32 v98, v94, v98
  v_mfma_f32_16x16x32_bf16 v[172:175], v[36:39], a[76:79], v[172:175]
  v_exp_f32_e64 v27, -v27
  v_mfma_f32_16x16x32_bf16 v[152:155], v[40:43], a[64:67], v[152:155]
  v_mul_f32 v99, v95, v99
  v_add_f32 v20, 1.0, v20
  v_mfma_f32_16x16x32_bf16 v[160:163], v[40:43], a[68:71], v[160:163]
  ds_read_b128 v[32:35], v4 offset:13312
  v_add_f32 v21, 1.0, v21
  v_mfma_f32_16x16x32_bf16 v[168:171], v[40:43], a[72:75], v[168:171]
  v_add_f32 v22, 1.0, v22
  v_add_f32 v23, 1.0, v23
  v_mfma_f32_16x16x32_bf16 v[176:179], v[40:43], a[76:79], v[176:179]
  v_add_f32 v24, 1.0, v24
  s_waitcnt lgkmcnt(2)
  v_mfma_f32_16x16x32_bf16 v[148:151], v[44:47], a[80:83], v[148:151]
  v_add_f32 v25, 1.0, v25
  v_add_f32 v26, 1.0, v26
  v_mfma_f32_16x16x32_bf16 v[156:159], v[44:47], a[84:87], v[156:159]
  ds_read_b128 v[36:39], v4 offset:14336
  v_add_f32 v27, 1.0, v27
  v_mfma_f32_16x16x32_bf16 v[164:167], v[44:47], a[88:91], v[164:167]
  v_rcp_f32 v20, v20
  v_mfma_f32_16x16x32_bf16 v[172:175], v[44:47], a[92:95], v[172:175]
  buffer_load_dwordx4 v1, s[8:11], s27 offen offset:2048 lds
  v_mfma_f32_16x16x32_bf16 v[152:155], v[48:51], a[80:83], v[152:155]
  v_rcp_f32 v21, v21
  v_mfma_f32_16x16x32_bf16 v[160:163], v[48:51], a[84:87], v[160:163]
  ds_read_b128 v[40:43], v4 offset:15360
  v_mfma_f32_16x16x32_bf16 v[168:171], v[48:51], a[88:91], v[168:171]
  v_rcp_f32 v22, v22
  v_mfma_f32_16x16x32_bf16 v[176:179], v[48:51], a[92:95], v[176:179]
  s_waitcnt lgkmcnt(2)
  v_mfma_f32_16x16x32_bf16 v[148:151], v[28:31], a[96:99], v[148:151]
  v_rcp_f32 v23, v23
  v_mfma_f32_16x16x32_bf16 v[156:159], v[28:31], a[100:103], v[156:159]
  ds_read_b128 v[44:47], v4 offset:16384
  v_mfma_f32_16x16x32_bf16 v[164:167], v[28:31], a[104:107], v[164:167]
  v_rcp_f32 v24, v24
  v_mfma_f32_16x16x32_bf16 v[172:175], v[28:31], a[108:111], v[172:175]
  v_rcp_f32 v25, v25
  v_mfma_f32_16x16x32_bf16 v[152:155], v[32:35], a[96:99], v[152:155]
  v_rcp_f32 v26, v26
  v_mfma_f32_16x16x32_bf16 v[160:163], v[32:35], a[100:103], v[160:163]
  ds_read_b128 v[48:51], v4 offset:17408
  buffer_load_dwordx4 v1, s[8:11], s27 offen offset:3072 lds
  v_mfma_f32_16x16x32_bf16 v[168:171], v[32:35], a[104:107], v[168:171]
  v_rcp_f32 v27, v27
  v_mfma_f32_16x16x32_bf16 v[176:179], v[32:35], a[108:111], v[176:179]
  v_mul_f32 v88, v88, v20
  s_waitcnt lgkmcnt(2)
  v_mfma_f32_16x16x32_bf16 v[148:151], v[36:39], a[112:115], v[148:151]
  v_mul_f32 v89, v89, v21
  v_mul_f32 v90, v90, v22
  v_mfma_f32_16x16x32_bf16 v[156:159], v[36:39], a[116:119], v[156:159]
  ds_read_b128 v[28:31], v4 offset:18432
  v_mul_f32 v91, v91, v23
  v_mfma_f32_16x16x32_bf16 v[164:167], v[36:39], a[120:123], v[164:167]
  v_mul_f32 v96, v96, v24
  v_mul_f32 v97, v97, v25
  v_mfma_f32_16x16x32_bf16 v[172:175], v[36:39], a[124:127], v[172:175]
  v_mul_f32 v98, v98, v26
  v_mul_f32 v99, v99, v27
  v_mfma_f32_16x16x32_bf16 v[152:155], v[40:43], a[112:115], v[152:155]
  v_cvt_pk_bf16_f32 v12, v88, v89
  v_cvt_pk_bf16_f32 v13, v90, v91
  v_mfma_f32_16x16x32_bf16 v[160:163], v[40:43], a[116:119], v[160:163]
  ds_read_b128 v[32:35], v4 offset:19456
  v_cvt_pk_bf16_f32 v14, v96, v97
  v_mfma_f32_16x16x32_bf16 v[168:171], v[40:43], a[120:123], v[168:171]
  v_cvt_pk_bf16_f32 v15, v98, v99
  s_add_u32 s29, s26, 0
  v_mfma_f32_16x16x32_bf16 v[176:179], v[40:43], a[124:127], v[176:179]
  s_add_u32 m0, s23, 118784
  s_waitcnt lgkmcnt(2)
  v_mfma_f32_16x16x32_bf16 v[148:151], v[44:47], a[128:131], v[148:151]
  s_add_u32 s27, s24, 118784
  buffer_load_dwordx4 v1, s[8:11], s27 offen offset:0 lds
  v_mfma_f32_16x16x32_bf16 v[156:159], v[44:47], a[132:135], v[156:159]
  ds_read_b128 v[36:39], v4 offset:20480
  s_nop 0
  v_mfma_f32_16x16x32_bf16 v[164:167], v[44:47], a[136:139], v[164:167]
  v_permlane16_swap_b32 v12, v14
  v_permlane16_swap_b32 v13, v15
  v_mfma_f32_16x16x32_bf16 v[172:175], v[44:47], a[140:143], v[172:175]
  buffer_store_dwordx4 v[12:15], v6, s[16:19], s29 offen sc1
  v_fma_f32 v20, v100, v100, s43
  v_mfma_f32_16x16x32_bf16 v[152:155], v[48:51], a[128:131], v[152:155]
  v_fma_f32 v21, v101, v101, s43
  v_fma_f32 v22, v102, v102, s43
  v_mfma_f32_16x16x32_bf16 v[160:163], v[48:51], a[132:135], v[160:163]
  ds_read_b128 v[40:43], v4 offset:21504
  v_fma_f32 v23, v103, v103, s43
  v_mfma_f32_16x16x32_bf16 v[168:171], v[48:51], a[136:139], v[168:171]
  v_fma_f32 v24, v108, v108, s43
  v_fma_f32 v25, v109, v109, s43
  v_mfma_f32_16x16x32_bf16 v[176:179], v[48:51], a[140:143], v[176:179]
  v_fma_f32 v26, v110, v110, s43
  s_waitcnt lgkmcnt(2)
  v_mfma_f32_16x16x32_bf16 v[148:151], v[28:31], a[144:147], v[148:151]
  v_fma_f32 v27, v111, v111, s43
  v_mul_f32 v20, v20, v100
  v_mfma_f32_16x16x32_bf16 v[156:159], v[28:31], a[148:151], v[156:159]
  ds_read_b128 v[44:47], v4 offset:22528
  s_add_u32 m0, s23, 0
  v_mfma_f32_16x16x32_bf16 v[164:167], v[28:31], a[152:155], v[164:167]
  s_add_u32 s27, s24, 147456
  buffer_load_dwordx4 v1, s[8:11], s27 offen offset:0 lds
  v_mfma_f32_16x16x32_bf16 v[172:175], v[28:31], a[156:159], v[172:175]
  v_mul_f32 v21, v21, v101
  v_mul_f32 v22, v22, v102
  v_mfma_f32_16x16x32_bf16 v[152:155], v[32:35], a[144:147], v[152:155]
  v_mul_f32 v23, v23, v103
  v_mul_f32 v24, v24, v108
  v_mfma_f32_16x16x32_bf16 v[160:163], v[32:35], a[148:151], v[160:163]
  ds_read_b128 v[48:51], v4 offset:23552
  v_mul_f32 v25, v25, v109
  v_mfma_f32_16x16x32_bf16 v[168:171], v[32:35], a[152:155], v[168:171]
  v_mul_f32 v26, v26, v110
  v_mul_f32 v27, v27, v111
  v_mfma_f32_16x16x32_bf16 v[176:179], v[32:35], a[156:159], v[176:179]
  s_waitcnt lgkmcnt(2)
  v_mfma_f32_16x16x32_bf16 v[148:151], v[36:39], a[160:163], v[148:151]
  v_exp_f32_e64 v20, -v20
  v_mfma_f32_16x16x32_bf16 v[156:159], v[36:39], a[164:167], v[156:159]
  ds_read_b128 v[28:31], v4 offset:24576
  v_mul_f32 v104, v100, v104
  v_mfma_f32_16x16x32_bf16 v[164:167], v[36:39], a[168:171], v[164:167]
  v_exp_f32_e64 v21, -v21
  v_mfma_f32_16x16x32_bf16 v[172:175], v[36:39], a[172:175], v[172:175]
  buffer_load_dwordx4 v1, s[8:11], s27 offen offset:1024 lds
  v_mul_f32 v105, v101, v105
  v_mfma_f32_16x16x32_bf16 v[152:155], v[40:43], a[160:163], v[152:155]
  v_exp_f32_e64 v22, -v22
  v_mfma_f32_16x16x32_bf16 v[160:163], v[40:43], a[164:167], v[160:163]
  ds_read_b128 v[32:35], v4 offset:25600
  v_mul_f32 v106, v102, v106
  v_mfma_f32_16x16x32_bf16 v[168:171], v[40:43], a[168:171], v[168:171]
  v_exp_f32_e64 v23, -v23
  v_mfma_f32_16x16x32_bf16 v[176:179], v[40:43], a[172:175], v[176:179]
  v_mul_f32 v107, v103, v107
  s_waitcnt lgkmcnt(2)
  v_mfma_f32_16x16x32_bf16 v[148:151], v[44:47], a[176:179], v[148:151]
  v_exp_f32_e64 v24, -v24
  v_mfma_f32_16x16x32_bf16 v[156:159], v[44:47], a[180:183], v[156:159]
  ds_read_b128 v[36:39], v4 offset:26624
  v_mul_f32 v112, v108, v112
  v_mfma_f32_16x16x32_bf16 v[164:167], v[44:47], a[184:187], v[164:167]
  v_exp_f32_e64 v25, -v25
  v_mfma_f32_16x16x32_bf16 v[172:175], v[44:47], a[188:191], v[172:175]
  v_mul_f32 v113, v109, v113
  v_mfma_f32_16x16x32_bf16 v[152:155], v[48:51], a[176:179], v[152:155]
  v_exp_f32_e64 v26, -v26
  v_mfma_f32_16x16x32_bf16 v[160:163], v[48:51], a[180:183], v[160:163]
  ds_read_b128 v[40:43], v4 offset:27648
  buffer_load_dwordx4 v1, s[8:11], s27 offen offset:2048 lds
  v_mfma_f32_16x16x32_bf16 v[168:171], v[48:51], a[184:187], v[168:171]
  v_mul_f32 v114, v110, v114
  v_mfma_f32_16x16x32_bf16 v[176:179], v[48:51], a[188:191], v[176:179]
  s_waitcnt lgkmcnt(2)
  v_mfma_f32_16x16x32_bf16 v[148:151], v[28:31], a[192:195], v[148:151]
  v_exp_f32_e64 v27, -v27
  v_mfma_f32_16x16x32_bf16 v[156:159], v[28:31], a[196:199], v[156:159]
  ds_read_b128 v[44:47], v4 offset:28672
  v_mul_f32 v115, v111, v115
  v_mfma_f32_16x16x32_bf16 v[164:167], v[28:31], a[200:203], v[164:167]
  v_add_f32 v20, 1.0, v20
  v_add_f32 v21, 1.0, v21
  v_mfma_f32_16x16x32_bf16 v[172:175], v[28:31], a[204:207], v[172:175]
  v_add_f32 v22, 1.0, v22
  v_add_f32 v23, 1.0, v23
  v_mfma_f32_16x16x32_bf16 v[152:155], v[32:35], a[192:195], v[152:155]
  v_add_f32 v24, 1.0, v24
  v_add_f32 v25, 1.0, v25
  v_mfma_f32_16x16x32_bf16 v[160:163], v[32:35], a[196:199], v[160:163]
  ds_read_b128 v[48:51], v4 offset:29696
  v_add_f32 v26, 1.0, v26
  v_mfma_f32_16x16x32_bf16 v[168:171], v[32:35], a[200:203], v[168:171]
  v_add_f32 v27, 1.0, v27
  v_mfma_f32_16x16x32_bf16 v[176:179], v[32:35], a[204:207], v[176:179]
  buffer_load_dwordx4 v1, s[8:11], s27 offen offset:3072 lds
  s_waitcnt lgkmcnt(2)
  v_mfma_f32_16x16x32_bf16 v[148:151], v[36:39], a[208:211], v[148:151]
  v_rcp_f32 v20, v20
  v_mfma_f32_16x16x32_bf16 v[156:159], v[36:39], a[212:215], v[156:159]
  ds_read_b128 v[28:31], v4 offset:30720
  v_mfma_f32_16x16x32_bf16 v[164:167], v[36:39], a[216:219], v[164:167]
  v_rcp_f32 v21, v21
  v_mfma_f32_16x16x32_bf16 v[172:175], v[36:39], a[220:223], v[172:175]
  v_rcp_f32 v22, v22
  v_mfma_f32_16x16x32_bf16 v[152:155], v[40:43], a[208:211], v[152:155]
  v_rcp_f32 v23, v23
  v_mfma_f32_16x16x32_bf16 v[160:163], v[40:43], a[212:215], v[160:163]
  ds_read_b128 v[32:35], v4 offset:31744
  v_mfma_f32_16x16x32_bf16 v[168:171], v[40:43], a[216:219], v[168:171]
  v_rcp_f32 v24, v24
  v_mfma_f32_16x16x32_bf16 v[176:179], v[40:43], a[220:223], v[176:179]
  s_waitcnt lgkmcnt(2)
  v_mfma_f32_16x16x32_bf16 v[148:151], v[44:47], a[224:227], v[148:151]
  v_rcp_f32 v25, v25
  v_mfma_f32_16x16x32_bf16 v[156:159], v[44:47], a[228:231], v[156:159]
  ds_read_b128 v[36:39], v4 offset:32768
  s_add_u32 m0, s23, 4096
  v_mfma_f32_16x16x32_bf16 v[164:167], v[44:47], a[232:235], v[164:167]
  s_add_u32 s27, s24, 151552
  buffer_load_dwordx4 v1, s[8:11], s27 offen offset:0 lds
  v_mfma_f32_16x16x32_bf16 v[172:175], v[44:47], a[236:239], v[172:175]
  v_rcp_f32 v26, v26
  v_mfma_f32_16x16x32_bf16 v[152:155], v[48:51], a[224:227], v[152:155]
  v_rcp_f32 v27, v27
  v_mfma_f32_16x16x32_bf16 v[160:163], v[48:51], a[228:231], v[160:163]
  ds_read_b128 v[40:43], v4 offset:33792
  v_mul_f32 v104, v104, v20
  v_mfma_f32_16x16x32_bf16 v[168:171], v[48:51], a[232:235], v[168:171]
  v_mul_f32 v105, v105, v21
  v_mul_f32 v106, v106, v22
  v_mfma_f32_16x16x32_bf16 v[176:179], v[48:51], a[236:239], v[176:179]
  v_mul_f32 v107, v107, v23
  s_waitcnt lgkmcnt(2)
  v_mfma_f32_16x16x32_bf16 v[148:151], v[28:31], a[240:243], v[148:151]
  v_mul_f32 v112, v112, v24
  v_mul_f32 v113, v113, v25
  v_mfma_f32_16x16x32_bf16 v[156:159], v[28:31], a[244:247], v[156:159]
  ds_read_b128 v[44:47], v4 offset:34816
  v_mul_f32 v114, v114, v26
  v_mfma_f32_16x16x32_bf16 v[164:167], v[28:31], a[248:251], v[164:167]
  v_mul_f32 v115, v115, v27
  v_cvt_pk_bf16_f32 v16, v104, v105
  v_mfma_f32_16x16x32_bf16 v[172:175], v[28:31], a[252:255], v[172:175]
  buffer_load_dwordx4 v1, s[8:11], s27 offen offset:1024 lds
  v_cvt_pk_bf16_f32 v17, v106, v107
  v_mfma_f32_16x16x32_bf16 v[152:155], v[32:35], a[240:243], v[152:155]
  v_cvt_pk_bf16_f32 v18, v112, v113
  v_cvt_pk_bf16_f32 v19, v114, v115
  v_mfma_f32_16x16x32_bf16 v[160:163], v[32:35], a[244:247], v[160:163]
  ds_read_b128 v[48:51], v4 offset:35840
  s_add_u32 s29, s26, 294912
  v_mfma_f32_16x16x32_bf16 v[168:171], v[32:35], a[248:251], v[168:171]
  s_nop 0
  v_permlane16_swap_b32 v16, v18
  v_mfma_f32_16x16x32_bf16 v[176:179], v[32:35], a[252:255], v[176:179]
  v_permlane16_swap_b32 v17, v19
  s_waitcnt lgkmcnt(2)
  s_waitcnt vmcnt(7)
  s_barrier
  v_mfma_f32_16x16x32_bf16 v[148:151], v[36:39], v[52:55], v[148:151]
  buffer_store_dwordx4 v[16:19], v6, s[16:19], s29 offen sc1
  v_fma_f32 v20, v116, v116, s43
  v_mfma_f32_16x16x32_bf16 v[156:159], v[36:39], v[56:59], v[156:159]
  ds_read_b128 v[28:31], v5 offset:0
  v_fma_f32 v21, v117, v117, s43
  v_mfma_f32_16x16x32_bf16 v[164:167], v[36:39], v[60:63], v[164:167]
  v_fma_f32 v22, v118, v118, s43
  v_fma_f32 v23, v119, v119, s43
  v_mfma_f32_16x16x32_bf16 v[172:175], v[36:39], v[64:67], v[172:175]
  v_fma_f32 v24, v124, v124, s43
  v_fma_f32 v25, v125, v125, s43
  v_mfma_f32_16x16x32_bf16 v[152:155], v[40:43], v[52:55], v[152:155]
  v_fma_f32 v26, v126, v126, s43
  v_fma_f32 v27, v127, v127, s43
  v_mfma_f32_16x16x32_bf16 v[160:163], v[40:43], v[56:59], v[160:163]
  ds_read_b128 v[32:35], v5 offset:1024
  buffer_load_dwordx4 v1, s[8:11], s27 offen offset:2048 lds
  v_mfma_f32_16x16x32_bf16 v[168:171], v[40:43], v[60:63], v[168:171]
  v_mul_f32 v20, v20, v116
  v_mul_f32 v21, v21, v117
  v_mfma_f32_16x16x32_bf16 v[176:179], v[40:43], v[64:67], v[176:179]
  v_mul_f32 v22, v22, v118
  s_waitcnt lgkmcnt(2)
  v_mfma_f32_16x16x32_bf16 v[148:151], v[44:47], v[68:71], v[148:151]
  v_mul_f32 v23, v23, v119
  v_mul_f32 v24, v24, v124
  v_mfma_f32_16x16x32_bf16 v[156:159], v[44:47], v[72:75], v[156:159]
  ds_read_b128 v[36:39], v5 offset:2048
  v_mul_f32 v25, v25, v125
  v_mfma_f32_16x16x32_bf16 v[164:167], v[44:47], v[76:79], v[164:167]
  v_mul_f32 v26, v26, v126
  v_mul_f32 v27, v27, v127
  v_mfma_f32_16x16x32_bf16 v[172:175], v[44:47], v[80:83], v[172:175]
  v_exp_f32_e64 v20, -v20
  v_mfma_f32_16x16x32_bf16 v[152:155], v[48:51], v[68:71], v[152:155]
  v_mul_f32 v120, v116, v120
  v_mfma_f32_16x16x32_bf16 v[160:163], v[48:51], v[72:75], v[160:163]
  ds_read_b128 v[40:43], v5 offset:3072
  v_mfma_f32_16x16x32_bf16 v[168:171], v[48:51], v[76:79], v[168:171]
  v_exp_f32_e64 v21, -v21
  v_mfma_f32_16x16x32_bf16 v[176:179], v[48:51], v[80:83], v[176:179]
  buffer_load_dwordx4 v1, s[8:11], s27 offen offset:3072 lds
  s_waitcnt lgkmcnt(2)
  v_mfma_f32_16x16x32_bf16 v[180:183], v[28:31], a[0:3], 0
  v_mul_f32 v121, v117, v121
  v_mfma_f32_16x16x32_bf16 v[188:191], v[28:31], a[4:7], 0
  ds_read_b128 v[44:47], v5 offset:4096
  v_mfma_f32_16x16x32_bf16 v[196:199], v[28:31], a[8:11], 0
  v_exp_f32_e64 v22, -v22
  v_mfma_f32_16x16x32_bf16 v[204:207], v[28:31], a[12:15], 0
  v_mul_f32 v122, v118, v122
  v_mfma_f32_16x16x32_bf16 v[184:187], v[32:35], a[0:3], 0
  v_exp_f32_e64 v23, -v23
  v_mfma_f32_16x16x32_bf16 v[192:195], v[32:35], a[4:7], 0
  ds_read_b128 v[48:51], v5 offset:5120
  v_mul_f32 v123, v119, v123
  v_mfma_f32_16x16x32_bf16 v[200:203], v[32:35], a[8:11], 0
  v_exp_f32_e64 v24, -v24
  v_mfma_f32_16x16x32_bf16 v[208:211], v[32:35], a[12:15], 0
  v_mul_f32 v128, v124, v128
  s_waitcnt lgkmcnt(2)
  v_mfma_f32_16x16x32_bf16 v[180:183], v[36:39], a[16:19], v[180:183]
  v_exp_f32_e64 v25, -v25
  v_mfma_f32_16x16x32_bf16 v[188:191], v[36:39], a[20:23], v[188:191]
  ds_read_b128 v[28:31], v5 offset:6144
  s_add_u32 m0, s23, 8192
  v_mfma_f32_16x16x32_bf16 v[196:199], v[36:39], a[24:27], v[196:199]
  s_add_u32 s27, s24, 155648
  buffer_load_dwordx4 v1, s[8:11], s27 offen offset:0 lds
  v_mfma_f32_16x16x32_bf16 v[204:207], v[36:39], a[28:31], v[204:207]
  v_mul_f32 v129, v125, v129
  v_mfma_f32_16x16x32_bf16 v[184:187], v[40:43], a[16:19], v[184:187]
  v_exp_f32_e64 v26, -v26
  v_mfma_f32_16x16x32_bf16 v[192:195], v[40:43], a[20:23], v[192:195]
  ds_read_b128 v[32:35], v5 offset:7168
  v_mul_f32 v130, v126, v130
  v_mfma_f32_16x16x32_bf16 v[200:203], v[40:43], a[24:27], v[200:203]
  v_exp_f32_e64 v27, -v27
  v_mfma_f32_16x16x32_bf16 v[208:211], v[40:43], a[28:31], v[208:211]
  v_mul_f32 v131, v127, v131
  s_waitcnt lgkmcnt(2)
  v_mfma_f32_16x16x32_bf16 v[180:183], v[44:47], a[32:35], v[180:183]
  v_add_f32 v20, 1.0, v20
  v_add_f32 v21, 1.0, v21
  v_mfma_f32_16x16x32_bf16 v[188:191], v[44:47], a[36:39], v[188:191]
  ds_read_b128 v[36:39], v5 offset:8192
  v_add_f32 v22, 1.0, v22
  v_mfma_f32_16x16x32_bf16 v[196:199], v[44:47], a[40:43], v[196:199]
  v_add_f32 v23, 1.0, v23
  v_add_f32 v24, 1.0, v24
  v_mfma_f32_16x16x32_bf16 v[204:207], v[44:47], a[44:47], v[204:207]
  s_add_u32 m0, s23, 36864
  s_add_u32 s27, s24, 184320
  v_mfma_f32_16x16x32_bf16 v[184:187], v[48:51], a[32:35], v[184:187]
  buffer_load_dwordx4 v1, s[8:11], s27 offen offset:0 lds
  v_add_f32 v25, 1.0, v25
  v_mfma_f32_16x16x32_bf16 v[192:195], v[48:51], a[36:39], v[192:195]
  ds_read_b128 v[40:43], v5 offset:9216
  v_add_f32 v26, 1.0, v26
  v_mfma_f32_16x16x32_bf16 v[200:203], v[48:51], a[40:43], v[200:203]
  v_add_f32 v27, 1.0, v27
  v_mfma_f32_16x16x32_bf16 v[208:211], v[48:51], a[44:47], v[208:211]
  s_waitcnt lgkmcnt(2)
  v_mfma_f32_16x16x32_bf16 v[180:183], v[28:31], a[48:51], v[180:183]
  v_rcp_f32 v20, v20
  v_mfma_f32_16x16x32_bf16 v[188:191], v[28:31], a[52:55], v[188:191]
  ds_read_b128 v[44:47], v5 offset:10240
  v_mfma_f32_16x16x32_bf16 v[196:199], v[28:31], a[56:59], v[196:199]
  v_rcp_f32 v21, v21
  v_mfma_f32_16x16x32_bf16 v[204:207], v[28:31], a[60:63], v[204:207]
  v_rcp_f32 v22, v22
  v_mfma_f32_16x16x32_bf16 v[184:187], v[32:35], a[48:51], v[184:187]
  v_rcp_f32 v23, v23
  v_mfma_f32_16x16x32_bf16 v[192:195], v[32:35], a[52:55], v[192:195]
  ds_read_b128 v[48:51], v5 offset:11264
  buffer_load_dwordx4 v1, s[8:11], s27 offen offset:1024 lds
  v_mfma_f32_16x16x32_bf16 v[200:203], v[32:35], a[56:59], v[200:203]
  v_rcp_f32 v24, v24
  v_mfma_f32_16x16x32_bf16 v[208:211], v[32:35], a[60:63], v[208:211]
  s_waitcnt lgkmcnt(2)
  v_mfma_f32_16x16x32_bf16 v[180:183], v[36:39], a[64:67], v[180:183]
  v_rcp_f32 v25, v25
  v_mfma_f32_16x16x32_bf16 v[188:191], v[36:39], a[68:71], v[188:191]
  ds_read_b128 v[28:31], v5 offset:12288
  v_mfma_f32_16x16x32_bf16 v[196:199], v[36:39], a[72:75], v[196:199]
  v_rcp_f32 v26, v26
  v_mfma_f32_16x16x32_bf16 v[204:207], v[36:39], a[76:79], v[204:207]
  v_rcp_f32 v27, v27
  v_mfma_f32_16x16x32_bf16 v[184:187], v[40:43], a[64:67], v[184:187]
  v_mul_f32 v120, v120, v20
  v_mul_f32 v121, v121, v21
  v_mfma_f32_16x16x32_bf16 v[192:195], v[40:43], a[68:71], v[192:195]
  ds_read_b128 v[32:35], v5 offset:13312
  v_mul_f32 v122, v122, v22
  v_mfma_f32_16x16x32_bf16 v[200:203], v[40:43], a[72:75], v[200:203]
  v_mul_f32 v123, v123, v23
  v_mul_f32 v128, v128, v24
  v_mfma_f32_16x16x32_bf16 v[208:211], v[40:43], a[76:79], v[208:211]
  buffer_load_dwordx4 v1, s[8:11], s27 offen offset:2048 lds
  s_waitcnt lgkmcnt(2)
  v_mfma_f32_16x16x32_bf16 v[180:183], v[44:47], a[80:83], v[180:183]
  v_mul_f32 v129, v129, v25
  v_mul_f32 v130, v130, v26
  v_mfma_f32_16x16x32_bf16 v[188:191], v[44:47], a[84:87], v[188:191]
  ds_read_b128 v[36:39], v5 offset:14336
  v_mul_f32 v131, v131, v27
  v_mfma_f32_16x16x32_bf16 v[196:199], v[44:47], a[88:91], v[196:199]
  v_cvt_pk_bf16_f32 v12, v120, v121
  v_cvt_pk_bf16_f32 v13, v122, v123
  v_mfma_f32_16x16x32_bf16 v[204:207], v[44:47], a[92:95], v[204:207]
  v_cvt_pk_bf16_f32 v14, v128, v129
  v_cvt_pk_bf16_f32 v15, v130, v131
  v_mfma_f32_16x16x32_bf16 v[184:187], v[48:51], a[80:83], v[184:187]
  s_add_u32 s29, s26, 512
  s_nop 0
  v_mfma_f32_16x16x32_bf16 v[192:195], v[48:51], a[84:87], v[192:195]
  ds_read_b128 v[40:43], v5 offset:15360
  v_permlane16_swap_b32 v12, v14
  v_mfma_f32_16x16x32_bf16 v[200:203], v[48:51], a[88:91], v[200:203]
  v_permlane16_swap_b32 v13, v15
  buffer_store_dwordx4 v[12:15], v6, s[16:19], s29 offen sc1
  v_mfma_f32_16x16x32_bf16 v[208:211], v[48:51], a[92:95], v[208:211]
  v_fma_f32 v20, v132, v132, s43
  s_waitcnt lgkmcnt(2)
  v_mfma_f32_16x16x32_bf16 v[180:183], v[28:31], a[96:99], v[180:183]
  v_fma_f32 v21, v133, v133, s43
  v_fma_f32 v22, v134, v134, s43
  v_mfma_f32_16x16x32_bf16 v[188:191], v[28:31], a[100:103], v[188:191]
  ds_read_b128 v[44:47], v5 offset:16384
  buffer_load_dwordx4 v1, s[8:11], s27 offen offset:3072 lds
  v_mfma_f32_16x16x32_bf16 v[196:199], v[28:31], a[104:107], v[196:199]
  v_fma_f32 v23, v135, v135, s43
  v_fma_f32 v24, v140, v140, s43
  v_mfma_f32_16x16x32_bf16 v[204:207], v[28:31], a[108:111], v[204:207]
  v_fma_f32 v25, v141, v141, s43
  v_fma_f32 v26, v142, v142, s43
  v_mfma_f32_16x16x32_bf16 v[184:187], v[32:35], a[96:99], v[184:187]
  v_fma_f32 v27, v143, v143, s43
  v_mul_f32 v20, v20, v132
  v_mfma_f32_16x16x32_bf16 v[192:195], v[32:35], a[100:103], v[192:195]
  ds_read_b128 v[48:51], v5 offset:17408
  v_mul_f32 v21, v21, v133
  v_mfma_f32_16x16x32_bf16 v[200:203], v[32:35], a[104:107], v[200:203]
  v_mul_f32 v22, v22, v134
  v_mul_f32 v23, v23, v135
  v_mfma_f32_16x16x32_bf16 v[208:211], v[32:35], a[108:111], v[208:211]
  v_mul_f32 v24, v24, v140
  s_waitcnt lgkmcnt(2)
  v_mfma_f32_16x16x32_bf16 v[180:183], v[36:39], a[112:115], v[180:183]
  v_mul_f32 v25, v25, v141
  v_mul_f32 v26, v26, v142
  v_mfma_f32_16x16x32_bf16 v[188:191], v[36:39], a[116:119], v[188:191]
  ds_read_b128 v[28:31], v5 offset:18432
  v_mul_f32 v27, v27, v143
  v_mfma_f32_16x16x32_bf16 v[196:199], v[36:39], a[120:123], v[196:199]
  v_exp_f32_e64 v20, -v20
  v_mfma_f32_16x16x32_bf16 v[204:207], v[36:39], a[124:127], v[204:207]
  s_add_u32 m0, s23, 40960
  s_add_u32 s27, s24, 188416
  v_mfma_f32_16x16x32_bf16 v[184:187], v[40:43], a[112:115], v[184:187]
  buffer_load_dwordx4 v1, s[8:11], s27 offen offset:0 lds
  v_mul_f32 v136, v132, v136
  v_mfma_f32_16x16x32_bf16 v[192:195], v[40:43], a[116:119], v[192:195]
  ds_read_b128 v[32:35], v5 offset:19456
  v_mfma_f32_16x16x32_bf16 v[200:203], v[40:43], a[120:123], v[200:203]
  v_exp_f32_e64 v21, -v21
  v_mfma_f32_16x16x32_bf16 v[208:211], v[40:43], a[124:127], v[208:211]
  v_mul_f32 v137, v133, v137
  s_waitcnt lgkmcnt(2)
  v_mfma_f32_16x16x32_bf16 v[180:183], v[44:47], a[128:131], v[180:183]
  v_exp_f32_e64 v22, -v22
  v_mfma_f32_16x16x32_bf16 v[188:191], v[44:47], a[132:135], v[188:191]
  ds_read_b128 v[36:39], v5 offset:20480
  v_mul_f32 v138, v134, v138
  v_mfma_f32_16x16x32_bf16 v[196:199], v[44:47], a[136:139], v[196:199]
  v_exp_f32_e64 v23, -v23
  v_mfma_f32_16x16x32_bf16 v[204:207], v[44:47], a[140:143], v[204:207]
  v_mul_f32 v139, v135, v139
  v_mfma_f32_16x16x32_bf16 v[184:187], v[48:51], a[128:131], v[184:187]
  v_exp_f32_e64 v24, -v24
  v_mfma_f32_16x16x32_bf16 v[192:195], v[48:51], a[132:135], v[192:195]
  ds_read_b128 v[40:43], v5 offset:21504
  buffer_load_dwordx4 v1, s[8:11], s27 offen offset:1024 lds
  v_mfma_f32_16x16x32_bf16 v[200:203], v[48:51], a[136:139], v[200:203]
  v_mul_f32 v144, v140, v144
  v_mfma_f32_16x16x32_bf16 v[208:211], v[48:51], a[140:143], v[208:211]
  s_waitcnt lgkmcnt(2)
  v_mfma_f32_16x16x32_bf16 v[180:183], v[28:31], a[144:147], v[180:183]
  v_exp_f32_e64 v25, -v25
  v_mfma_f32_16x16x32_bf16 v[188:191], v[28:31], a[148:151], v[188:191]
  ds_read_b128 v[44:47], v5 offset:22528
  v_mul_f32 v145, v141, v145
  v_mfma_f32_16x16x32_bf16 v[196:199], v[28:31], a[152:155], v[196:199]
  v_exp_f32_e64 v26, -v26
  v_mfma_f32_16x16x32_bf16 v[204:207], v[28:31], a[156:159], v[204:207]
  v_mul_f32 v146, v142, v146
  v_mfma_f32_16x16x32_bf16 v[184:187], v[32:35], a[144:147], v[184:187]
  v_exp_f32_e64 v27, -v27
  v_mfma_f32_16x16x32_bf16 v[192:195], v[32:35], a[148:151], v[192:195]
  ds_read_b128 v[48:51], v5 offset:23552
  v_mul_f32 v147, v143, v147
  v_mfma_f32_16x16x32_bf16 v[200:203], v[32:35], a[152:155], v[200:203]
  v_add_f32 v20, 1.0, v20
  v_add_f32 v21, 1.0, v21
  v_mfma_f32_16x16x32_bf16 v[208:211], v[32:35], a[156:159], v[208:211]
  buffer_load_dwordx4 v1, s[8:11], s27 offen offset:2048 lds
  s_waitcnt lgkmcnt(2)
  v_mfma_f32_16x16x32_bf16 v[180:183], v[36:39], a[160:163], v[180:183]
  v_add_f32 v22, 1.0, v22
  v_add_f32 v23, 1.0, v23
  v_mfma_f32_16x16x32_bf16 v[188:191], v[36:39], a[164:167], v[188:191]
  ds_read_b128 v[28:31], v5 offset:24576
  v_add_f32 v24, 1.0, v24
  v_mfma_f32_16x16x32_bf16 v[196:199], v[36:39], a[168:171], v[196:199]
  v_add_f32 v25, 1.0, v25
  v_add_f32 v26, 1.0, v26
  v_mfma_f32_16x16x32_bf16 v[204:207], v[36:39], a[172:175], v[204:207]
  v_add_f32 v27, 1.0, v27
  v_mfma_f32_16x16x32_bf16 v[184:187], v[40:43], a[160:163], v[184:187]
  v_rcp_f32 v20, v20
  v_mfma_f32_16x16x32_bf16 v[192:195], v[40:43], a[164:167], v[192:195]
  ds_read_b128 v[32:35], v5 offset:25600
  v_mfma_f32_16x16x32_bf16 v[200:203], v[40:43], a[168:171], v[200:203]
  v_rcp_f32 v21, v21
  v_mfma_f32_16x16x32_bf16 v[208:211], v[40:43], a[172:175], v[208:211]
  s_waitcnt lgkmcnt(2)
  v_mfma_f32_16x16x32_bf16 v[180:183], v[44:47], a[176:179], v[180:183]
  v_rcp_f32 v22, v22
  v_mfma_f32_16x16x32_bf16 v[188:191], v[44:47], a[180:183], v[188:191]
  ds_read_b128 v[36:39], v5 offset:26624
  buffer_load_dwordx4 v1, s[8:11], s27 offen offset:3072 lds
  v_mfma_f32_16x16x32_bf16 v[196:199], v[44:47], a[184:187], v[196:199]
  v_rcp_f32 v23, v23
  v_mfma_f32_16x16x32_bf16 v[204:207], v[44:47], a[188:191], v[204:207]
  v_rcp_f32 v24, v24
  v_mfma_f32_16x16x32_bf16 v[184:187], v[48:51], a[176:179], v[184:187]
  v_rcp_f32 v25, v25
  v_mfma_f32_16x16x32_bf16 v[192:195], v[48:51], a[180:183], v[192:195]
  ds_read_b128 v[40:43], v5 offset:27648
  v_mfma_f32_16x16x32_bf16 v[200:203], v[48:51], a[184:187], v[200:203]
  v_rcp_f32 v26, v26
  v_mfma_f32_16x16x32_bf16 v[208:211], v[48:51], a[188:191], v[208:211]
  s_waitcnt lgkmcnt(2)
  v_mfma_f32_16x16x32_bf16 v[180:183], v[28:31], a[192:195], v[180:183]
  v_rcp_f32 v27, v27
  v_mfma_f32_16x16x32_bf16 v[188:191], v[28:31], a[196:199], v[188:191]
  ds_read_b128 v[44:47], v5 offset:28672
  v_mul_f32 v136, v136, v20
  v_mfma_f32_16x16x32_bf16 v[196:199], v[28:31], a[200:203], v[196:199]
  v_mul_f32 v137, v137, v21
  v_mul_f32 v138, v138, v22
  v_mfma_f32_16x16x32_bf16 v[204:207], v[28:31], a[204:207], v[204:207]
  s_add_u32 m0, s23, 45056
  s_add_u32 s27, s24, 192512
  v_mfma_f32_16x16x32_bf16 v[184:187], v[32:35], a[192:195], v[184:187]
  buffer_load_dwordx4 v1, s[8:11], s27 offen offset:0 lds
  v_mul_f32 v139, v139, v23
  v_mfma_f32_16x16x32_bf16 v[192:195], v[32:35], a[196:199], v[192:195]
  ds_read_b128 v[48:51], v5 offset:29696
  v_mul_f32 v144, v144, v24
  v_mfma_f32_16x16x32_bf16 v[200:203], v[32:35], a[200:203], v[200:203]
  v_mul_f32 v145, v145, v25
  v_mul_f32 v146, v146, v26
  v_mfma_f32_16x16x32_bf16 v[208:211], v[32:35], a[204:207], v[208:211]
  v_mul_f32 v147, v147, v27
  s_waitcnt lgkmcnt(2)
  v_mfma_f32_16x16x32_bf16 v[180:183], v[36:39], a[208:211], v[180:183]
  v_cvt_pk_bf16_f32 v16, v136, v137
  v_cvt_pk_bf16_f32 v17, v138, v139
  v_mfma_f32_16x16x32_bf16 v[188:191], v[36:39], a[212:215], v[188:191]
  ds_read_b128 v[28:31], v5 offset:30720
  v_cvt_pk_bf16_f32 v18, v144, v145
  v_mfma_f32_16x16x32_bf16 v[196:199], v[36:39], a[216:219], v[196:199]
  v_cvt_pk_bf16_f32 v19, v146, v147
  s_add_u32 s29, s26, 295424
  v_mfma_f32_16x16x32_bf16 v[204:207], v[36:39], a[220:223], v[204:207]
  s_nop 0
  v_permlane16_swap_b32 v16, v18
  v_mfma_f32_16x16x32_bf16 v[184:187], v[40:43], a[208:211], v[184:187]
  v_permlane16_swap_b32 v17, v19
  buffer_store_dwordx4 v[16:19], v6, s[16:19], s29 offen sc1
  v_mfma_f32_16x16x32_bf16 v[192:195], v[40:43], a[212:215], v[192:195]
  ds_read_b128 v[32:35], v5 offset:31744
  v_fma_f32 v20, v148, v148, s43
  v_mfma_f32_16x16x32_bf16 v[200:203], v[40:43], a[216:219], v[200:203]
  v_fma_f32 v21, v149, v149, s43
  v_fma_f32 v22, v150, v150, s43
  v_mfma_f32_16x16x32_bf16 v[208:211], v[40:43], a[220:223], v[208:211]
  v_fma_f32 v23, v151, v151, s43
  s_waitcnt lgkmcnt(2)
  v_mfma_f32_16x16x32_bf16 v[180:183], v[44:47], a[224:227], v[180:183]
  v_fma_f32 v24, v156, v156, s43
  v_fma_f32 v25, v157, v157, s43
  v_mfma_f32_16x16x32_bf16 v[188:191], v[44:47], a[228:231], v[188:191]
  ds_read_b128 v[36:39], v5 offset:32768
  v_fma_f32 v26, v158, v158, s43
  v_mfma_f32_16x16x32_bf16 v[196:199], v[44:47], a[232:235], v[196:199]
  v_fma_f32 v27, v159, v159, s43
  v_mul_f32 v20, v20, v148
  v_mfma_f32_16x16x32_bf16 v[204:207], v[44:47], a[236:239], v[204:207]
  v_mul_f32 v21, v21, v149
  v_mul_f32 v22, v22, v150
  v_mfma_f32_16x16x32_bf16 v[184:187], v[48:51], a[224:227], v[184:187]
  v_mul_f32 v23, v23, v151
  v_mul_f32 v24, v24, v156
  v_mfma_f32_16x16x32_bf16 v[192:195], v[48:51], a[228:231], v[192:195]
  ds_read_b128 v[40:43], v5 offset:33792
  v_mul_f32 v25, v25, v157
  v_mfma_f32_16x16x32_bf16 v[200:203], v[48:51], a[232:235], v[200:203]
  v_mul_f32 v26, v26, v158
  v_mul_f32 v27, v27, v159
  v_mfma_f32_16x16x32_bf16 v[208:211], v[48:51], a[236:239], v[208:211]
  s_waitcnt lgkmcnt(2)
  v_mfma_f32_16x16x32_bf16 v[180:183], v[28:31], a[240:243], v[180:183]
  v_exp_f32_e64 v20, -v20
  v_mfma_f32_16x16x32_bf16 v[188:191], v[28:31], a[244:247], v[188:191]
  ds_read_b128 v[44:47], v5 offset:34816
  v_mul_f32 v152, v148, v152
  v_mfma_f32_16x16x32_bf16 v[196:199], v[28:31], a[248:251], v[196:199]
  v_exp_f32_e64 v21, -v21
  v_mfma_f32_16x16x32_bf16 v[204:207], v[28:31], a[252:255], v[204:207]
  v_mul_f32 v153, v149, v153
  v_mfma_f32_16x16x32_bf16 v[184:187], v[32:35], a[240:243], v[184:187]
  v_exp_f32_e64 v22, -v22
  v_mfma_f32_16x16x32_bf16 v[192:195], v[32:35], a[244:247], v[192:195]
  ds_read_b128 v[48:51], v5 offset:35840
  v_mul_f32 v154, v150, v154
  v_mfma_f32_16x16x32_bf16 v[200:203], v[32:35], a[248:251], v[200:203]
  v_exp_f32_e64 v23, -v23
  v_mfma_f32_16x16x32_bf16 v[208:211], v[32:35], a[252:255], v[208:211]
  v_mul_f32 v155, v151, v155
  s_waitcnt lgkmcnt(2)
  s_waitcnt vmcnt(11)
  s_barrier
  v_mfma_f32_16x16x32_bf16 v[180:183], v[36:39], v[52:55], v[180:183]
  s_add_u32 m0, s23, 73728
  s_add_u32 s27, s24, 221184
  v_mfma_f32_16x16x32_bf16 v[188:191], v[36:39], v[56:59], v[188:191]
  ds_read_b128 v[28:31], v2 offset:0
  buffer_load_dwordx4 v1, s[8:11], s27 offen offset:0 lds
  v_mfma_f32_16x16x32_bf16 v[196:199], v[36:39], v[60:63], v[196:199]
  v_exp_f32_e64 v24, -v24
  v_mfma_f32_16x16x32_bf16 v[204:207], v[36:39], v[64:67], v[204:207]
  v_mul_f32 v160, v156, v160
  v_mfma_f32_16x16x32_bf16 v[184:187], v[40:43], v[52:55], v[184:187]
  v_exp_f32_e64 v25, -v25
  v_mfma_f32_16x16x32_bf16 v[192:195], v[40:43], v[56:59], v[192:195]
  ds_read_b128 v[32:35], v2 offset:1024
  v_mul_f32 v161, v157, v161
  v_mfma_f32_16x16x32_bf16 v[200:203], v[40:43], v[60:63], v[200:203]
  v_exp_f32_e64 v26, -v26
  v_mfma_f32_16x16x32_bf16 v[208:211], v[40:43], v[64:67], v[208:211]
  v_mul_f32 v162, v158, v162
  s_waitcnt lgkmcnt(2)
  v_mfma_f32_16x16x32_bf16 v[180:183], v[44:47], v[68:71], v[180:183]
  v_exp_f32_e64 v27, -v27
  v_mfma_f32_16x16x32_bf16 v[188:191], v[44:47], v[72:75], v[188:191]
  ds_read_b128 v[36:39], v2 offset:2048
  buffer_load_dwordx4 v1, s[8:11], s27 offen offset:1024 lds
  v_mfma_f32_16x16x32_bf16 v[196:199], v[44:47], v[76:79], v[196:199]
  v_mul_f32 v163, v159, v163
  v_add_f32 v20, 1.0, v20
  v_mfma_f32_16x16x32_bf16 v[204:207], v[44:47], v[80:83], v[204:207]
  v_add_f32 v21, 1.0, v21
  v_add_f32 v22, 1.0, v22
  v_mfma_f32_16x16x32_bf16 v[184:187], v[48:51], v[68:71], v[184:187]
  v_add_f32 v23, 1.0, v23
  v_add_f32 v24, 1.0, v24
  v_mfma_f32_16x16x32_bf16 v[192:195], v[48:51], v[72:75], v[192:195]
  ds_read_b128 v[40:43], v2 offset:3072
  v_add_f32 v25, 1.0, v25
  v_mfma_f32_16x16x32_bf16 v[200:203], v[48:51], v[76:79], v[200:203]
  v_add_f32 v26, 1.0, v26
  v_add_f32 v27, 1.0, v27
  v_mfma_f32_16x16x32_bf16 v[208:211], v[48:51], v[80:83], v[208:211]
  s_waitcnt lgkmcnt(2)
  v_mfma_f32_16x16x32_bf16 v[84:87], v[28:31], a[0:3], 0
  v_rcp_f32 v20, v20
  v_mfma_f32_16x16x32_bf16 v[92:95], v[28:31], a[4:7], 0
  ds_read_b128 v[44:47], v2 offset:4096
  v_mfma_f32_16x16x32_bf16 v[100:103], v[28:31], a[8:11], 0
  v_rcp_f32 v21, v21
  v_mfma_f32_16x16x32_bf16 v[108:111], v[28:31], a[12:15], 0
  buffer_load_dwordx4 v1, s[8:11], s27 offen offset:2048 lds
  v_mfma_f32_16x16x32_bf16 v[88:91], v[32:35], a[0:3], 0
  v_rcp_f32 v22, v22
  v_mfma_f32_16x16x32_bf16 v[96:99], v[32:35], a[4:7], 0
  ds_read_b128 v[48:51], v2 offset:5120
  v_mfma_f32_16x16x32_bf16 v[104:107], v[32:35], a[8:11], 0
  v_rcp_f32 v23, v23
  v_mfma_f32_16x16x32_bf16 v[112:115], v[32:35], a[12:15], 0
  s_waitcnt lgkmcnt(2)
  v_mfma_f32_16x16x32_bf16 v[84:87], v[36:39], a[16:19], v[84:87]
  v_rcp_f32 v24, v24
  v_mfma_f32_16x16x32_bf16 v[92:95], v[36:39], a[20:23], v[92:95]
  ds_read_b128 v[28:31], v2 offset:6144
  v_mfma_f32_16x16x32_bf16 v[100:103], v[36:39], a[24:27], v[100:103]
  v_rcp_f32 v25, v25
  v_mfma_f32_16x16x32_bf16 v[108:111], v[36:39], a[28:31], v[108:111]
  v_rcp_f32 v26, v26
  v_mfma_f32_16x16x32_bf16 v[88:91], v[40:43], a[16:19], v[88:91]
  v_rcp_f32 v27, v27
  v_mfma_f32_16x16x32_bf16 v[96:99], v[40:43], a[20:23], v[96:99]
  ds_read_b128 v[32:35], v2 offset:7168
  buffer_load_dwordx4 v1, s[8:11], s27 offen offset:3072 lds
  v_mfma_f32_16x16x32_bf16 v[104:107], v[40:43], a[24:27], v[104:107]
  v_mul_f32 v152, v152, v20
  v_mul_f32 v153, v153, v21
  v_mfma_f32_16x16x32_bf16 v[112:115], v[40:43], a[28:31], v[112:115]
  v_mul_f32 v154, v154, v22
  s_waitcnt lgkmcnt(2)
  v_mfma_f32_16x16x32_bf16 v[84:87], v[44:47], a[32:35], v[84:87]
  v_mul_f32 v155, v155, v23
  v_mul_f32 v160, v160, v24
  v_mfma_f32_16x16x32_bf16 v[92:95], v[44:47], a[36:39], v[92:95]
  ds_read_b128 v[36:39], v2 offset:8192
  v_mul_f32 v161, v161, v25
  v_mfma_f32_16x16x32_bf16 v[100:103], v[44:47], a[40:43], v[100:103]
  v_mul_f32 v162, v162, v26
  v_mul_f32 v163, v163, v27
  v_mfma_f32_16x16x32_bf16 v[108:111], v[44:47], a[44:47], v[108:111]
  v_cvt_pk_bf16_f32 v12, v152, v153
  v_cvt_pk_bf16_f32 v13, v154, v155
  v_mfma_f32_16x16x32_bf16 v[88:91], v[48:51], a[32:35], v[88:91]
  v_cvt_pk_bf16_f32 v14, v160, v161
  v_cvt_pk_bf16_f32 v15, v162, v163
  v_mfma_f32_16x16x32_bf16 v[96:99], v[48:51], a[36:39], v[96:99]
  ds_read_b128 v[40:43], v2 offset:9216
  s_add_u32 s29, s26, 1024
  v_mfma_f32_16x16x32_bf16 v[104:107], v[48:51], a[40:43], v[104:107]
  s_nop 0
  v_permlane16_swap_b32 v12, v14
  v_mfma_f32_16x16x32_bf16 v[112:115], v[48:51], a[44:47], v[112:115]
  s_add_u32 m0, s23, 77824
  s_waitcnt lgkmcnt(2)
  v_mfma_f32_16x16x32_bf16 v[84:87], v[28:31], a[48:51], v[84:87]
  s_add_u32 s27, s24, 225280
  buffer_load_dwordx4 v1, s[8:11], s27 offen offset:0 lds
  v_mfma_f32_16x16x32_bf16 v[92:95], v[28:31], a[52:55], v[92:95]
  ds_read_b128 v[44:47], v2 offset:10240
  v_permlane16_swap_b32 v13, v15
  v_mfma_f32_16x16x32_bf16 v[100:103], v[28:31], a[56:59], v[100:103]
  buffer_store_dwordx4 v[12:15], v6, s[16:19], s29 offen sc1
  v_fma_f32 v20, v164, v164, s43
  v_mfma_f32_16x16x32_bf16 v[108:111], v[28:31], a[60:63], v[108:111]
  v_fma_f32 v21, v165, v165, s43
  v_fma_f32 v22, v166, v166, s43
  v_mfma_f32_16x16x32_bf16 v[88:91], v[32:35], a[48:51], v[88:91]
  v_fma_f32 v23, v167, v167, s43
  v_fma_f32 v24, v172, v172, s43
  v_mfma_f32_16x16x32_bf16 v[96:99], v[32:35], a[52:55], v[96:99]
  ds_read_b128 v[48:51], v2 offset:11264
  v_fma_f32 v25, v173, v173, s43
  v_mfma_f32_16x16x32_bf16 v[104:107], v[32:35], a[56:59], v[104:107]
  v_fma_f32 v26, v174, v174, s43
  v_fma_f32 v27, v175, v175, s43
  v_mfma_f32_16x16x32_bf16 v[112:115], v[32:35], a[60:63], v[112:115]
  v_mul_f32 v20, v20, v164
  s_waitcnt lgkmcnt(2)
  v_mfma_f32_16x16x32_bf16 v[84:87], v[36:39], a[64:67], v[84:87]
  v_mul_f32 v21, v21, v165
  v_mul_f32 v22, v22, v166
  v_mfma_f32_16x16x32_bf16 v[92:95], v[36:39], a[68:71], v[92:95]
  ds_read_b128 v[28:31], v2 offset:12288
  buffer_load_dwordx4 v1, s[8:11], s27 offen offset:1024 lds
  v_mfma_f32_16x16x32_bf16 v[100:103], v[36:39], a[72:75], v[100:103]
  v_mul_f32 v23, v23, v167
  v_mul_f32 v24, v24, v172
  v_mfma_f32_16x16x32_bf16 v[108:111], v[36:39], a[76:79], v[108:111]
  v_mul_f32 v25, v25, v173
  v_mul_f32 v26, v26, v174
  v_mfma_f32_16x16x32_bf16 v[88:91], v[40:43], a[64:67], v[88:91]
  v_mul_f32 v27, v27, v175
  v_mfma_f32_16x16x32_bf16 v[96:99], v[40:43], a[68:71], v[96:99]
  ds_read_b128 v[32:35], v2 offset:13312
  v_mfma_f32_16x16x32_bf16 v[104:107], v[40:43], a[72:75], v[104:107]
  v_exp_f32_e64 v20, -v20
  v_mfma_f32_16x16x32_bf16 v[112:115], v[40:43], a[76:79], v[112:115]
  v_mul_f32 v168, v164, v168
  s_waitcnt lgkmcnt(2)
  v_mfma_f32_16x16x32_bf16 v[84:87], v[44:47], a[80:83], v[84:87]
  v_exp_f32_e64 v21, -v21
  v_mfma_f32_16x16x32_bf16 v[92:95], v[44:47], a[84:87], v[92:95]
  ds_read_b128 v[36:39], v2 offset:14336
  v_mul_f32 v169, v165, v169
  v_mfma_f32_16x16x32_bf16 v[100:103], v[44:47], a[88:91], v[100:103]
  v_exp_f32_e64 v22, -v22
  v_mfma_f32_16x16x32_bf16 v[108:111], v[44:47], a[92:95], v[108:111]
  buffer_load_dwordx4 v1, s[8:11], s27 offen offset:2048 lds
  v_mul_f32 v170, v166, v170
  v_mfma_f32_16x16x32_bf16 v[88:91], v[48:51], a[80:83], v[88:91]
  v_exp_f32_e64 v23, -v23
  v_mfma_f32_16x16x32_bf16 v[96:99], v[48:51], a[84:87], v[96:99]
  ds_read_b128 v[40:43], v2 offset:15360
  v_mul_f32 v171, v167, v171
  v_mfma_f32_16x16x32_bf16 v[104:107], v[48:51], a[88:91], v[104:107]
  v_exp_f32_e64 v24, -v24
  v_mfma_f32_16x16x32_bf16 v[112:115], v[48:51], a[92:95], v[112:115]
  v_mul_f32 v176, v172, v176
  s_waitcnt lgkmcnt(2)
  v_mfma_f32_16x16x32_bf16 v[84:87], v[28:31], a[96:99], v[84:87]
  v_exp_f32_e64 v25, -v25
  v_mfma_f32_16x16x32_bf16 v[92:95], v[28:31], a[100:103], v[92:95]
  ds_read_b128 v[44:47], v2 offset:16384
  v_mul_f32 v177, v173, v177
  v_mfma_f32_16x16x32_bf16 v[100:103], v[28:31], a[104:107], v[100:103]
  v_exp_f32_e64 v26, -v26
  v_mfma_f32_16x16x32_bf16 v[108:111], v[28:31], a[108:111], v[108:111]
  v_mul_f32 v178, v174, v178
  v_mfma_f32_16x16x32_bf16 v[88:91], v[32:35], a[96:99], v[88:91]
  v_exp_f32_e64 v27, -v27
  v_mfma_f32_16x16x32_bf16 v[96:99], v[32:35], a[100:103], v[96:99]
  ds_read_b128 v[48:51], v2 offset:17408
  buffer_load_dwordx4 v1, s[8:11], s27 offen offset:3072 lds
  v_mfma_f32_16x16x32_bf16 v[104:107], v[32:35], a[104:107], v[104:107]
  v_mul_f32 v179, v175, v179
  v_add_f32 v20, 1.0, v20
  v_mfma_f32_16x16x32_bf16 v[112:115], v[32:35], a[108:111], v[112:115]
  v_add_f32 v21, 1.0, v21
  s_waitcnt lgkmcnt(2)
  v_mfma_f32_16x16x32_bf16 v[84:87], v[36:39], a[112:115], v[84:87]
  v_add_f32 v22, 1.0, v22
  v_add_f32 v23, 1.0, v23
  v_mfma_f32_16x16x32_bf16 v[92:95], v[36:39], a[116:119], v[92:95]
  ds_read_b128 v[28:31], v2 offset:18432
  v_add_f32 v24, 1.0, v24
  v_mfma_f32_16x16x32_bf16 v[100:103], v[36:39], a[120:123], v[100:103]
  v_add_f32 v25, 1.0, v25
  v_add_f32 v26, 1.0, v26
  v_mfma_f32_16x16x32_bf16 v[108:111], v[36:39], a[124:127], v[108:111]
  v_add_f32 v27, 1.0, v27
  v_mfma_f32_16x16x32_bf16 v[88:91], v[40:43], a[112:115], v[88:91]
  v_rcp_f32 v20, v20
  v_mfma_f32_16x16x32_bf16 v[96:99], v[40:43], a[116:119], v[96:99]
  ds_read_b128 v[32:35], v2 offset:19456
  v_mfma_f32_16x16x32_bf16 v[104:107], v[40:43], a[120:123], v[104:107]
  v_rcp_f32 v21, v21
  v_mfma_f32_16x16x32_bf16 v[112:115], v[40:43], a[124:127], v[112:115]
  s_add_u32 m0, s23, 81920
  s_waitcnt lgkmcnt(2)
  v_mfma_f32_16x16x32_bf16 v[84:87], v[44:47], a[128:131], v[84:87]
  s_add_u32 s27, s24, 229376
  buffer_load_dwordx4 v1, s[8:11], s27 offen offset:0 lds
  v_mfma_f32_16x16x32_bf16 v[92:95], v[44:47], a[132:135], v[92:95]
  ds_read_b128 v[36:39], v2 offset:20480
  v_mfma_f32_16x16x32_bf16 v[100:103], v[44:47], a[136:139], v[100:103]
  v_rcp_f32 v22, v22
  v_mfma_f32_16x16x32_bf16 v[108:111], v[44:47], a[140:143], v[108:111]
  v_rcp_f32 v23, v23
  v_mfma_f32_16x16x32_bf16 v[88:91], v[48:51], a[128:131], v[88:91]
  v_rcp_f32 v24, v24
  v_mfma_f32_16x16x32_bf16 v[96:99], v[48:51], a[132:135], v[96:99]
  ds_read_b128 v[40:43], v2 offset:21504
  v_mfma_f32_16x16x32_bf16 v[104:107], v[48:51], a[136:139], v[104:107]
  v_rcp_f32 v25, v25
  v_mfma_f32_16x16x32_bf16 v[112:115], v[48:51], a[140:143], v[112:115]
  s_waitcnt lgkmcnt(2)
  v_mfma_f32_16x16x32_bf16 v[84:87], v[28:31], a[144:147], v[84:87]
  v_rcp_f32 v26, v26
  v_mfma_f32_16x16x32_bf16 v[92:95], v[28:31], a[148:151], v[92:95]
  ds_read_b128 v[44:47], v2 offset:22528
  v_mfma_f32_16x16x32_bf16 v[100:103], v[28:31], a[152:155], v[100:103]
  v_rcp_f32 v27, v27
  v_mfma_f32_16x16x32_bf16 v[108:111], v[28:31], a[156:159], v[108:111]
  v_mul_f32 v168, v168, v20
  v_mul_f32 v169, v169, v21
  v_mfma_f32_16x16x32_bf16 v[88:91], v[32:35], a[144:147], v[88:91]
  v_mul_f32 v170, v170, v22
  v_mul_f32 v171, v171, v23
  v_mfma_f32_16x16x32_bf16 v[96:99], v[32:35], a[148:151], v[96:99]
  ds_read_b128 v[48:51], v2 offset:23552
  v_mul_f32 v176, v176, v24
  v_mfma_f32_16x16x32_bf16 v[104:107], v[32:35], a[152:155], v[104:107]
  v_mul_f32 v177, v177, v25
  v_mul_f32 v178, v178, v26
  v_mfma_f32_16x16x32_bf16 v[112:115], v[32:35], a[156:159], v[112:115]
  v_mul_f32 v179, v179, v27
  s_waitcnt lgkmcnt(2)
  v_mfma_f32_16x16x32_bf16 v[84:87], v[36:39], a[160:163], v[84:87]
  v_cvt_pk_bf16_f32 v16, v168, v169
  v_cvt_pk_bf16_f32 v17, v170, v171
  v_mfma_f32_16x16x32_bf16 v[92:95], v[36:39], a[164:167], v[92:95]
  ds_read_b128 v[28:31], v2 offset:24576
  v_cvt_pk_bf16_f32 v18, v176, v177
  v_mfma_f32_16x16x32_bf16 v[100:103], v[36:39], a[168:171], v[100:103]
  v_cvt_pk_bf16_f32 v19, v178, v179
  s_add_u32 s29, s26, 295936
  v_mfma_f32_16x16x32_bf16 v[108:111], v[36:39], a[172:175], v[108:111]
  s_nop 0
  v_permlane16_swap_b32 v16, v18
  v_mfma_f32_16x16x32_bf16 v[88:91], v[40:43], a[160:163], v[88:91]
  v_permlane16_swap_b32 v17, v19
  buffer_store_dwordx4 v[16:19], v6, s[16:19], s29 offen sc1
  v_mfma_f32_16x16x32_bf16 v[96:99], v[40:43], a[164:167], v[96:99]
  ds_read_b128 v[32:35], v2 offset:25600
  v_fma_f32 v20, v180, v180, s43
  v_mfma_f32_16x16x32_bf16 v[104:107], v[40:43], a[168:171], v[104:107]
  v_fma_f32 v21, v181, v181, s43
  v_fma_f32 v22, v182, v182, s43
  v_mfma_f32_16x16x32_bf16 v[112:115], v[40:43], a[172:175], v[112:115]
  v_fma_f32 v23, v183, v183, s43
  s_waitcnt lgkmcnt(2)
  v_mfma_f32_16x16x32_bf16 v[84:87], v[44:47], a[176:179], v[84:87]
  v_fma_f32 v24, v188, v188, s43
  v_fma_f32 v25, v189, v189, s43
  v_mfma_f32_16x16x32_bf16 v[92:95], v[44:47], a[180:183], v[92:95]
  ds_read_b128 v[36:39], v2 offset:26624
  v_fma_f32 v26, v190, v190, s43
  v_mfma_f32_16x16x32_bf16 v[100:103], v[44:47], a[184:187], v[100:103]
  v_fma_f32 v27, v191, v191, s43
  v_mul_f32 v20, v20, v180
  v_mfma_f32_16x16x32_bf16 v[108:111], v[44:47], a[188:191], v[108:111]
  v_mul_f32 v21, v21, v181
  v_mul_f32 v22, v22, v182
  v_mfma_f32_16x16x32_bf16 v[88:91], v[48:51], a[176:179], v[88:91]
  v_mul_f32 v23, v23, v183
  v_mul_f32 v24, v24, v188
  v_mfma_f32_16x16x32_bf16 v[96:99], v[48:51], a[180:183], v[96:99]
  ds_read_b128 v[40:43], v2 offset:27648
  v_mul_f32 v25, v25, v189
  v_mfma_f32_16x16x32_bf16 v[104:107], v[48:51], a[184:187], v[104:107]
  v_mul_f32 v26, v26, v190
  v_mul_f32 v27, v27, v191
  v_mfma_f32_16x16x32_bf16 v[112:115], v[48:51], a[188:191], v[112:115]
  s_waitcnt lgkmcnt(2)
  v_mfma_f32_16x16x32_bf16 v[84:87], v[28:31], a[192:195], v[84:87]
  v_exp_f32_e64 v20, -v20
  v_mfma_f32_16x16x32_bf16 v[92:95], v[28:31], a[196:199], v[92:95]
  ds_read_b128 v[44:47], v2 offset:28672
  v_mul_f32 v184, v180, v184
  v_mfma_f32_16x16x32_bf16 v[100:103], v[28:31], a[200:203], v[100:103]
  v_exp_f32_e64 v21, -v21
  v_mfma_f32_16x16x32_bf16 v[108:111], v[28:31], a[204:207], v[108:111]
  v_mul_f32 v185, v181, v185
  v_mfma_f32_16x16x32_bf16 v[88:91], v[32:35], a[192:195], v[88:91]
  v_exp_f32_e64 v22, -v22
  v_mfma_f32_16x16x32_bf16 v[96:99], v[32:35], a[196:199], v[96:99]
  ds_read_b128 v[48:51], v2 offset:29696
  v_mul_f32 v186, v182, v186
  v_mfma_f32_16x16x32_bf16 v[104:107], v[32:35], a[200:203], v[104:107]
  v_exp_f32_e64 v23, -v23
  v_mfma_f32_16x16x32_bf16 v[112:115], v[32:35], a[204:207], v[112:115]
  v_mul_f32 v187, v183, v187
  s_waitcnt lgkmcnt(2)
  v_mfma_f32_16x16x32_bf16 v[84:87], v[36:39], a[208:211], v[84:87]
  v_exp_f32_e64 v24, -v24
  v_mfma_f32_16x16x32_bf16 v[92:95], v[36:39], a[212:215], v[92:95]
  ds_read_b128 v[28:31], v2 offset:30720
  v_mul_f32 v192, v188, v192
  v_mfma_f32_16x16x32_bf16 v[100:103], v[36:39], a[216:219], v[100:103]
  v_exp_f32_e64 v25, -v25
  v_mfma_f32_16x16x32_bf16 v[108:111], v[36:39], a[220:223], v[108:111]
  v_mul_f32 v193, v189, v193
  v_mfma_f32_16x16x32_bf16 v[88:91], v[40:43], a[208:211], v[88:91]
  v_exp_f32_e64 v26, -v26
  v_mfma_f32_16x16x32_bf16 v[96:99], v[40:43], a[212:215], v[96:99]
  ds_read_b128 v[32:35], v2 offset:31744
  v_mul_f32 v194, v190, v194
  v_mfma_f32_16x16x32_bf16 v[104:107], v[40:43], a[216:219], v[104:107]
  v_exp_f32_e64 v27, -v27
  v_mfma_f32_16x16x32_bf16 v[112:115], v[40:43], a[220:223], v[112:115]
  v_mul_f32 v195, v191, v195
  s_waitcnt lgkmcnt(2)
  v_mfma_f32_16x16x32_bf16 v[84:87], v[44:47], a[224:227], v[84:87]
  v_add_f32 v20, 1.0, v20
  v_add_f32 v21, 1.0, v21
  v_mfma_f32_16x16x32_bf16 v[92:95], v[44:47], a[228:231], v[92:95]
  ds_read_b128 v[36:39], v2 offset:32768
  v_add_f32 v22, 1.0, v22
  v_mfma_f32_16x16x32_bf16 v[100:103], v[44:47], a[232:235], v[100:103]
  v_add_f32 v23, 1.0, v23
  v_add_f32 v24, 1.0, v24
  v_mfma_f32_16x16x32_bf16 v[108:111], v[44:47], a[236:239], v[108:111]
  v_add_f32 v25, 1.0, v25
  v_add_f32 v26, 1.0, v26
  v_mfma_f32_16x16x32_bf16 v[88:91], v[48:51], a[224:227], v[88:91]
  v_add_f32 v27, 1.0, v27
  v_mfma_f32_16x16x32_bf16 v[96:99], v[48:51], a[228:231], v[96:99]
  ds_read_b128 v[40:43], v2 offset:33792
  v_mfma_f32_16x16x32_bf16 v[104:107], v[48:51], a[232:235], v[104:107]
  v_rcp_f32 v20, v20
  v_mfma_f32_16x16x32_bf16 v[112:115], v[48:51], a[236:239], v[112:115]
  s_waitcnt lgkmcnt(2)
  v_mfma_f32_16x16x32_bf16 v[84:87], v[28:31], a[240:243], v[84:87]
  v_rcp_f32 v21, v21
  v_mfma_f32_16x16x32_bf16 v[92:95], v[28:31], a[244:247], v[92:95]
  ds_read_b128 v[44:47], v2 offset:34816
  v_mfma_f32_16x16x32_bf16 v[100:103], v[28:31], a[248:251], v[100:103]
  v_rcp_f32 v22, v22
  v_mfma_f32_16x16x32_bf16 v[108:111], v[28:31], a[252:255], v[108:111]
  v_rcp_f32 v23, v23
  v_mfma_f32_16x16x32_bf16 v[88:91], v[32:35], a[240:243], v[88:91]
  v_rcp_f32 v24, v24
  v_mfma_f32_16x16x32_bf16 v[96:99], v[32:35], a[244:247], v[96:99]
  ds_read_b128 v[48:51], v2 offset:35840
  v_mfma_f32_16x16x32_bf16 v[104:107], v[32:35], a[248:251], v[104:107]
  v_rcp_f32 v25, v25
  v_mfma_f32_16x16x32_bf16 v[112:115], v[32:35], a[252:255], v[112:115]
  s_waitcnt lgkmcnt(2)
  s_waitcnt vmcnt(12)
  s_barrier
  v_mfma_f32_16x16x32_bf16 v[84:87], v[36:39], v[52:55], v[84:87]
  s_add_u32 m0, s23, 110592
  s_add_u32 s27, s24, 258048
  v_mfma_f32_16x16x32_bf16 v[92:95], v[36:39], v[56:59], v[92:95]
  ds_read_b128 v[28:31], v3 offset:0
  buffer_load_dwordx4 v1, s[8:11], s27 offen offset:0 lds
  v_mfma_f32_16x16x32_bf16 v[100:103], v[36:39], v[60:63], v[100:103]
  v_rcp_f32 v26, v26
  v_mfma_f32_16x16x32_bf16 v[108:111], v[36:39], v[64:67], v[108:111]
  v_rcp_f32 v27, v27
  v_mfma_f32_16x16x32_bf16 v[88:91], v[40:43], v[52:55], v[88:91]
  v_mul_f32 v184, v184, v20
  v_mul_f32 v185, v185, v21
  v_mfma_f32_16x16x32_bf16 v[96:99], v[40:43], v[56:59], v[96:99]
  ds_read_b128 v[32:35], v3 offset:1024
  v_mul_f32 v186, v186, v22
  v_mfma_f32_16x16x32_bf16 v[104:107], v[40:43], v[60:63], v[104:107]
  v_mul_f32 v187, v187, v23
  v_mul_f32 v192, v192, v24
  v_mfma_f32_16x16x32_bf16 v[112:115], v[40:43], v[64:67], v[112:115]
  v_mul_f32 v193, v193, v25
  s_waitcnt lgkmcnt(2)
  v_mfma_f32_16x16x32_bf16 v[84:87], v[44:47], v[68:71], v[84:87]
  v_mul_f32 v194, v194, v26
  v_mul_f32 v195, v195, v27
  v_mfma_f32_16x16x32_bf16 v[92:95], v[44:47], v[72:75], v[92:95]
  ds_read_b128 v[36:39], v3 offset:2048
  buffer_load_dwordx4 v1, s[8:11], s27 offen offset:1024 lds
  v_mfma_f32_16x16x32_bf16 v[100:103], v[44:47], v[76:79], v[100:103]
  v_cvt_pk_bf16_f32 v12, v184, v185
  v_cvt_pk_bf16_f32 v13, v186, v187
  v_mfma_f32_16x16x32_bf16 v[108:111], v[44:47], v[80:83], v[108:111]
  v_cvt_pk_bf16_f32 v14, v192, v193
  v_cvt_pk_bf16_f32 v15, v194, v195
  v_mfma_f32_16x16x32_bf16 v[88:91], v[48:51], v[68:71], v[88:91]
  s_add_u32 s29, s26, 1536
  s_nop 0
  v_mfma_f32_16x16x32_bf16 v[96:99], v[48:51], v[72:75], v[96:99]
  ds_read_b128 v[40:43], v3 offset:3072
  v_permlane16_swap_b32 v12, v14
  v_mfma_f32_16x16x32_bf16 v[104:107], v[48:51], v[76:79], v[104:107]
  v_permlane16_swap_b32 v13, v15
  buffer_store_dwordx4 v[12:15], v6, s[16:19], s29 offen sc1
  v_mfma_f32_16x16x32_bf16 v[112:115], v[48:51], v[80:83], v[112:115]
  v_fma_f32 v20, v196, v196, s43
  s_waitcnt lgkmcnt(2)
  v_mfma_f32_16x16x32_bf16 v[116:119], v[28:31], a[0:3], 0
  v_fma_f32 v21, v197, v197, s43
  v_fma_f32 v22, v198, v198, s43
  v_mfma_f32_16x16x32_bf16 v[124:127], v[28:31], a[4:7], 0
  ds_read_b128 v[44:47], v3 offset:4096
  v_fma_f32 v23, v199, v199, s43
  v_mfma_f32_16x16x32_bf16 v[132:135], v[28:31], a[8:11], 0
  v_fma_f32 v24, v204, v204, s43
  v_fma_f32 v25, v205, v205, s43
  v_mfma_f32_16x16x32_bf16 v[140:143], v[28:31], a[12:15], 0
  buffer_load_dwordx4 v1, s[8:11], s27 offen offset:2048 lds
  v_fma_f32 v26, v206, v206, s43
  v_mfma_f32_16x16x32_bf16 v[120:123], v[32:35], a[0:3], 0
  v_fma_f32 v27, v207, v207, s43
  v_mul_f32 v20, v20, v196
  v_mfma_f32_16x16x32_bf16 v[128:131], v[32:35], a[4:7], 0
  ds_read_b128 v[48:51], v3 offset:5120
  v_mul_f32 v21, v21, v197
  v_mfma_f32_16x16x32_bf16 v[136:139], v[32:35], a[8:11], 0
  v_mul_f32 v22, v22, v198
  v_mul_f32 v23, v23, v199
  v_mfma_f32_16x16x32_bf16 v[144:147], v[32:35], a[12:15], 0
  v_mul_f32 v24, v24, v204
  s_waitcnt lgkmcnt(2)
  v_mfma_f32_16x16x32_bf16 v[116:119], v[36:39], a[16:19], v[116:119]
  v_mul_f32 v25, v25, v205
  v_mul_f32 v26, v26, v206
  v_mfma_f32_16x16x32_bf16 v[124:127], v[36:39], a[20:23], v[124:127]
  ds_read_b128 v[28:31], v3 offset:6144
  v_mul_f32 v27, v27, v207
  v_mfma_f32_16x16x32_bf16 v[132:135], v[36:39], a[24:27], v[132:135]
  v_exp_f32_e64 v20, -v20
  v_mfma_f32_16x16x32_bf16 v[140:143], v[36:39], a[28:31], v[140:143]
  v_mul_f32 v200, v196, v200
  v_mfma_f32_16x16x32_bf16 v[120:123], v[40:43], a[16:19], v[120:123]
  v_exp_f32_e64 v21, -v21
  v_mfma_f32_16x16x32_bf16 v[128:131], v[40:43], a[20:23], v[128:131]
  ds_read_b128 v[32:35], v3 offset:7168
  buffer_load_dwordx4 v1, s[8:11], s27 offen offset:3072 lds
  v_mfma_f32_16x16x32_bf16 v[136:139], v[40:43], a[24:27], v[136:139]
  v_mul_f32 v201, v197, v201
  v_mfma_f32_16x16x32_bf16 v[144:147], v[40:43], a[28:31], v[144:147]
  s_waitcnt lgkmcnt(2)
  v_mfma_f32_16x16x32_bf16 v[116:119], v[44:47], a[32:35], v[116:119]
  v_exp_f32_e64 v22, -v22
  v_mfma_f32_16x16x32_bf16 v[124:127], v[44:47], a[36:39], v[124:127]
  ds_read_b128 v[36:39], v3 offset:8192
  v_mul_f32 v202, v198, v202
  v_mfma_f32_16x16x32_bf16 v[132:135], v[44:47], a[40:43], v[132:135]
  v_exp_f32_e64 v23, -v23
  v_mfma_f32_16x16x32_bf16 v[140:143], v[44:47], a[44:47], v[140:143]
  v_mul_f32 v203, v199, v203
  v_mfma_f32_16x16x32_bf16 v[120:123], v[48:51], a[32:35], v[120:123]
  v_exp_f32_e64 v24, -v24
  v_mfma_f32_16x16x32_bf16 v[128:131], v[48:51], a[36:39], v[128:131]
  ds_read_b128 v[40:43], v3 offset:9216
  v_mul_f32 v208, v204, v208
  v_mfma_f32_16x16x32_bf16 v[136:139], v[48:51], a[40:43], v[136:139]
  v_exp_f32_e64 v25, -v25
  v_mfma_f32_16x16x32_bf16 v[144:147], v[48:51], a[44:47], v[144:147]
  s_add_u32 m0, s23, 114688
  s_waitcnt lgkmcnt(2)
  v_mfma_f32_16x16x32_bf16 v[116:119], v[28:31], a[48:51], v[116:119]
  s_add_u32 s27, s24, 262144
  buffer_load_dwordx4 v1, s[8:11], s27 offen offset:0 lds
  v_mfma_f32_16x16x32_bf16 v[124:127], v[28:31], a[52:55], v[124:127]
  ds_read_b128 v[44:47], v3 offset:10240
  v_mul_f32 v209, v205, v209
  v_mfma_f32_16x16x32_bf16 v[132:135], v[28:31], a[56:59], v[132:135]
  v_exp_f32_e64 v26, -v26
  v_mfma_f32_16x16x32_bf16 v[140:143], v[28:31], a[60:63], v[140:143]
  v_mul_f32 v210, v206, v210
  v_mfma_f32_16x16x32_bf16 v[120:123], v[32:35], a[48:51], v[120:123]
  v_exp_f32_e64 v27, -v27
  v_mfma_f32_16x16x32_bf16 v[128:131], v[32:35], a[52:55], v[128:131]
  ds_read_b128 v[48:51], v3 offset:11264
  v_mul_f32 v211, v207, v211
  v_mfma_f32_16x16x32_bf16 v[136:139], v[32:35], a[56:59], v[136:139]
  v_add_f32 v20, 1.0, v20
  v_add_f32 v21, 1.0, v21
  v_mfma_f32_16x16x32_bf16 v[144:147], v[32:35], a[60:63], v[144:147]
  v_add_f32 v22, 1.0, v22
  s_waitcnt lgkmcnt(2)
  v_mfma_f32_16x16x32_bf16 v[116:119], v[36:39], a[64:67], v[116:119]
  v_add_f32 v23, 1.0, v23
  v_add_f32 v24, 1.0, v24
  v_mfma_f32_16x16x32_bf16 v[124:127], v[36:39], a[68:71], v[124:127]
  ds_read_b128 v[28:31], v3 offset:12288
  buffer_load_dwordx4 v1, s[8:11], s27 offen offset:1024 lds
  v_mfma_f32_16x16x32_bf16 v[132:135], v[36:39], a[72:75], v[132:135]
  v_add_f32 v25, 1.0, v25
  v_add_f32 v26, 1.0, v26
  v_mfma_f32_16x16x32_bf16 v[140:143], v[36:39], a[76:79], v[140:143]
  v_add_f32 v27, 1.0, v27
  v_mfma_f32_16x16x32_bf16 v[120:123], v[40:43], a[64:67], v[120:123]
  v_rcp_f32 v20, v20
  v_mfma_f32_16x16x32_bf16 v[128:131], v[40:43], a[68:71], v[128:131]
  ds_read_b128 v[32:35], v3 offset:13312
  v_mfma_f32_16x16x32_bf16 v[136:139], v[40:43], a[72:75], v[136:139]
  v_rcp_f32 v21, v21
  v_mfma_f32_16x16x32_bf16 v[144:147], v[40:43], a[76:79], v[144:147]
  s_waitcnt lgkmcnt(2)
  v_mfma_f32_16x16x32_bf16 v[116:119], v[44:47], a[80:83], v[116:119]
  v_rcp_f32 v22, v22
  v_mfma_f32_16x16x32_bf16 v[124:127], v[44:47], a[84:87], v[124:127]
  ds_read_b128 v[36:39], v3 offset:14336
  v_mfma_f32_16x16x32_bf16 v[132:135], v[44:47], a[88:91], v[132:135]
  v_rcp_f32 v23, v23
  v_mfma_f32_16x16x32_bf16 v[140:143], v[44:47], a[92:95], v[140:143]
  buffer_load_dwordx4 v1, s[8:11], s27 offen offset:2048 lds
  v_mfma_f32_16x16x32_bf16 v[120:123], v[48:51], a[80:83], v[120:123]
  v_rcp_f32 v24, v24
  v_mfma_f32_16x16x32_bf16 v[128:131], v[48:51], a[84:87], v[128:131]
  ds_read_b128 v[40:43], v3 offset:15360
  v_mfma_f32_16x16x32_bf16 v[136:139], v[48:51], a[88:91], v[136:139]
  v_rcp_f32 v25, v25
  v_mfma_f32_16x16x32_bf16 v[144:147], v[48:51], a[92:95], v[144:147]
  s_waitcnt lgkmcnt(2)
  v_mfma_f32_16x16x32_bf16 v[116:119], v[28:31], a[96:99], v[116:119]
  v_rcp_f32 v26, v26
  v_mfma_f32_16x16x32_bf16 v[124:127], v[28:31], a[100:103], v[124:127]
  ds_read_b128 v[44:47], v3 offset:16384
  v_mfma_f32_16x16x32_bf16 v[132:135], v[28:31], a[104:107], v[132:135]
  v_rcp_f32 v27, v27
  v_mfma_f32_16x16x32_bf16 v[140:143], v[28:31], a[108:111], v[140:143]
  v_mul_f32 v200, v200, v20
  v_mul_f32 v201, v201, v21
  v_mfma_f32_16x16x32_bf16 v[120:123], v[32:35], a[96:99], v[120:123]
  v_mul_f32 v202, v202, v22
  v_mul_f32 v203, v203, v23
  v_mfma_f32_16x16x32_bf16 v[128:131], v[32:35], a[100:103], v[128:131]
  ds_read_b128 v[48:51], v3 offset:17408
  buffer_load_dwordx4 v1, s[8:11], s27 offen offset:3072 lds
  v_mfma_f32_16x16x32_bf16 v[136:139], v[32:35], a[104:107], v[136:139]
  v_mul_f32 v208, v208, v24
  v_mul_f32 v209, v209, v25
  v_mfma_f32_16x16x32_bf16 v[144:147], v[32:35], a[108:111], v[144:147]
  v_mul_f32 v210, v210, v26
  s_waitcnt lgkmcnt(2)
  v_mfma_f32_16x16x32_bf16 v[116:119], v[36:39], a[112:115], v[116:119]
  v_mul_f32 v211, v211, v27
  v_cvt_pk_bf16_f32 v16, v200, v201
  v_mfma_f32_16x16x32_bf16 v[124:127], v[36:39], a[116:119], v[124:127]
  ds_read_b128 v[28:31], v3 offset:18432
  v_cvt_pk_bf16_f32 v17, v202, v203
  v_mfma_f32_16x16x32_bf16 v[132:135], v[36:39], a[120:123], v[132:135]
  v_cvt_pk_bf16_f32 v18, v208, v209
  v_cvt_pk_bf16_f32 v19, v210, v211
  v_mfma_f32_16x16x32_bf16 v[140:143], v[36:39], a[124:127], v[140:143]
  s_add_u32 s29, s26, 296448
  s_nop 0
  v_mfma_f32_16x16x32_bf16 v[120:123], v[40:43], a[112:115], v[120:123]
  v_permlane16_swap_b32 v16, v18
  v_permlane16_swap_b32 v17, v19
  v_mfma_f32_16x16x32_bf16 v[128:131], v[40:43], a[116:119], v[128:131]
  ds_read_b128 v[32:35], v3 offset:19456
  buffer_store_dwordx4 v[16:19], v6, s[16:19], s29 offen sc1
  v_mfma_f32_16x16x32_bf16 v[136:139], v[40:43], a[120:123], v[136:139]
  v_fma_f32 v20, v84, v84, s43
  v_fma_f32 v21, v85, v85, s43
  v_mfma_f32_16x16x32_bf16 v[144:147], v[40:43], a[124:127], v[144:147]
  s_add_u32 m0, s23, 118784
  s_waitcnt lgkmcnt(2)
  v_mfma_f32_16x16x32_bf16 v[116:119], v[44:47], a[128:131], v[116:119]
  s_add_u32 s27, s24, 266240
  buffer_load_dwordx4 v1, s[8:11], s27 offen offset:0 lds
  v_mfma_f32_16x16x32_bf16 v[124:127], v[44:47], a[132:135], v[124:127]
  ds_read_b128 v[36:39], v3 offset:20480
  v_fma_f32 v22, v86, v86, s43
  v_mfma_f32_16x16x32_bf16 v[132:135], v[44:47], a[136:139], v[132:135]
  v_fma_f32 v23, v87, v87, s43
  v_fma_f32 v24, v92, v92, s43
  v_mfma_f32_16x16x32_bf16 v[140:143], v[44:47], a[140:143], v[140:143]
  v_fma_f32 v25, v93, v93, s43
  v_fma_f32 v26, v94, v94, s43
  v_mfma_f32_16x16x32_bf16 v[120:123], v[48:51], a[128:131], v[120:123]
  v_fma_f32 v27, v95, v95, s43
  v_mul_f32 v20, v20, v84
  v_mfma_f32_16x16x32_bf16 v[128:131], v[48:51], a[132:135], v[128:131]
  ds_read_b128 v[40:43], v3 offset:21504
  v_mul_f32 v21, v21, v85
  v_mfma_f32_16x16x32_bf16 v[136:139], v[48:51], a[136:139], v[136:139]
  v_mul_f32 v22, v22, v86
  v_mul_f32 v23, v23, v87
  v_mfma_f32_16x16x32_bf16 v[144:147], v[48:51], a[140:143], v[144:147]
  v_mul_f32 v24, v24, v92
  s_waitcnt lgkmcnt(2)
  v_mfma_f32_16x16x32_bf16 v[116:119], v[28:31], a[144:147], v[116:119]
  v_mul_f32 v25, v25, v93
  v_mul_f32 v26, v26, v94
  v_mfma_f32_16x16x32_bf16 v[124:127], v[28:31], a[148:151], v[124:127]
  ds_read_b128 v[44:47], v3 offset:22528
  v_mul_f32 v27, v27, v95
  v_mfma_f32_16x16x32_bf16 v[132:135], v[28:31], a[152:155], v[132:135]
  v_exp_f32_e64 v20, -v20
  v_mfma_f32_16x16x32_bf16 v[140:143], v[28:31], a[156:159], v[140:143]
  v_mul_f32 v88, v84, v88
  v_mfma_f32_16x16x32_bf16 v[120:123], v[32:35], a[144:147], v[120:123]
  v_exp_f32_e64 v21, -v21
  v_mfma_f32_16x16x32_bf16 v[128:131], v[32:35], a[148:151], v[128:131]
  ds_read_b128 v[48:51], v3 offset:23552
  v_mul_f32 v89, v85, v89
  v_mfma_f32_16x16x32_bf16 v[136:139], v[32:35], a[152:155], v[136:139]
  v_exp_f32_e64 v22, -v22
  v_mfma_f32_16x16x32_bf16 v[144:147], v[32:35], a[156:159], v[144:147]
  v_mul_f32 v90, v86, v90
  s_waitcnt lgkmcnt(2)
  v_mfma_f32_16x16x32_bf16 v[116:119], v[36:39], a[160:163], v[116:119]
  v_exp_f32_e64 v23, -v23
  v_mfma_f32_16x16x32_bf16 v[124:127], v[36:39], a[164:167], v[124:127]
  ds_read_b128 v[28:31], v3 offset:24576
  v_mul_f32 v91, v87, v91
  v_mfma_f32_16x16x32_bf16 v[132:135], v[36:39], a[168:171], v[132:135]
  v_exp_f32_e64 v24, -v24
  v_mfma_f32_16x16x32_bf16 v[140:143], v[36:39], a[172:175], v[140:143]
  v_mul_f32 v96, v92, v96
  v_mfma_f32_16x16x32_bf16 v[120:123], v[40:43], a[160:163], v[120:123]
  v_exp_f32_e64 v25, -v25
  v_mfma_f32_16x16x32_bf16 v[128:131], v[40:43], a[164:167], v[128:131]
  ds_read_b128 v[32:35], v3 offset:25600
  v_mul_f32 v97, v93, v97
  v_mfma_f32_16x16x32_bf16 v[136:139], v[40:43], a[168:171], v[136:139]
  v_exp_f32_e64 v26, -v26
  v_mfma_f32_16x16x32_bf16 v[144:147], v[40:43], a[172:175], v[144:147]
  v_mul_f32 v98, v94, v98
  s_waitcnt lgkmcnt(2)
  v_mfma_f32_16x16x32_bf16 v[116:119], v[44:47], a[176:179], v[116:119]
  v_exp_f32_e64 v27, -v27
  v_mfma_f32_16x16x32_bf16 v[124:127], v[44:47], a[180:183], v[124:127]
  ds_read_b128 v[36:39], v3 offset:26624
  v_mul_f32 v99, v95, v99
  v_mfma_f32_16x16x32_bf16 v[132:135], v[44:47], a[184:187], v[132:135]
  v_add_f32 v20, 1.0, v20
  v_add_f32 v21, 1.0, v21
  v_mfma_f32_16x16x32_bf16 v[140:143], v[44:47], a[188:191], v[140:143]
  v_add_f32 v22, 1.0, v22
  v_add_f32 v23, 1.0, v23
  v_mfma_f32_16x16x32_bf16 v[120:123], v[48:51], a[176:179], v[120:123]
  v_add_f32 v24, 1.0, v24
  v_add_f32 v25, 1.0, v25
  v_mfma_f32_16x16x32_bf16 v[128:131], v[48:51], a[180:183], v[128:131]
  ds_read_b128 v[40:43], v3 offset:27648
  v_add_f32 v26, 1.0, v26
  v_mfma_f32_16x16x32_bf16 v[136:139], v[48:51], a[184:187], v[136:139]
  v_add_f32 v27, 1.0, v27
  v_mfma_f32_16x16x32_bf16 v[144:147], v[48:51], a[188:191], v[144:147]
  s_waitcnt lgkmcnt(2)
  v_mfma_f32_16x16x32_bf16 v[116:119], v[28:31], a[192:195], v[116:119]
  v_rcp_f32 v20, v20
  v_mfma_f32_16x16x32_bf16 v[124:127], v[28:31], a[196:199], v[124:127]
  ds_read_b128 v[44:47], v3 offset:28672
  v_mfma_f32_16x16x32_bf16 v[132:135], v[28:31], a[200:203], v[132:135]
  v_rcp_f32 v21, v21
  v_mfma_f32_16x16x32_bf16 v[140:143], v[28:31], a[204:207], v[140:143]
  v_rcp_f32 v22, v22
  v_mfma_f32_16x16x32_bf16 v[120:123], v[32:35], a[192:195], v[120:123]
  v_rcp_f32 v23, v23
  v_mfma_f32_16x16x32_bf16 v[128:131], v[32:35], a[196:199], v[128:131]
  ds_read_b128 v[48:51], v3 offset:29696
  v_mfma_f32_16x16x32_bf16 v[136:139], v[32:35], a[200:203], v[136:139]
  v_rcp_f32 v24, v24
  v_mfma_f32_16x16x32_bf16 v[144:147], v[32:35], a[204:207], v[144:147]
  s_waitcnt lgkmcnt(2)
  v_mfma_f32_16x16x32_bf16 v[116:119], v[36:39], a[208:211], v[116:119]
  v_rcp_f32 v25, v25
  v_mfma_f32_16x16x32_bf16 v[124:127], v[36:39], a[212:215], v[124:127]
  ds_read_b128 v[28:31], v3 offset:30720
  v_mfma_f32_16x16x32_bf16 v[132:135], v[36:39], a[216:219], v[132:135]
  v_rcp_f32 v26, v26
  v_mfma_f32_16x16x32_bf16 v[140:143], v[36:39], a[220:223], v[140:143]
  v_rcp_f32 v27, v27
  v_mfma_f32_16x16x32_bf16 v[120:123], v[40:43], a[208:211], v[120:123]
  v_mul_f32 v88, v88, v20
  v_mul_f32 v89, v89, v21
  v_mfma_f32_16x16x32_bf16 v[128:131], v[40:43], a[212:215], v[128:131]
  ds_read_b128 v[32:35], v3 offset:31744
  v_mul_f32 v90, v90, v22
  v_mfma_f32_16x16x32_bf16 v[136:139], v[40:43], a[216:219], v[136:139]
  v_mul_f32 v91, v91, v23
  v_mul_f32 v96, v96, v24
  v_mfma_f32_16x16x32_bf16 v[144:147], v[40:43], a[220:223], v[144:147]
  v_mul_f32 v97, v97, v25
  s_waitcnt lgkmcnt(2)
  v_mfma_f32_16x16x32_bf16 v[116:119], v[44:47], a[224:227], v[116:119]
  v_mul_f32 v98, v98, v26
  v_mul_f32 v99, v99, v27
  v_mfma_f32_16x16x32_bf16 v[124:127], v[44:47], a[228:231], v[124:127]
  ds_read_b128 v[36:39], v3 offset:32768
  v_cvt_pk_bf16_f32 v12, v88, v89
  v_mfma_f32_16x16x32_bf16 v[132:135], v[44:47], a[232:235], v[132:135]
  v_cvt_pk_bf16_f32 v13, v90, v91
  v_cvt_pk_bf16_f32 v14, v96, v97
  v_mfma_f32_16x16x32_bf16 v[140:143], v[44:47], a[236:239], v[140:143]
  v_cvt_pk_bf16_f32 v15, v98, v99
  s_add_u32 s29, s26, 2048
  v_mfma_f32_16x16x32_bf16 v[120:123], v[48:51], a[224:227], v[120:123]
  s_nop 0
  v_permlane16_swap_b32 v12, v14
  v_mfma_f32_16x16x32_bf16 v[128:131], v[48:51], a[228:231], v[128:131]
  ds_read_b128 v[40:43], v3 offset:33792
  v_permlane16_swap_b32 v13, v15
  v_mfma_f32_16x16x32_bf16 v[136:139], v[48:51], a[232:235], v[136:139]
  buffer_store_dwordx4 v[12:15], v6, s[16:19], s29 offen sc1
  v_fma_f32 v20, v100, v100, s43
  v_mfma_f32_16x16x32_bf16 v[144:147], v[48:51], a[236:239], v[144:147]
  v_fma_f32 v21, v101, v101, s43
  s_waitcnt lgkmcnt(2)
  v_mfma_f32_16x16x32_bf16 v[116:119], v[28:31], a[240:243], v[116:119]
  v_fma_f32 v22, v102, v102, s43
  v_fma_f32 v23, v103, v103, s43
  v_mfma_f32_16x16x32_bf16 v[124:127], v[28:31], a[244:247], v[124:127]
  ds_read_b128 v[44:47], v3 offset:34816
  v_fma_f32 v24, v108, v108, s43
  v_mfma_f32_16x16x32_bf16 v[132:135], v[28:31], a[248:251], v[132:135]
  v_fma_f32 v25, v109, v109, s43
  v_fma_f32 v26, v110, v110, s43
  v_mfma_f32_16x16x32_bf16 v[140:143], v[28:31], a[252:255], v[140:143]
  v_fma_f32 v27, v111, v111, s43
  v_mul_f32 v20, v20, v100
  v_mfma_f32_16x16x32_bf16 v[120:123], v[32:35], a[240:243], v[120:123]
  v_mul_f32 v21, v21, v101
  v_mul_f32 v22, v22, v102
  v_mfma_f32_16x16x32_bf16 v[128:131], v[32:35], a[244:247], v[128:131]
  ds_read_b128 v[48:51], v3 offset:35840
  v_mul_f32 v23, v23, v103
  v_mfma_f32_16x16x32_bf16 v[136:139], v[32:35], a[248:251], v[136:139]
  v_mul_f32 v24, v24, v108
  v_mul_f32 v25, v25, v109
  v_mfma_f32_16x16x32_bf16 v[144:147], v[32:35], a[252:255], v[144:147]
  v_mul_f32 v26, v26, v110
  s_waitcnt lgkmcnt(2)
  s_waitcnt vmcnt(13)
  s_barrier
  v_mfma_f32_16x16x32_bf16 v[116:119], v[36:39], v[52:55], v[116:119]
  s_add_u32 m0, s23, 0
  s_add_u32 s27, s24, 294912
  v_mfma_f32_16x16x32_bf16 v[124:127], v[36:39], v[56:59], v[124:127]
  ds_read_b128 v[28:31], v4 offset:0
  buffer_load_dwordx4 v1, s[8:11], s27 offen offset:0 lds
  v_mfma_f32_16x16x32_bf16 v[132:135], v[36:39], v[60:63], v[132:135]
  v_mul_f32 v27, v27, v111
  v_mfma_f32_16x16x32_bf16 v[140:143], v[36:39], v[64:67], v[140:143]
  v_exp_f32_e64 v20, -v20
  v_mfma_f32_16x16x32_bf16 v[120:123], v[40:43], v[52:55], v[120:123]
  v_mul_f32 v104, v100, v104
  v_mfma_f32_16x16x32_bf16 v[128:131], v[40:43], v[56:59], v[128:131]
  ds_read_b128 v[32:35], v4 offset:1024
  v_mfma_f32_16x16x32_bf16 v[136:139], v[40:43], v[60:63], v[136:139]
  v_exp_f32_e64 v21, -v21
  v_mfma_f32_16x16x32_bf16 v[144:147], v[40:43], v[64:67], v[144:147]
  v_mul_f32 v105, v101, v105
  s_waitcnt lgkmcnt(2)
  v_mfma_f32_16x16x32_bf16 v[116:119], v[44:47], v[68:71], v[116:119]
  v_exp_f32_e64 v22, -v22
  v_mfma_f32_16x16x32_bf16 v[124:127], v[44:47], v[72:75], v[124:127]
  ds_read_b128 v[36:39], v4 offset:2048
  buffer_load_dwordx4 v1, s[8:11], s27 offen offset:1024 lds
  v_mfma_f32_16x16x32_bf16 v[132:135], v[44:47], v[76:79], v[132:135]
  v_mul_f32 v106, v102, v106
  v_mfma_f32_16x16x32_bf16 v[140:143], v[44:47], v[80:83], v[140:143]
  v_exp_f32_e64 v23, -v23
  v_mfma_f32_16x16x32_bf16 v[120:123], v[48:51], v[68:71], v[120:123]
  v_mul_f32 v107, v103, v107
  v_mfma_f32_16x16x32_bf16 v[128:131], v[48:51], v[72:75], v[128:131]
  ds_read_b128 v[40:43], v4 offset:3072
  v_mfma_f32_16x16x32_bf16 v[136:139], v[48:51], v[76:79], v[136:139]
  v_exp_f32_e64 v24, -v24
  v_mfma_f32_16x16x32_bf16 v[144:147], v[48:51], v[80:83], v[144:147]
  v_mul_f32 v112, v108, v112
  s_waitcnt lgkmcnt(2)
  v_mfma_f32_16x16x32_bf16 v[148:151], v[28:31], a[0:3], 0
  v_exp_f32_e64 v25, -v25
  v_mfma_f32_16x16x32_bf16 v[156:159], v[28:31], a[4:7], 0
  ds_read_b128 v[44:47], v4 offset:4096
  v_mul_f32 v113, v109, v113
  v_mfma_f32_16x16x32_bf16 v[164:167], v[28:31], a[8:11], 0
  v_exp_f32_e64 v26, -v26
  v_mfma_f32_16x16x32_bf16 v[172:175], v[28:31], a[12:15], 0
  buffer_load_dwordx4 v1, s[8:11], s27 offen offset:2048 lds
  v_mul_f32 v114, v110, v114
  v_mfma_f32_16x16x32_bf16 v[152:155], v[32:35], a[0:3], 0
  v_exp_f32_e64 v27, -v27
  v_mfma_f32_16x16x32_bf16 v[160:163], v[32:35], a[4:7], 0
  ds_read_b128 v[48:51], v4 offset:5120
  v_mul_f32 v115, v111, v115
  v_mfma_f32_16x16x32_bf16 v[168:171], v[32:35], a[8:11], 0
  v_add_f32 v20, 1.0, v20
  v_add_f32 v21, 1.0, v21
  v_mfma_f32_16x16x32_bf16 v[176:179], v[32:35], a[12:15], 0
  v_add_f32 v22, 1.0, v22
  s_waitcnt lgkmcnt(2)
  v_mfma_f32_16x16x32_bf16 v[148:151], v[36:39], a[16:19], v[148:151]
  v_add_f32 v23, 1.0, v23
  v_add_f32 v24, 1.0, v24
  v_mfma_f32_16x16x32_bf16 v[156:159], v[36:39], a[20:23], v[156:159]
  ds_read_b128 v[28:31], v4 offset:6144
  v_add_f32 v25, 1.0, v25
  v_mfma_f32_16x16x32_bf16 v[164:167], v[36:39], a[24:27], v[164:167]
  v_add_f32 v26, 1.0, v26
  v_add_f32 v27, 1.0, v27
  v_mfma_f32_16x16x32_bf16 v[172:175], v[36:39], a[28:31], v[172:175]
  v_rcp_f32 v20, v20
  v_mfma_f32_16x16x32_bf16 v[152:155], v[40:43], a[16:19], v[152:155]
  v_rcp_f32 v21, v21
  v_mfma_f32_16x16x32_bf16 v[160:163], v[40:43], a[20:23], v[160:163]
  ds_read_b128 v[32:35], v4 offset:7168
  buffer_load_dwordx4 v1, s[8:11], s27 offen offset:3072 lds
  v_mfma_f32_16x16x32_bf16 v[168:171], v[40:43], a[24:27], v[168:171]
  v_rcp_f32 v22, v22
  v_mfma_f32_16x16x32_bf16 v[176:179], v[40:43], a[28:31], v[176:179]
  s_waitcnt lgkmcnt(2)
  v_mfma_f32_16x16x32_bf16 v[148:151], v[44:47], a[32:35], v[148:151]
  v_rcp_f32 v23, v23
  v_mfma_f32_16x16x32_bf16 v[156:159], v[44:47], a[36:39], v[156:159]
  ds_read_b128 v[36:39], v4 offset:8192
  v_mfma_f32_16x16x32_bf16 v[164:167], v[44:47], a[40:43], v[164:167]
  v_rcp_f32 v24, v24
  v_mfma_f32_16x16x32_bf16 v[172:175], v[44:47], a[44:47], v[172:175]
  v_rcp_f32 v25, v25
  v_mfma_f32_16x16x32_bf16 v[152:155], v[48:51], a[32:35], v[152:155]
  v_rcp_f32 v26, v26
  v_mfma_f32_16x16x32_bf16 v[160:163], v[48:51], a[36:39], v[160:163]
  ds_read_b128 v[40:43], v4 offset:9216
  v_mfma_f32_16x16x32_bf16 v[168:171], v[48:51], a[40:43], v[168:171]
  v_rcp_f32 v27, v27
  v_mfma_f32_16x16x32_bf16 v[176:179], v[48:51], a[44:47], v[176:179]
  s_add_u32 m0, s23, 4096
  s_waitcnt lgkmcnt(2)
  v_mfma_f32_16x16x32_bf16 v[148:151], v[28:31], a[48:51], v[148:151]
  s_add_u32 s27, s24, 299008
  buffer_load_dwordx4 v1, s[8:11], s27 offen offset:0 lds
  v_mfma_f32_16x16x32_bf16 v[156:159], v[28:31], a[52:55], v[156:159]
  ds_read_b128 v[44:47], v4 offset:10240
  v_mul_f32 v104, v104, v20
  v_mfma_f32_16x16x32_bf16 v[164:167], v[28:31], a[56:59], v[164:167]
  v_mul_f32 v105, v105, v21
  v_mul_f32 v106, v106, v22
  v_mfma_f32_16x16x32_bf16 v[172:175], v[28:31], a[60:63], v[172:175]
  v_mul_f32 v107, v107, v23
  v_mul_f32 v112, v112, v24
  v_mfma_f32_16x16x32_bf16 v[152:155], v[32:35], a[48:51], v[152:155]
  v_mul_f32 v113, v113, v25
  v_mul_f32 v114, v114, v26
  v_mfma_f32_16x16x32_bf16 v[160:163], v[32:35], a[52:55], v[160:163]
  ds_read_b128 v[48:51], v4 offset:11264
  v_mul_f32 v115, v115, v27
  v_mfma_f32_16x16x32_bf16 v[168:171], v[32:35], a[56:59], v[168:171]
  v_cvt_pk_bf16_f32 v16, v104, v105
  v_cvt_pk_bf16_f32 v17, v106, v107
  v_mfma_f32_16x16x32_bf16 v[176:179], v[32:35], a[60:63], v[176:179]
  v_cvt_pk_bf16_f32 v18, v112, v113
  s_waitcnt lgkmcnt(2)
  v_mfma_f32_16x16x32_bf16 v[148:151], v[36:39], a[64:67], v[148:151]
  v_cvt_pk_bf16_f32 v19, v114, v115
  s_add_u32 s29, s26, 296960
  v_mfma_f32_16x16x32_bf16 v[156:159], v[36:39], a[68:71], v[156:159]
  ds_read_b128 v[28:31], v4 offset:12288
  buffer_load_dwordx4 v1, s[8:11], s27 offen offset:1024 lds
  v_mfma_f32_16x16x32_bf16 v[164:167], v[36:39], a[72:75], v[164:167]
  s_nop 0
  v_permlane16_swap_b32 v16, v18
  v_mfma_f32_16x16x32_bf16 v[172:175], v[36:39], a[76:79], v[172:175]
  v_permlane16_swap_b32 v17, v19
  buffer_store_dwordx4 v[16:19], v6, s[16:19], s29 offen sc1
  v_mfma_f32_16x16x32_bf16 v[152:155], v[40:43], a[64:67], v[152:155]
  v_fma_f32 v20, v116, v116, s43
  v_fma_f32 v21, v117, v117, s43
  v_mfma_f32_16x16x32_bf16 v[160:163], v[40:43], a[68:71], v[160:163]
  ds_read_b128 v[32:35], v4 offset:13312
  v_fma_f32 v22, v118, v118, s43
  v_mfma_f32_16x16x32_bf16 v[168:171], v[40:43], a[72:75], v[168:171]
  v_fma_f32 v23, v119, v119, s43
  v_fma_f32 v24, v124, v124, s43
  v_mfma_f32_16x16x32_bf16 v[176:179], v[40:43], a[76:79], v[176:179]
  v_fma_f32 v25, v125, v125, s43
  s_waitcnt lgkmcnt(2)
  v_mfma_f32_16x16x32_bf16 v[148:151], v[44:47], a[80:83], v[148:151]
  v_fma_f32 v26, v126, v126, s43
  v_fma_f32 v27, v127, v127, s43
  v_mfma_f32_16x16x32_bf16 v[156:159], v[44:47], a[84:87], v[156:159]
  ds_read_b128 v[36:39], v4 offset:14336
  v_mul_f32 v20, v20, v116
  v_mfma_f32_16x16x32_bf16 v[164:167], v[44:47], a[88:91], v[164:167]
  v_mul_f32 v21, v21, v117
  v_mul_f32 v22, v22, v118
  v_mfma_f32_16x16x32_bf16 v[172:175], v[44:47], a[92:95], v[172:175]
  buffer_load_dwordx4 v1, s[8:11], s27 offen offset:2048 lds
  v_mul_f32 v23, v23, v119
  v_mfma_f32_16x16x32_bf16 v[152:155], v[48:51], a[80:83], v[152:155]
  v_mul_f32 v24, v24, v124
  v_mul_f32 v25, v25, v125
  v_mfma_f32_16x16x32_bf16 v[160:163], v[48:51], a[84:87], v[160:163]
  ds_read_b128 v[40:43], v4 offset:15360
  v_mul_f32 v26, v26, v126
  v_mfma_f32_16x16x32_bf16 v[168:171], v[48:51], a[88:91], v[168:171]
  v_mul_f32 v27, v27, v127
  v_mfma_f32_16x16x32_bf16 v[176:179], v[48:51], a[92:95], v[176:179]
  s_waitcnt lgkmcnt(2)
  v_mfma_f32_16x16x32_bf16 v[148:151], v[28:31], a[96:99], v[148:151]
  v_exp_f32_e64 v20, -v20
  v_mfma_f32_16x16x32_bf16 v[156:159], v[28:31], a[100:103], v[156:159]
  ds_read_b128 v[44:47], v4 offset:16384
  v_mul_f32 v120, v116, v120
  v_mfma_f32_16x16x32_bf16 v[164:167], v[28:31], a[104:107], v[164:167]
  v_exp_f32_e64 v21, -v21
  v_mfma_f32_16x16x32_bf16 v[172:175], v[28:31], a[108:111], v[172:175]
  v_mul_f32 v121, v117, v121
  v_mfma_f32_16x16x32_bf16 v[152:155], v[32:35], a[96:99], v[152:155]
  v_exp_f32_e64 v22, -v22
  v_mfma_f32_16x16x32_bf16 v[160:163], v[32:35], a[100:103], v[160:163]
  ds_read_b128 v[48:51], v4 offset:17408
  buffer_load_dwordx4 v1, s[8:11], s27 offen offset:3072 lds
  v_mfma_f32_16x16x32_bf16 v[168:171], v[32:35], a[104:107], v[168:171]
  v_mul_f32 v122, v118, v122
  v_mfma_f32_16x16x32_bf16 v[176:179], v[32:35], a[108:111], v[176:179]
  s_waitcnt lgkmcnt(2)
  v_mfma_f32_16x16x32_bf16 v[148:151], v[36:39], a[112:115], v[148:151]
  v_exp_f32_e64 v23, -v23
  v_mfma_f32_16x16x32_bf16 v[156:159], v[36:39], a[116:119], v[156:159]
  ds_read_b128 v[28:31], v4 offset:18432
  v_mul_f32 v123, v119, v123
  v_mfma_f32_16x16x32_bf16 v[164:167], v[36:39], a[120:123], v[164:167]
  v_exp_f32_e64 v24, -v24
  v_mfma_f32_16x16x32_bf16 v[172:175], v[36:39], a[124:127], v[172:175]
  v_mul_f32 v128, v124, v128
  v_mfma_f32_16x16x32_bf16 v[152:155], v[40:43], a[112:115], v[152:155]
  v_exp_f32_e64 v25, -v25
  v_mfma_f32_16x16x32_bf16 v[160:163], v[40:43], a[116:119], v[160:163]
  ds_read_b128 v[32:35], v4 offset:19456
  v_mul_f32 v129, v125, v129
  v_mfma_f32_16x16x32_bf16 v[168:171], v[40:43], a[120:123], v[168:171]
  v_exp_f32_e64 v26, -v26
  v_mfma_f32_16x16x32_bf16 v[176:179], v[40:43], a[124:127], v[176:179]
  s_add_u32 m0, s23, 8192
  s_waitcnt lgkmcnt(2)
  v_mfma_f32_16x16x32_bf16 v[148:151], v[44:47], a[128:131], v[148:151]
  s_add_u32 s27, s24, 303104
  buffer_load_dwordx4 v1, s[8:11], s27 offen offset:0 lds
  v_mfma_f32_16x16x32_bf16 v[156:159], v[44:47], a[132:135], v[156:159]
  ds_read_b128 v[36:39], v4 offset:20480
  v_mul_f32 v130, v126, v130
  v_mfma_f32_16x16x32_bf16 v[164:167], v[44:47], a[136:139], v[164:167]
  v_exp_f32_e64 v27, -v27
  v_mfma_f32_16x16x32_bf16 v[172:175], v[44:47], a[140:143], v[172:175]
  v_mul_f32 v131, v127, v131
  v_add_f32 v20, 1.0, v20
  v_mfma_f32_16x16x32_bf16 v[152:155], v[48:51], a[128:131], v[152:155]
  v_add_f32 v21, 1.0, v21
  v_add_f32 v22, 1.0, v22
  v_mfma_f32_16x16x32_bf16 v[160:163], v[48:51], a[132:135], v[160:163]
  ds_read_b128 v[40:43], v4 offset:21504
  v_add_f32 v23, 1.0, v23
  v_mfma_f32_16x16x32_bf16 v[168:171], v[48:51], a[136:139], v[168:171]
  v_add_f32 v24, 1.0, v24
  v_add_f32 v25, 1.0, v25
  v_mfma_f32_16x16x32_bf16 v[176:179], v[48:51], a[140:143], v[176:179]
  v_add_f32 v26, 1.0, v26
  s_waitcnt lgkmcnt(2)
  v_mfma_f32_16x16x32_bf16 v[148:151], v[28:31], a[144:147], v[148:151]
  v_add_f32 v27, 1.0, v27
  v_mfma_f32_16x16x32_bf16 v[156:159], v[28:31], a[148:151], v[156:159]
  ds_read_b128 v[44:47], v4 offset:22528
  s_mov_b32 s44, 0
  v_mfma_f32_16x16x32_bf16 v[164:167], v[28:31], a[152:155], v[164:167]
  buffer_load_dwordx4 v[212:215], v252, s[52:55], s44 offen nt
  v_mfma_f32_16x16x32_bf16 v[172:175], v[28:31], a[156:159], v[172:175]
  v_rcp_f32 v20, v20
  v_mfma_f32_16x16x32_bf16 v[152:155], v[32:35], a[144:147], v[152:155]
  v_rcp_f32 v21, v21
  v_mfma_f32_16x16x32_bf16 v[160:163], v[32:35], a[148:151], v[160:163]
  ds_read_b128 v[48:51], v4 offset:23552
  v_mfma_f32_16x16x32_bf16 v[168:171], v[32:35], a[152:155], v[168:171]
  v_rcp_f32 v22, v22
  v_mfma_f32_16x16x32_bf16 v[176:179], v[32:35], a[156:159], v[176:179]
  s_waitcnt lgkmcnt(2)
  v_mfma_f32_16x16x32_bf16 v[148:151], v[36:39], a[160:163], v[148:151]
  v_rcp_f32 v23, v23
  v_mfma_f32_16x16x32_bf16 v[156:159], v[36:39], a[164:167], v[156:159]
  ds_read_b128 v[28:31], v4 offset:24576
  s_mov_b32 s44, 9216
  v_mfma_f32_16x16x32_bf16 v[164:167], v[36:39], a[168:171], v[164:167]
  buffer_load_dwordx4 v[216:219], v252, s[52:55], s44 offen nt
  v_mfma_f32_16x16x32_bf16 v[172:175], v[36:39], a[172:175], v[172:175]
  v_rcp_f32 v24, v24
  v_mfma_f32_16x16x32_bf16 v[152:155], v[40:43], a[160:163], v[152:155]
  v_rcp_f32 v25, v25
  v_mfma_f32_16x16x32_bf16 v[160:163], v[40:43], a[164:167], v[160:163]
  ds_read_b128 v[32:35], v4 offset:25600
  v_mfma_f32_16x16x32_bf16 v[168:171], v[40:43], a[168:171], v[168:171]
  v_rcp_f32 v26, v26
  v_mfma_f32_16x16x32_bf16 v[176:179], v[40:43], a[172:175], v[176:179]
  s_waitcnt lgkmcnt(2)
  v_mfma_f32_16x16x32_bf16 v[148:151], v[44:47], a[176:179], v[148:151]
  v_rcp_f32 v27, v27
  v_mfma_f32_16x16x32_bf16 v[156:159], v[44:47], a[180:183], v[156:159]
  ds_read_b128 v[36:39], v4 offset:26624
  s_mov_b32 s44, 18432
  v_mfma_f32_16x16x32_bf16 v[164:167], v[44:47], a[184:187], v[164:167]
  buffer_load_dwordx4 v[220:223], v252, s[52:55], s44 offen nt
  v_mul_f32 v120, v120, v20
  v_mfma_f32_16x16x32_bf16 v[172:175], v[44:47], a[188:191], v[172:175]
  v_mul_f32 v121, v121, v21
  v_mul_f32 v122, v122, v22
  v_mfma_f32_16x16x32_bf16 v[152:155], v[48:51], a[176:179], v[152:155]
  v_mul_f32 v123, v123, v23
  v_mul_f32 v128, v128, v24
  v_mfma_f32_16x16x32_bf16 v[160:163], v[48:51], a[180:183], v[160:163]
  ds_read_b128 v[40:43], v4 offset:27648
  v_mul_f32 v129, v129, v25
  v_mfma_f32_16x16x32_bf16 v[168:171], v[48:51], a[184:187], v[168:171]
  v_mul_f32 v130, v130, v26
  v_mul_f32 v131, v131, v27
  v_mfma_f32_16x16x32_bf16 v[176:179], v[48:51], a[188:191], v[176:179]
  v_cvt_pk_bf16_f32 v12, v120, v121
  s_waitcnt lgkmcnt(2)
  v_mfma_f32_16x16x32_bf16 v[148:151], v[28:31], a[192:195], v[148:151]
  v_cvt_pk_bf16_f32 v13, v122, v123
  v_cvt_pk_bf16_f32 v14, v128, v129
  v_mfma_f32_16x16x32_bf16 v[156:159], v[28:31], a[196:199], v[156:159]
  ds_read_b128 v[44:47], v4 offset:28672
  s_mov_b32 s44, 27648
  v_mfma_f32_16x16x32_bf16 v[164:167], v[28:31], a[200:203], v[164:167]
  buffer_load_dwordx4 v[224:227], v252, s[52:55], s44 offen nt
  v_cvt_pk_bf16_f32 v15, v130, v131
  v_mfma_f32_16x16x32_bf16 v[172:175], v[28:31], a[204:207], v[172:175]
  s_add_u32 s29, s26, 2560
  s_nop 0
  v_mfma_f32_16x16x32_bf16 v[152:155], v[32:35], a[192:195], v[152:155]
  v_permlane16_swap_b32 v12, v14
  v_permlane16_swap_b32 v13, v15
  v_mfma_f32_16x16x32_bf16 v[160:163], v[32:35], a[196:199], v[160:163]
  ds_read_b128 v[48:51], v4 offset:29696
  buffer_store_dwordx4 v[12:15], v6, s[16:19], s29 offen sc1
  v_mfma_f32_16x16x32_bf16 v[168:171], v[32:35], a[200:203], v[168:171]
  v_fma_f32 v20, v132, v132, s43
  v_fma_f32 v21, v133, v133, s43
  v_mfma_f32_16x16x32_bf16 v[176:179], v[32:35], a[204:207], v[176:179]
  v_fma_f32 v22, v134, v134, s43
  s_waitcnt lgkmcnt(2)
  v_mfma_f32_16x16x32_bf16 v[148:151], v[36:39], a[208:211], v[148:151]
  v_fma_f32 v23, v135, v135, s43
  v_fma_f32 v24, v140, v140, s43
  v_mfma_f32_16x16x32_bf16 v[156:159], v[36:39], a[212:215], v[156:159]
  ds_read_b128 v[28:31], v4 offset:30720
  s_mov_b32 s44, 36864
  v_mfma_f32_16x16x32_bf16 v[164:167], v[36:39], a[216:219], v[164:167]
  buffer_load_dwordx4 v[228:231], v252, s[52:55], s44 offen nt
  v_fma_f32 v25, v141, v141, s43
  v_mfma_f32_16x16x32_bf16 v[172:175], v[36:39], a[220:223], v[172:175]
  v_fma_f32 v26, v142, v142, s43
  v_fma_f32 v27, v143, v143, s43
  v_mfma_f32_16x16x32_bf16 v[152:155], v[40:43], a[208:211], v[152:155]
  v_mul_f32 v20, v20, v132
  v_mul_f32 v21, v21, v133
  v_mfma_f32_16x16x32_bf16 v[160:163], v[40:43], a[212:215], v[160:163]
  ds_read_b128 v[32:35], v4 offset:31744
  v_mul_f32 v22, v22, v134
  v_mfma_f32_16x16x32_bf16 v[168:171], v[40:43], a[216:219], v[168:171]
  v_mul_f32 v23, v23, v135
  v_mul_f32 v24, v24, v140
  v_mfma_f32_16x16x32_bf16 v[176:179], v[40:43], a[220:223], v[176:179]
  v_mul_f32 v25, v25, v141
  s_waitcnt lgkmcnt(2)
  v_mfma_f32_16x16x32_bf16 v[148:151], v[44:47], a[224:227], v[148:151]
  v_mul_f32 v26, v26, v142
  v_mul_f32 v27, v27, v143
  v_mfma_f32_16x16x32_bf16 v[156:159], v[44:47], a[228:231], v[156:159]
  ds_read_b128 v[36:39], v4 offset:32768
  s_mov_b32 s44, 46080
  v_mfma_f32_16x16x32_bf16 v[164:167], v[44:47], a[232:235], v[164:167]
  buffer_load_dwordx4 v[232:235], v252, s[52:55], s44 offen nt
  v_mfma_f32_16x16x32_bf16 v[172:175], v[44:47], a[236:239], v[172:175]
  v_exp_f32_e64 v20, -v20
  v_mfma_f32_16x16x32_bf16 v[152:155], v[48:51], a[224:227], v[152:155]
  v_mul_f32 v136, v132, v136
  v_mfma_f32_16x16x32_bf16 v[160:163], v[48:51], a[228:231], v[160:163]
  ds_read_b128 v[40:43], v4 offset:33792
  v_mfma_f32_16x16x32_bf16 v[168:171], v[48:51], a[232:235], v[168:171]
  v_exp_f32_e64 v21, -v21
  v_mfma_f32_16x16x32_bf16 v[176:179], v[48:51], a[236:239], v[176:179]
  v_mul_f32 v137, v133, v137
  s_waitcnt lgkmcnt(2)
  v_mfma_f32_16x16x32_bf16 v[148:151], v[28:31], a[240:243], v[148:151]
  v_exp_f32_e64 v22, -v22
  v_mfma_f32_16x16x32_bf16 v[156:159], v[28:31], a[244:247], v[156:159]
  ds_read_b128 v[44:47], v4 offset:34816
  s_mov_b32 s44, 55296
  v_mfma_f32_16x16x32_bf16 v[164:167], v[28:31], a[248:251], v[164:167]
  buffer_load_dwordx4 v[236:239], v252, s[52:55], s44 offen nt
  v_mul_f32 v138, v134, v138
  v_mfma_f32_16x16x32_bf16 v[172:175], v[28:31], a[252:255], v[172:175]
  v_exp_f32_e64 v23, -v23
  v_mfma_f32_16x16x32_bf16 v[152:155], v[32:35], a[240:243], v[152:155]
  v_mul_f32 v139, v135, v139
  v_mfma_f32_16x16x32_bf16 v[160:163], v[32:35], a[244:247], v[160:163]
  ds_read_b128 v[48:51], v4 offset:35840
  v_mfma_f32_16x16x32_bf16 v[168:171], v[32:35], a[248:251], v[168:171]
  v_exp_f32_e64 v24, -v24
  v_mfma_f32_16x16x32_bf16 v[176:179], v[32:35], a[252:255], v[176:179]
  v_mul_f32 v144, v140, v144
  s_waitcnt lgkmcnt(2)
  s_waitcnt vmcnt(19)
  s_barrier
  v_mfma_f32_16x16x32_bf16 v[148:151], v[36:39], v[52:55], v[148:151]
  v_exp_f32_e64 v25, -v25
  v_mfma_f32_16x16x32_bf16 v[156:159], v[36:39], v[56:59], v[156:159]
  ds_read_b128 v[28:31], v5 offset:0
  s_mov_b32 s44, 64512
  v_mfma_f32_16x16x32_bf16 v[164:167], v[36:39], v[60:63], v[164:167]
  buffer_load_dwordx4 v[240:243], v252, s[52:55], s44 offen nt
  v_mul_f32 v145, v141, v145
  v_mfma_f32_16x16x32_bf16 v[172:175], v[36:39], v[64:67], v[172:175]
  v_exp_f32_e64 v26, -v26
  v_mfma_f32_16x16x32_bf16 v[152:155], v[40:43], v[52:55], v[152:155]
  v_mul_f32 v146, v142, v146
  v_mfma_f32_16x16x32_bf16 v[160:163], v[40:43], v[56:59], v[160:163]
  ds_read_b128 v[32:35], v5 offset:1024
  v_mfma_f32_16x16x32_bf16 v[168:171], v[40:43], v[60:63], v[168:171]
  v_exp_f32_e64 v27, -v27
  v_mfma_f32_16x16x32_bf16 v[176:179], v[40:43], v[64:67], v[176:179]
  v_mul_f32 v147, v143, v147
  s_waitcnt lgkmcnt(2)
  v_mfma_f32_16x16x32_bf16 v[148:151], v[44:47], v[68:71], v[148:151]
  v_add_f32 v20, 1.0, v20
  v_add_f32 v21, 1.0, v21
  v_mfma_f32_16x16x32_bf16 v[156:159], v[44:47], v[72:75], v[156:159]
  ds_read_b128 v[36:39], v5 offset:2048
  v_add_f32 v22, 1.0, v22
  v_mfma_f32_16x16x32_bf16 v[164:167], v[44:47], v[76:79], v[164:167]
  v_add_f32 v23, 1.0, v23
  v_add_f32 v24, 1.0, v24
  v_mfma_f32_16x16x32_bf16 v[172:175], v[44:47], v[80:83], v[172:175]
  v_add_f32 v25, 1.0, v25
  v_add_f32 v26, 1.0, v26
  v_mfma_f32_16x16x32_bf16 v[152:155], v[48:51], v[68:71], v[152:155]
  v_add_f32 v27, 1.0, v27
  v_mfma_f32_16x16x32_bf16 v[160:163], v[48:51], v[72:75], v[160:163]
  ds_read_b128 v[40:43], v5 offset:3072
  v_mfma_f32_16x16x32_bf16 v[168:171], v[48:51], v[76:79], v[168:171]
  v_rcp_f32 v20, v20
  v_mfma_f32_16x16x32_bf16 v[176:179], v[48:51], v[80:83], v[176:179]
  s_waitcnt lgkmcnt(2)
  v_mfma_f32_16x16x32_bf16 v[180:183], v[28:31], a[0:3], 0
  v_rcp_f32 v21, v21
  v_mfma_f32_16x16x32_bf16 v[188:191], v[28:31], a[4:7], 0
  ds_read_b128 v[44:47], v5 offset:4096
  v_mfma_f32_16x16x32_bf16 v[196:199], v[28:31], a[8:11], 0
  v_rcp_f32 v22, v22
  v_mfma_f32_16x16x32_bf16 v[204:207], v[28:31], a[12:15], 0
  v_rcp_f32 v23, v23
  v_mfma_f32_16x16x32_bf16 v[184:187], v[32:35], a[0:3], 0
  v_rcp_f32 v24, v24
  v_mfma_f32_16x16x32_bf16 v[192:195], v[32:35], a[4:7], 0
  ds_read_b128 v[48:51], v5 offset:5120
  v_mfma_f32_16x16x32_bf16 v[200:203], v[32:35], a[8:11], 0
  v_rcp_f32 v25, v25
  v_mfma_f32_16x16x32_bf16 v[208:211], v[32:35], a[12:15], 0
  s_waitcnt lgkmcnt(2)
  v_mfma_f32_16x16x32_bf16 v[180:183], v[36:39], a[16:19], v[180:183]
  v_rcp_f32 v26, v26
  v_mfma_f32_16x16x32_bf16 v[188:191], v[36:39], a[20:23], v[188:191]
  ds_read_b128 v[28:31], v5 offset:6144
  v_mfma_f32_16x16x32_bf16 v[196:199], v[36:39], a[24:27], v[196:199]
  v_rcp_f32 v27, v27
  v_mfma_f32_16x16x32_bf16 v[204:207], v[36:39], a[28:31], v[204:207]
  v_mul_f32 v136, v136, v20
  v_mul_f32 v137, v137, v21
  v_mfma_f32_16x16x32_bf16 v[184:187], v[40:43], a[16:19], v[184:187]
  v_mul_f32 v138, v138, v22
  v_mul_f32 v139, v139, v23
  v_mfma_f32_16x16x32_bf16 v[192:195], v[40:43], a[20:23], v[192:195]
  ds_read_b128 v[32:35], v5 offset:7168
  v_mul_f32 v144, v144, v24
  v_mfma_f32_16x16x32_bf16 v[200:203], v[40:43], a[24:27], v[200:203]
  v_mul_f32 v145, v145, v25
  v_mul_f32 v146, v146, v26
  v_mfma_f32_16x16x32_bf16 v[208:211], v[40:43], a[28:31], v[208:211]
  v_mul_f32 v147, v147, v27
  s_waitcnt lgkmcnt(2)
  v_mfma_f32_16x16x32_bf16 v[180:183], v[44:47], a[32:35], v[180:183]
  v_cvt_pk_bf16_f32 v16, v136, v137
  v_cvt_pk_bf16_f32 v17, v138, v139
  v_mfma_f32_16x16x32_bf16 v[188:191], v[44:47], a[36:39], v[188:191]
  ds_read_b128 v[36:39], v5 offset:8192
  v_cvt_pk_bf16_f32 v18, v144, v145
  v_mfma_f32_16x16x32_bf16 v[196:199], v[44:47], a[40:43], v[196:199]
  v_cvt_pk_bf16_f32 v19, v146, v147
  s_add_u32 s29, s26, 297472
  v_mfma_f32_16x16x32_bf16 v[204:207], v[44:47], a[44:47], v[204:207]
  s_nop 0
  v_permlane16_swap_b32 v16, v18
  v_mfma_f32_16x16x32_bf16 v[184:187], v[48:51], a[32:35], v[184:187]
  v_permlane16_swap_b32 v17, v19
  buffer_store_dwordx4 v[16:19], v6, s[16:19], s29 offen sc1
  v_mfma_f32_16x16x32_bf16 v[192:195], v[48:51], a[36:39], v[192:195]
  ds_read_b128 v[40:43], v5 offset:9216
  v_fma_f32 v20, v148, v148, s43
  v_mfma_f32_16x16x32_bf16 v[200:203], v[48:51], a[40:43], v[200:203]
  v_fma_f32 v21, v149, v149, s43
  v_fma_f32 v22, v150, v150, s43
  v_mfma_f32_16x16x32_bf16 v[208:211], v[48:51], a[44:47], v[208:211]
  v_fma_f32 v23, v151, v151, s43
  s_waitcnt lgkmcnt(2)
  v_mfma_f32_16x16x32_bf16 v[180:183], v[28:31], a[48:51], v[180:183]
  v_fma_f32 v24, v156, v156, s43
  v_fma_f32 v25, v157, v157, s43
  v_mfma_f32_16x16x32_bf16 v[188:191], v[28:31], a[52:55], v[188:191]
  ds_read_b128 v[44:47], v5 offset:10240
  v_fma_f32 v26, v158, v158, s43
  v_mfma_f32_16x16x32_bf16 v[196:199], v[28:31], a[56:59], v[196:199]
  v_fma_f32 v27, v159, v159, s43
  v_mul_f32 v20, v20, v148
  v_mfma_f32_16x16x32_bf16 v[204:207], v[28:31], a[60:63], v[204:207]
  v_mul_f32 v21, v21, v149
  v_mul_f32 v22, v22, v150
  v_mfma_f32_16x16x32_bf16 v[184:187], v[32:35], a[48:51], v[184:187]
  v_mul_f32 v23, v23, v151
  v_mul_f32 v24, v24, v156
  v_mfma_f32_16x16x32_bf16 v[192:195], v[32:35], a[52:55], v[192:195]
  ds_read_b128 v[48:51], v5 offset:11264
  v_mul_f32 v25, v25, v157
  v_mfma_f32_16x16x32_bf16 v[200:203], v[32:35], a[56:59], v[200:203]
  v_mul_f32 v26, v26, v158
  v_mul_f32 v27, v27, v159
  v_mfma_f32_16x16x32_bf16 v[208:211], v[32:35], a[60:63], v[208:211]
  s_waitcnt lgkmcnt(2)
  v_mfma_f32_16x16x32_bf16 v[180:183], v[36:39], a[64:67], v[180:183]
  v_exp_f32_e64 v20, -v20
  v_mfma_f32_16x16x32_bf16 v[188:191], v[36:39], a[68:71], v[188:191]
  ds_read_b128 v[28:31], v5 offset:12288
  v_mul_f32 v152, v148, v152
  v_mfma_f32_16x16x32_bf16 v[196:199], v[36:39], a[72:75], v[196:199]
  v_exp_f32_e64 v21, -v21
  v_mfma_f32_16x16x32_bf16 v[204:207], v[36:39], a[76:79], v[204:207]
  v_mul_f32 v153, v149, v153
  v_mfma_f32_16x16x32_bf16 v[184:187], v[40:43], a[64:67], v[184:187]
  v_exp_f32_e64 v22, -v22
  v_mfma_f32_16x16x32_bf16 v[192:195], v[40:43], a[68:71], v[192:195]
  ds_read_b128 v[32:35], v5 offset:13312
  v_mul_f32 v154, v150, v154
  v_mfma_f32_16x16x32_bf16 v[200:203], v[40:43], a[72:75], v[200:203]
  v_exp_f32_e64 v23, -v23
  v_mfma_f32_16x16x32_bf16 v[208:211], v[40:43], a[76:79], v[208:211]
  v_mul_f32 v155, v151, v155
  s_waitcnt lgkmcnt(2)
  v_mfma_f32_16x16x32_bf16 v[180:183], v[44:47], a[80:83], v[180:183]
  v_exp_f32_e64 v24, -v24
  v_mfma_f32_16x16x32_bf16 v[188:191], v[44:47], a[84:87], v[188:191]
  ds_read_b128 v[36:39], v5 offset:14336
  v_mul_f32 v160, v156, v160
  v_mfma_f32_16x16x32_bf16 v[196:199], v[44:47], a[88:91], v[196:199]
  v_exp_f32_e64 v25, -v25
  v_mfma_f32_16x16x32_bf16 v[204:207], v[44:47], a[92:95], v[204:207]
  v_mul_f32 v161, v157, v161
  v_mfma_f32_16x16x32_bf16 v[184:187], v[48:51], a[80:83], v[184:187]
  v_exp_f32_e64 v26, -v26
  v_mfma_f32_16x16x32_bf16 v[192:195], v[48:51], a[84:87], v[192:195]
  ds_read_b128 v[40:43], v5 offset:15360
  v_mul_f32 v162, v158, v162
  v_mfma_f32_16x16x32_bf16 v[200:203], v[48:51], a[88:91], v[200:203]
  v_exp_f32_e64 v27, -v27
  v_mfma_f32_16x16x32_bf16 v[208:211], v[48:51], a[92:95], v[208:211]
  v_mul_f32 v163, v159, v163
  s_waitcnt lgkmcnt(2)
  v_mfma_f32_16x16x32_bf16 v[180:183], v[28:31], a[96:99], v[180:183]
  v_add_f32 v20, 1.0, v20
  v_add_f32 v21, 1.0, v21
  v_mfma_f32_16x16x32_bf16 v[188:191], v[28:31], a[100:103], v[188:191]
  ds_read_b128 v[44:47], v5 offset:16384
  v_add_f32 v22, 1.0, v22
  v_mfma_f32_16x16x32_bf16 v[196:199], v[28:31], a[104:107], v[196:199]
  v_add_f32 v23, 1.0, v23
  v_add_f32 v24, 1.0, v24
  v_mfma_f32_16x16x32_bf16 v[204:207], v[28:31], a[108:111], v[204:207]
  v_add_f32 v25, 1.0, v25
  v_add_f32 v26, 1.0, v26
  v_mfma_f32_16x16x32_bf16 v[184:187], v[32:35], a[96:99], v[184:187]
  v_add_f32 v27, 1.0, v27
  v_mfma_f32_16x16x32_bf16 v[192:195], v[32:35], a[100:103], v[192:195]
  ds_read_b128 v[48:51], v5 offset:17408
  v_mfma_f32_16x16x32_bf16 v[200:203], v[32:35], a[104:107], v[200:203]
  v_rcp_f32 v20, v20
  v_mfma_f32_16x16x32_bf16 v[208:211], v[32:35], a[108:111], v[208:211]
  s_waitcnt lgkmcnt(2)
  v_mfma_f32_16x16x32_bf16 v[180:183], v[36:39], a[112:115], v[180:183]
  v_rcp_f32 v21, v21
  v_mfma_f32_16x16x32_bf16 v[188:191], v[36:39], a[116:119], v[188:191]
  ds_read_b128 v[28:31], v5 offset:18432
  v_mfma_f32_16x16x32_bf16 v[196:199], v[36:39], a[120:123], v[196:199]
  v_rcp_f32 v22, v22
  v_mfma_f32_16x16x32_bf16 v[204:207], v[36:39], a[124:127], v[204:207]
  v_rcp_f32 v23, v23
  v_mfma_f32_16x16x32_bf16 v[184:187], v[40:43], a[112:115], v[184:187]
  v_rcp_f32 v24, v24
  v_mfma_f32_16x16x32_bf16 v[192:195], v[40:43], a[116:119], v[192:195]
  ds_read_b128 v[32:35], v5 offset:19456
  v_mfma_f32_16x16x32_bf16 v[200:203], v[40:43], a[120:123], v[200:203]
  v_rcp_f32 v25, v25
  v_mfma_f32_16x16x32_bf16 v[208:211], v[40:43], a[124:127], v[208:211]
  s_waitcnt lgkmcnt(2)
  v_mfma_f32_16x16x32_bf16 v[180:183], v[44:47], a[128:131], v[180:183]
  v_rcp_f32 v26, v26
  v_mfma_f32_16x16x32_bf16 v[188:191], v[44:47], a[132:135], v[188:191]
  ds_read_b128 v[36:39], v5 offset:20480
  v_mfma_f32_16x16x32_bf16 v[196:199], v[44:47], a[136:139], v[196:199]
  v_rcp_f32 v27, v27
  v_mfma_f32_16x16x32_bf16 v[204:207], v[44:47], a[140:143], v[204:207]
  v_mul_f32 v152, v152, v20
  v_mul_f32 v153, v153, v21
  v_mfma_f32_16x16x32_bf16 v[184:187], v[48:51], a[128:131], v[184:187]
  v_mul_f32 v154, v154, v22
  v_mul_f32 v155, v155, v23
  v_mfma_f32_16x16x32_bf16 v[192:195], v[48:51], a[132:135], v[192:195]
  ds_read_b128 v[40:43], v5 offset:21504
  v_mul_f32 v160, v160, v24
  v_mfma_f32_16x16x32_bf16 v[200:203], v[48:51], a[136:139], v[200:203]
  v_mul_f32 v161, v161, v25
  v_mul_f32 v162, v162, v26
  v_mfma_f32_16x16x32_bf16 v[208:211], v[48:51], a[140:143], v[208:211]
  v_mul_f32 v163, v163, v27
  s_waitcnt lgkmcnt(2)
  v_mfma_f32_16x16x32_bf16 v[180:183], v[28:31], a[144:147], v[180:183]
  v_cvt_pk_bf16_f32 v12, v152, v153
  v_cvt_pk_bf16_f32 v13, v154, v155
  v_mfma_f32_16x16x32_bf16 v[188:191], v[28:31], a[148:151], v[188:191]
  ds_read_b128 v[44:47], v5 offset:22528
  v_cvt_pk_bf16_f32 v14, v160, v161
  v_mfma_f32_16x16x32_bf16 v[196:199], v[28:31], a[152:155], v[196:199]
  v_cvt_pk_bf16_f32 v15, v162, v163
  s_add_u32 s29, s26, 3072
  v_mfma_f32_16x16x32_bf16 v[204:207], v[28:31], a[156:159], v[204:207]
  s_nop 0
  v_permlane16_swap_b32 v12, v14
  v_mfma_f32_16x16x32_bf16 v[184:187], v[32:35], a[144:147], v[184:187]
  v_permlane16_swap_b32 v13, v15
  buffer_store_dwordx4 v[12:15], v6, s[16:19], s29 offen sc1
  v_mfma_f32_16x16x32_bf16 v[192:195], v[32:35], a[148:151], v[192:195]
  ds_read_b128 v[48:51], v5 offset:23552
  v_fma_f32 v20, v164, v164, s43
  v_mfma_f32_16x16x32_bf16 v[200:203], v[32:35], a[152:155], v[200:203]
  v_fma_f32 v21, v165, v165, s43
  v_fma_f32 v22, v166, v166, s43
  v_mfma_f32_16x16x32_bf16 v[208:211], v[32:35], a[156:159], v[208:211]
  v_fma_f32 v23, v167, v167, s43
  s_waitcnt lgkmcnt(2)
  v_mfma_f32_16x16x32_bf16 v[180:183], v[36:39], a[160:163], v[180:183]
  v_fma_f32 v24, v172, v172, s43
  v_fma_f32 v25, v173, v173, s43
  v_mfma_f32_16x16x32_bf16 v[188:191], v[36:39], a[164:167], v[188:191]
  ds_read_b128 v[28:31], v5 offset:24576
  v_fma_f32 v26, v174, v174, s43
  v_mfma_f32_16x16x32_bf16 v[196:199], v[36:39], a[168:171], v[196:199]
  v_fma_f32 v27, v175, v175, s43
  v_mul_f32 v20, v20, v164
  v_mfma_f32_16x16x32_bf16 v[204:207], v[36:39], a[172:175], v[204:207]
  v_mul_f32 v21, v21, v165
  v_mul_f32 v22, v22, v166
  v_mfma_f32_16x16x32_bf16 v[184:187], v[40:43], a[160:163], v[184:187]
  v_mul_f32 v23, v23, v167
  v_mul_f32 v24, v24, v172
  v_mfma_f32_16x16x32_bf16 v[192:195], v[40:43], a[164:167], v[192:195]
  ds_read_b128 v[32:35], v5 offset:25600
  v_mul_f32 v25, v25, v173
  v_mfma_f32_16x16x32_bf16 v[200:203], v[40:43], a[168:171], v[200:203]
  v_mul_f32 v26, v26, v174
  v_mul_f32 v27, v27, v175
  v_mfma_f32_16x16x32_bf16 v[208:211], v[40:43], a[172:175], v[208:211]
  s_waitcnt lgkmcnt(2)
  v_mfma_f32_16x16x32_bf16 v[180:183], v[44:47], a[176:179], v[180:183]
  v_exp_f32_e64 v20, -v20
  v_mfma_f32_16x16x32_bf16 v[188:191], v[44:47], a[180:183], v[188:191]
  ds_read_b128 v[36:39], v5 offset:26624
  v_mul_f32 v168, v164, v168
  v_mfma_f32_16x16x32_bf16 v[196:199], v[44:47], a[184:187], v[196:199]
  v_exp_f32_e64 v21, -v21
  v_mfma_f32_16x16x32_bf16 v[204:207], v[44:47], a[188:191], v[204:207]
  v_mul_f32 v169, v165, v169
  v_mfma_f32_16x16x32_bf16 v[184:187], v[48:51], a[176:179], v[184:187]
  v_exp_f32_e64 v22, -v22
  v_mfma_f32_16x16x32_bf16 v[192:195], v[48:51], a[180:183], v[192:195]
  ds_read_b128 v[40:43], v5 offset:27648
  v_mul_f32 v170, v166, v170
  v_mfma_f32_16x16x32_bf16 v[200:203], v[48:51], a[184:187], v[200:203]
  v_exp_f32_e64 v23, -v23
  v_mfma_f32_16x16x32_bf16 v[208:211], v[48:51], a[188:191], v[208:211]
  v_mul_f32 v171, v167, v171
  s_waitcnt lgkmcnt(2)
  v_mfma_f32_16x16x32_bf16 v[180:183], v[28:31], a[192:195], v[180:183]
  v_exp_f32_e64 v24, -v24
  v_mfma_f32_16x16x32_bf16 v[188:191], v[28:31], a[196:199], v[188:191]
  ds_read_b128 v[44:47], v5 offset:28672
  v_mul_f32 v176, v172, v176
  v_mfma_f32_16x16x32_bf16 v[196:199], v[28:31], a[200:203], v[196:199]
  v_exp_f32_e64 v25, -v25
  v_mfma_f32_16x16x32_bf16 v[204:207], v[28:31], a[204:207], v[204:207]
  v_mul_f32 v177, v173, v177
  v_mfma_f32_16x16x32_bf16 v[184:187], v[32:35], a[192:195], v[184:187]
  v_exp_f32_e64 v26, -v26
  v_mfma_f32_16x16x32_bf16 v[192:195], v[32:35], a[196:199], v[192:195]
  ds_read_b128 v[48:51], v5 offset:29696
  v_mul_f32 v178, v174, v178
  v_mfma_f32_16x16x32_bf16 v[200:203], v[32:35], a[200:203], v[200:203]
  v_exp_f32_e64 v27, -v27
  v_mfma_f32_16x16x32_bf16 v[208:211], v[32:35], a[204:207], v[208:211]
  v_mul_f32 v179, v175, v179
  s_waitcnt lgkmcnt(2)
  v_mfma_f32_16x16x32_bf16 v[180:183], v[36:39], a[208:211], v[180:183]
  v_add_f32 v20, 1.0, v20
  v_add_f32 v21, 1.0, v21
  v_mfma_f32_16x16x32_bf16 v[188:191], v[36:39], a[212:215], v[188:191]
  ds_read_b128 v[28:31], v5 offset:30720
  v_add_f32 v22, 1.0, v22
  v_mfma_f32_16x16x32_bf16 v[196:199], v[36:39], a[216:219], v[196:199]
  v_add_f32 v23, 1.0, v23
  v_add_f32 v24, 1.0, v24
  v_mfma_f32_16x16x32_bf16 v[204:207], v[36:39], a[220:223], v[204:207]
  v_add_f32 v25, 1.0, v25
  v_add_f32 v26, 1.0, v26
  v_mfma_f32_16x16x32_bf16 v[184:187], v[40:43], a[208:211], v[184:187]
  v_add_f32 v27, 1.0, v27
  v_mfma_f32_16x16x32_bf16 v[192:195], v[40:43], a[212:215], v[192:195]
  ds_read_b128 v[32:35], v5 offset:31744
  v_mfma_f32_16x16x32_bf16 v[200:203], v[40:43], a[216:219], v[200:203]
  v_rcp_f32 v20, v20
  v_mfma_f32_16x16x32_bf16 v[208:211], v[40:43], a[220:223], v[208:211]
  s_waitcnt lgkmcnt(2)
  v_mfma_f32_16x16x32_bf16 v[180:183], v[44:47], a[224:227], v[180:183]
  v_rcp_f32 v21, v21
  v_mfma_f32_16x16x32_bf16 v[188:191], v[44:47], a[228:231], v[188:191]
  ds_read_b128 v[36:39], v5 offset:32768
  v_mfma_f32_16x16x32_bf16 v[196:199], v[44:47], a[232:235], v[196:199]
  v_rcp_f32 v22, v22
  v_mfma_f32_16x16x32_bf16 v[204:207], v[44:47], a[236:239], v[204:207]
  v_rcp_f32 v23, v23
  v_mfma_f32_16x16x32_bf16 v[184:187], v[48:51], a[224:227], v[184:187]
  v_rcp_f32 v24, v24
  v_mfma_f32_16x16x32_bf16 v[192:195], v[48:51], a[228:231], v[192:195]
  ds_read_b128 v[40:43], v5 offset:33792
  v_mfma_f32_16x16x32_bf16 v[200:203], v[48:51], a[232:235], v[200:203]
  v_rcp_f32 v25, v25
  v_mfma_f32_16x16x32_bf16 v[208:211], v[48:51], a[236:239], v[208:211]
  s_waitcnt lgkmcnt(2)
  v_mfma_f32_16x16x32_bf16 v[180:183], v[28:31], a[240:243], v[180:183]
  v_rcp_f32 v26, v26
  v_mfma_f32_16x16x32_bf16 v[188:191], v[28:31], a[244:247], v[188:191]
  ds_read_b128 v[44:47], v5 offset:34816
  v_mfma_f32_16x16x32_bf16 v[196:199], v[28:31], a[248:251], v[196:199]
  v_rcp_f32 v27, v27
  v_mfma_f32_16x16x32_bf16 v[204:207], v[28:31], a[252:255], v[204:207]
  v_mul_f32 v168, v168, v20
  v_mul_f32 v169, v169, v21
  v_mfma_f32_16x16x32_bf16 v[184:187], v[32:35], a[240:243], v[184:187]
  v_mul_f32 v170, v170, v22
  v_mul_f32 v171, v171, v23
  v_mfma_f32_16x16x32_bf16 v[192:195], v[32:35], a[244:247], v[192:195]
  ds_read_b128 v[48:51], v5 offset:35840
  v_mul_f32 v176, v176, v24
  v_mfma_f32_16x16x32_bf16 v[200:203], v[32:35], a[248:251], v[200:203]
  v_mul_f32 v177, v177, v25
  v_mul_f32 v178, v178, v26
  v_mfma_f32_16x16x32_bf16 v[208:211], v[32:35], a[252:255], v[208:211]
  v_mul_f32 v179, v179, v27
  s_waitcnt lgkmcnt(2)
  s_waitcnt vmcnt(11)
  s_barrier
  v_mfma_f32_16x16x32_bf16 v[180:183], v[36:39], v[52:55], v[180:183]
  v_cvt_pk_bf16_f32 v16, v168, v169
  v_cvt_pk_bf16_f32 v17, v170, v171
  v_mfma_f32_16x16x32_bf16 v[188:191], v[36:39], v[56:59], v[188:191]
  ds_read_b128 v[28:31], v2 offset:0
  v_cvt_pk_bf16_f32 v18, v176, v177
  v_mfma_f32_16x16x32_bf16 v[196:199], v[36:39], v[60:63], v[196:199]
  v_cvt_pk_bf16_f32 v19, v178, v179
  s_add_u32 s29, s26, 297984
  v_mfma_f32_16x16x32_bf16 v[204:207], v[36:39], v[64:67], v[204:207]
  s_nop 0
  v_permlane16_swap_b32 v16, v18
  v_mfma_f32_16x16x32_bf16 v[184:187], v[40:43], v[52:55], v[184:187]
  v_permlane16_swap_b32 v17, v19
  buffer_store_dwordx4 v[16:19], v6, s[16:19], s29 offen sc1
  v_mfma_f32_16x16x32_bf16 v[192:195], v[40:43], v[56:59], v[192:195]
  ds_read_b128 v[32:35], v2 offset:1024
  v_mfma_f32_16x16x32_bf16 v[200:203], v[40:43], v[60:63], v[200:203]
  v_mfma_f32_16x16x32_bf16 v[208:211], v[40:43], v[64:67], v[208:211]
  s_waitcnt lgkmcnt(2)
  v_mfma_f32_16x16x32_bf16 v[180:183], v[44:47], v[68:71], v[180:183]
  v_mfma_f32_16x16x32_bf16 v[188:191], v[44:47], v[72:75], v[188:191]
  ds_read_b128 v[36:39], v2 offset:2048
  v_mfma_f32_16x16x32_bf16 v[196:199], v[44:47], v[76:79], v[196:199]
  v_mfma_f32_16x16x32_bf16 v[204:207], v[44:47], v[80:83], v[204:207]
  v_mfma_f32_16x16x32_bf16 v[184:187], v[48:51], v[68:71], v[184:187]
  v_mfma_f32_16x16x32_bf16 v[192:195], v[48:51], v[72:75], v[192:195]
  ds_read_b128 v[40:43], v2 offset:3072
  v_mfma_f32_16x16x32_bf16 v[200:203], v[48:51], v[76:79], v[200:203]
  v_mfma_f32_16x16x32_bf16 v[208:211], v[48:51], v[80:83], v[208:211]
  s_waitcnt lgkmcnt(2)
  v_mfma_f32_16x16x32_bf16 v[84:87], v[28:31], a[0:3], 0
  v_mfma_f32_16x16x32_bf16 v[92:95], v[28:31], a[4:7], 0
  ds_read_b128 v[44:47], v2 offset:4096
  v_mfma_f32_16x16x32_bf16 v[100:103], v[28:31], a[8:11], 0
  v_mfma_f32_16x16x32_bf16 v[108:111], v[28:31], a[12:15], 0
  v_mfma_f32_16x16x32_bf16 v[88:91], v[32:35], a[0:3], 0
  v_mfma_f32_16x16x32_bf16 v[96:99], v[32:35], a[4:7], 0
  ds_read_b128 v[48:51], v2 offset:5120
  v_mfma_f32_16x16x32_bf16 v[104:107], v[32:35], a[8:11], 0
  v_mfma_f32_16x16x32_bf16 v[112:115], v[32:35], a[12:15], 0
  v_fma_f32 v20, v180, v180, s43
  s_waitcnt lgkmcnt(2)
  v_mfma_f32_16x16x32_bf16 v[84:87], v[36:39], a[16:19], v[84:87]
  v_fma_f32 v21, v181, v181, s43
  v_fma_f32 v22, v182, v182, s43
  v_mfma_f32_16x16x32_bf16 v[92:95], v[36:39], a[20:23], v[92:95]
  ds_read_b128 v[28:31], v2 offset:6144
  v_fma_f32 v23, v183, v183, s43
  v_mfma_f32_16x16x32_bf16 v[100:103], v[36:39], a[24:27], v[100:103]
  v_fma_f32 v24, v188, v188, s43
  v_fma_f32 v25, v189, v189, s43
  v_mfma_f32_16x16x32_bf16 v[108:111], v[36:39], a[28:31], v[108:111]
  v_fma_f32 v26, v190, v190, s43
  v_fma_f32 v27, v191, v191, s43
  v_mfma_f32_16x16x32_bf16 v[88:91], v[40:43], a[16:19], v[88:91]
  v_mul_f32 v20, v20, v180
  v_mul_f32 v21, v21, v181
  v_mfma_f32_16x16x32_bf16 v[96:99], v[40:43], a[20:23], v[96:99]
  ds_read_b128 v[32:35], v2 offset:7168
  v_mul_f32 v22, v22, v182
  v_mfma_f32_16x16x32_bf16 v[104:107], v[40:43], a[24:27], v[104:107]
  v_mul_f32 v23, v23, v183
  v_mul_f32 v24, v24, v188
  v_mfma_f32_16x16x32_bf16 v[112:115], v[40:43], a[28:31], v[112:115]
  v_mul_f32 v25, v25, v189
  s_waitcnt lgkmcnt(2)
  v_mfma_f32_16x16x32_bf16 v[84:87], v[44:47], a[32:35], v[84:87]
  v_mul_f32 v26, v26, v190
  v_mul_f32 v27, v27, v191
  v_mfma_f32_16x16x32_bf16 v[92:95], v[44:47], a[36:39], v[92:95]
  ds_read_b128 v[36:39], v2 offset:8192
  v_mfma_f32_16x16x32_bf16 v[100:103], v[44:47], a[40:43], v[100:103]
  v_exp_f32_e64 v20, -v20
  v_mfma_f32_16x16x32_bf16 v[108:111], v[44:47], a[44:47], v[108:111]
  v_mul_f32 v184, v180, v184
  v_mfma_f32_16x16x32_bf16 v[88:91], v[48:51], a[32:35], v[88:91]
  v_exp_f32_e64 v21, -v21
  v_mfma_f32_16x16x32_bf16 v[96:99], v[48:51], a[36:39], v[96:99]
  ds_read_b128 v[40:43], v2 offset:9216
  v_mul_f32 v185, v181, v185
  v_mfma_f32_16x16x32_bf16 v[104:107], v[48:51], a[40:43], v[104:107]
  v_exp_f32_e64 v22, -v22
  v_mfma_f32_16x16x32_bf16 v[112:115], v[48:51], a[44:47], v[112:115]
  v_mul_f32 v186, v182, v186
  s_waitcnt lgkmcnt(2)
  v_mfma_f32_16x16x32_bf16 v[84:87], v[28:31], a[48:51], v[84:87]
  v_exp_f32_e64 v23, -v23
  v_mfma_f32_16x16x32_bf16 v[92:95], v[28:31], a[52:55], v[92:95]
  ds_read_b128 v[44:47], v2 offset:10240
  v_mul_f32 v187, v183, v187
  v_mfma_f32_16x16x32_bf16 v[100:103], v[28:31], a[56:59], v[100:103]
  v_exp_f32_e64 v24, -v24
  v_mfma_f32_16x16x32_bf16 v[108:111], v[28:31], a[60:63], v[108:111]
  v_mul_f32 v192, v188, v192
  v_mfma_f32_16x16x32_bf16 v[88:91], v[32:35], a[48:51], v[88:91]
  v_exp_f32_e64 v25, -v25
  v_mfma_f32_16x16x32_bf16 v[96:99], v[32:35], a[52:55], v[96:99]
  ds_read_b128 v[48:51], v2 offset:11264
  v_mul_f32 v193, v189, v193
  v_mfma_f32_16x16x32_bf16 v[104:107], v[32:35], a[56:59], v[104:107]
  v_exp_f32_e64 v26, -v26
  v_mfma_f32_16x16x32_bf16 v[112:115], v[32:35], a[60:63], v[112:115]
  v_mul_f32 v194, v190, v194
  s_waitcnt lgkmcnt(2)
  v_mfma_f32_16x16x32_bf16 v[84:87], v[36:39], a[64:67], v[84:87]
  v_exp_f32_e64 v27, -v27
  v_mfma_f32_16x16x32_bf16 v[92:95], v[36:39], a[68:71], v[92:95]
  ds_read_b128 v[28:31], v2 offset:12288
  v_mul_f32 v195, v191, v195
  v_mfma_f32_16x16x32_bf16 v[100:103], v[36:39], a[72:75], v[100:103]
  v_add_f32 v20, 1.0, v20
  v_add_f32 v21, 1.0, v21
  v_mfma_f32_16x16x32_bf16 v[108:111], v[36:39], a[76:79], v[108:111]
  v_add_f32 v22, 1.0, v22
  v_add_f32 v23, 1.0, v23
  v_mfma_f32_16x16x32_bf16 v[88:91], v[40:43], a[64:67], v[88:91]
  v_add_f32 v24, 1.0, v24
  v_add_f32 v25, 1.0, v25
  v_mfma_f32_16x16x32_bf16 v[96:99], v[40:43], a[68:71], v[96:99]
  ds_read_b128 v[32:35], v2 offset:13312
  v_add_f32 v26, 1.0, v26
  v_mfma_f32_16x16x32_bf16 v[104:107], v[40:43], a[72:75], v[104:107]
  v_add_f32 v27, 1.0, v27
  v_mfma_f32_16x16x32_bf16 v[112:115], v[40:43], a[76:79], v[112:115]
  s_waitcnt lgkmcnt(2)
  v_mfma_f32_16x16x32_bf16 v[84:87], v[44:47], a[80:83], v[84:87]
  v_rcp_f32 v20, v20
  v_mfma_f32_16x16x32_bf16 v[92:95], v[44:47], a[84:87], v[92:95]
  ds_read_b128 v[36:39], v2 offset:14336
  v_mfma_f32_16x16x32_bf16 v[100:103], v[44:47], a[88:91], v[100:103]
  v_rcp_f32 v21, v21
  v_mfma_f32_16x16x32_bf16 v[108:111], v[44:47], a[92:95], v[108:111]
  v_rcp_f32 v22, v22
  v_mfma_f32_16x16x32_bf16 v[88:91], v[48:51], a[80:83], v[88:91]
  v_rcp_f32 v23, v23
  v_mfma_f32_16x16x32_bf16 v[96:99], v[48:51], a[84:87], v[96:99]
  ds_read_b128 v[40:43], v2 offset:15360
  v_mfma_f32_16x16x32_bf16 v[104:107], v[48:51], a[88:91], v[104:107]
  v_rcp_f32 v24, v24
  v_mfma_f32_16x16x32_bf16 v[112:115], v[48:51], a[92:95], v[112:115]
  s_waitcnt lgkmcnt(2)
  v_mfma_f32_16x16x32_bf16 v[84:87], v[28:31], a[96:99], v[84:87]
  v_rcp_f32 v25, v25
  v_mfma_f32_16x16x32_bf16 v[92:95], v[28:31], a[100:103], v[92:95]
  ds_read_b128 v[44:47], v2 offset:16384
  v_mfma_f32_16x16x32_bf16 v[100:103], v[28:31], a[104:107], v[100:103]
  v_rcp_f32 v26, v26
  v_mfma_f32_16x16x32_bf16 v[108:111], v[28:31], a[108:111], v[108:111]
  v_rcp_f32 v27, v27
  v_mfma_f32_16x16x32_bf16 v[88:91], v[32:35], a[96:99], v[88:91]
  v_mul_f32 v184, v184, v20
  v_mul_f32 v185, v185, v21
  v_mfma_f32_16x16x32_bf16 v[96:99], v[32:35], a[100:103], v[96:99]
  ds_read_b128 v[48:51], v2 offset:17408
  v_mul_f32 v186, v186, v22
  v_mfma_f32_16x16x32_bf16 v[104:107], v[32:35], a[104:107], v[104:107]
  v_mul_f32 v187, v187, v23
  v_mul_f32 v192, v192, v24
  v_mfma_f32_16x16x32_bf16 v[112:115], v[32:35], a[108:111], v[112:115]
  v_mul_f32 v193, v193, v25
  s_waitcnt lgkmcnt(2)
  v_mfma_f32_16x16x32_bf16 v[84:87], v[36:39], a[112:115], v[84:87]
  v_mul_f32 v194, v194, v26
  v_mul_f32 v195, v195, v27
  v_mfma_f32_16x16x32_bf16 v[92:95], v[36:39], a[116:119], v[92:95]
  ds_read_b128 v[28:31], v2 offset:18432
  v_cvt_pk_bf16_f32 v12, v184, v185
  v_mfma_f32_16x16x32_bf16 v[100:103], v[36:39], a[120:123], v[100:103]
  v_cvt_pk_bf16_f32 v13, v186, v187
  v_cvt_pk_bf16_f32 v14, v192, v193
  v_mfma_f32_16x16x32_bf16 v[108:111], v[36:39], a[124:127], v[108:111]
  v_cvt_pk_bf16_f32 v15, v194, v195
  s_add_u32 s29, s26, 3584
  v_mfma_f32_16x16x32_bf16 v[88:91], v[40:43], a[112:115], v[88:91]
  s_nop 0
  v_permlane16_swap_b32 v12, v14
  v_mfma_f32_16x16x32_bf16 v[96:99], v[40:43], a[116:119], v[96:99]
  ds_read_b128 v[32:35], v2 offset:19456
  v_permlane16_swap_b32 v13, v15
  v_mfma_f32_16x16x32_bf16 v[104:107], v[40:43], a[120:123], v[104:107]
  buffer_store_dwordx4 v[12:15], v6, s[16:19], s29 offen sc1
  v_fma_f32 v20, v196, v196, s43
  v_mfma_f32_16x16x32_bf16 v[112:115], v[40:43], a[124:127], v[112:115]
  v_fma_f32 v21, v197, v197, s43
  s_waitcnt lgkmcnt(2)
  s_waitcnt vmcnt(4)
  v_mfma_f32_16x16x32_bf16 v[84:87], v[44:47], a[128:131], v[84:87]
  v_perm_b32 v244, v216, v212, s58
  v_perm_b32 v245, v224, v220, s58
  v_mfma_f32_16x16x32_bf16 v[92:95], v[44:47], a[132:135], v[92:95]
  ds_read_b128 v[36:39], v2 offset:20480
  v_perm_b32 v246, v232, v228, s58
  v_mfma_f32_16x16x32_bf16 v[100:103], v[44:47], a[136:139], v[100:103]
  v_perm_b32 v247, v240, v236, s58
  s_mov_b32 s45, 0
  v_mfma_f32_16x16x32_bf16 v[108:111], v[44:47], a[140:143], v[108:111]
  buffer_store_dwordx4 v[244:247], v253, s[48:51], s45 offen sc1
  v_perm_b32 v248, v216, v212, s59
  v_mfma_f32_16x16x32_bf16 v[88:91], v[48:51], a[128:131], v[88:91]
  v_perm_b32 v249, v224, v220, s59
  v_perm_b32 v250, v232, v228, s59
  v_mfma_f32_16x16x32_bf16 v[96:99], v[48:51], a[132:135], v[96:99]
  ds_read_b128 v[40:43], v2 offset:21504
  v_perm_b32 v251, v240, v236, s59
  v_mfma_f32_16x16x32_bf16 v[104:107], v[48:51], a[136:139], v[104:107]
  s_mov_b32 s45, 1024
  buffer_store_dwordx4 v[248:251], v253, s[48:51], s45 offen sc1
  v_mfma_f32_16x16x32_bf16 v[112:115], v[48:51], a[140:143], v[112:115]
  v_perm_b32 v244, v217, v213, s58
  s_waitcnt lgkmcnt(2)
  v_mfma_f32_16x16x32_bf16 v[84:87], v[28:31], a[144:147], v[84:87]
  v_perm_b32 v245, v225, v221, s58
  v_perm_b32 v246, v233, v229, s58
  v_mfma_f32_16x16x32_bf16 v[92:95], v[28:31], a[148:151], v[92:95]
  ds_read_b128 v[44:47], v2 offset:22528
  v_perm_b32 v247, v241, v237, s58
  v_mfma_f32_16x16x32_bf16 v[100:103], v[28:31], a[152:155], v[100:103]
  s_mov_b32 s45, 2048
  buffer_store_dwordx4 v[244:247], v253, s[48:51], s45 offen sc1
  v_mfma_f32_16x16x32_bf16 v[108:111], v[28:31], a[156:159], v[108:111]
  v_perm_b32 v248, v217, v213, s59
  v_perm_b32 v249, v225, v221, s59
  v_mfma_f32_16x16x32_bf16 v[88:91], v[32:35], a[144:147], v[88:91]
  v_perm_b32 v250, v233, v229, s59
  v_perm_b32 v251, v241, v237, s59
  v_mfma_f32_16x16x32_bf16 v[96:99], v[32:35], a[148:151], v[96:99]
  ds_read_b128 v[48:51], v2 offset:23552
  s_mov_b32 s45, 3072
  v_mfma_f32_16x16x32_bf16 v[104:107], v[32:35], a[152:155], v[104:107]
  buffer_store_dwordx4 v[248:251], v253, s[48:51], s45 offen sc1
  v_perm_b32 v244, v218, v214, s58
  v_mfma_f32_16x16x32_bf16 v[112:115], v[32:35], a[156:159], v[112:115]
  v_perm_b32 v245, v226, v222, s58
  s_waitcnt lgkmcnt(2)
  v_mfma_f32_16x16x32_bf16 v[84:87], v[36:39], a[160:163], v[84:87]
  v_perm_b32 v246, v234, v230, s58
  v_perm_b32 v247, v242, v238, s58
  v_mfma_f32_16x16x32_bf16 v[92:95], v[36:39], a[164:167], v[92:95]
  ds_read_b128 v[28:31], v2 offset:24576
  s_mov_b32 s45, 4096
  v_mfma_f32_16x16x32_bf16 v[100:103], v[36:39], a[168:171], v[100:103]
  buffer_store_dwordx4 v[244:247], v253, s[48:51], s45 offen sc1
  v_perm_b32 v248, v218, v214, s59
  v_mfma_f32_16x16x32_bf16 v[108:111], v[36:39], a[172:175], v[108:111]
  v_perm_b32 v249, v226, v222, s59
  v_perm_b32 v250, v234, v230, s59
  v_mfma_f32_16x16x32_bf16 v[88:91], v[40:43], a[160:163], v[88:91]
  v_perm_b32 v251, v242, v238, s59
  s_mov_b32 s45, 5120
  v_mfma_f32_16x16x32_bf16 v[96:99], v[40:43], a[164:167], v[96:99]
  ds_read_b128 v[32:35], v2 offset:25600
  buffer_store_dwordx4 v[248:251], v253, s[48:51], s45 offen sc1
  v_mfma_f32_16x16x32_bf16 v[104:107], v[40:43], a[168:171], v[104:107]
  v_perm_b32 v244, v219, v215, s58
  v_perm_b32 v245, v227, v223, s58
  v_mfma_f32_16x16x32_bf16 v[112:115], v[40:43], a[172:175], v[112:115]
  v_perm_b32 v246, v235, v231, s58
  s_waitcnt lgkmcnt(2)
  v_mfma_f32_16x16x32_bf16 v[84:87], v[44:47], a[176:179], v[84:87]
  v_perm_b32 v247, v243, v239, s58
  s_mov_b32 s45, 6144
  v_mfma_f32_16x16x32_bf16 v[92:95], v[44:47], a[180:183], v[92:95]
  ds_read_b128 v[36:39], v2 offset:26624
  buffer_store_dwordx4 v[244:247], v253, s[48:51], s45 offen sc1
  v_mfma_f32_16x16x32_bf16 v[100:103], v[44:47], a[184:187], v[100:103]
  v_perm_b32 v248, v219, v215, s59
  v_perm_b32 v249, v227, v223, s59
  v_mfma_f32_16x16x32_bf16 v[108:111], v[44:47], a[188:191], v[108:111]
  v_perm_b32 v250, v235, v231, s59
  v_perm_b32 v251, v243, v239, s59
  v_mfma_f32_16x16x32_bf16 v[88:91], v[48:51], a[176:179], v[88:91]
  s_mov_b32 s45, 7168
  buffer_store_dwordx4 v[248:251], v253, s[48:51], s45 offen sc1
  v_mfma_f32_16x16x32_bf16 v[96:99], v[48:51], a[180:183], v[96:99]
  ds_read_b128 v[40:43], v2 offset:27648
  v_fma_f32 v22, v198, v198, s43
  v_mfma_f32_16x16x32_bf16 v[104:107], v[48:51], a[184:187], v[104:107]
  v_fma_f32 v23, v199, v199, s43
  v_fma_f32 v24, v204, v204, s43
  v_mfma_f32_16x16x32_bf16 v[112:115], v[48:51], a[188:191], v[112:115]
  v_fma_f32 v25, v205, v205, s43
  s_waitcnt lgkmcnt(2)
  v_mfma_f32_16x16x32_bf16 v[84:87], v[28:31], a[192:195], v[84:87]
  v_fma_f32 v26, v206, v206, s43
  v_fma_f32 v27, v207, v207, s43
  v_mfma_f32_16x16x32_bf16 v[92:95], v[28:31], a[196:199], v[92:95]
  ds_read_b128 v[44:47], v2 offset:28672
  v_mul_f32 v20, v20, v196
  v_mfma_f32_16x16x32_bf16 v[100:103], v[28:31], a[200:203], v[100:103]
  v_mul_f32 v21, v21, v197
  v_mul_f32 v22, v22, v198
  v_mfma_f32_16x16x32_bf16 v[108:111], v[28:31], a[204:207], v[108:111]
  v_mul_f32 v23, v23, v199
  v_mul_f32 v24, v24, v204
  v_mfma_f32_16x16x32_bf16 v[88:91], v[32:35], a[192:195], v[88:91]
  v_mul_f32 v25, v25, v205
  v_mul_f32 v26, v26, v206
  v_mfma_f32_16x16x32_bf16 v[96:99], v[32:35], a[196:199], v[96:99]
  ds_read_b128 v[48:51], v2 offset:29696
  v_mul_f32 v27, v27, v207
  v_mfma_f32_16x16x32_bf16 v[104:107], v[32:35], a[200:203], v[104:107]
  v_exp_f32_e64 v20, -v20
  v_mfma_f32_16x16x32_bf16 v[112:115], v[32:35], a[204:207], v[112:115]
  v_mul_f32 v200, v196, v200
  s_waitcnt lgkmcnt(2)
  v_mfma_f32_16x16x32_bf16 v[84:87], v[36:39], a[208:211], v[84:87]
  v_exp_f32_e64 v21, -v21
  v_mfma_f32_16x16x32_bf16 v[92:95], v[36:39], a[212:215], v[92:95]
  ds_read_b128 v[28:31], v2 offset:30720
  v_mul_f32 v201, v197, v201
  v_mfma_f32_16x16x32_bf16 v[100:103], v[36:39], a[216:219], v[100:103]
  v_exp_f32_e64 v22, -v22
  v_mfma_f32_16x16x32_bf16 v[108:111], v[36:39], a[220:223], v[108:111]
  v_mul_f32 v202, v198, v202
  v_mfma_f32_16x16x32_bf16 v[88:91], v[40:43], a[208:211], v[88:91]
  v_exp_f32_e64 v23, -v23
  v_mfma_f32_16x16x32_bf16 v[96:99], v[40:43], a[212:215], v[96:99]
  ds_read_b128 v[32:35], v2 offset:31744
  v_mul_f32 v203, v199, v203
  v_mfma_f32_16x16x32_bf16 v[104:107], v[40:43], a[216:219], v[104:107]
  v_exp_f32_e64 v24, -v24
  v_mfma_f32_16x16x32_bf16 v[112:115], v[40:43], a[220:223], v[112:115]
  v_mul_f32 v208, v204, v208
  s_waitcnt lgkmcnt(2)
  v_mfma_f32_16x16x32_bf16 v[84:87], v[44:47], a[224:227], v[84:87]
  v_exp_f32_e64 v25, -v25
  v_mfma_f32_16x16x32_bf16 v[92:95], v[44:47], a[228:231], v[92:95]
  ds_read_b128 v[36:39], v2 offset:32768
  v_mul_f32 v209, v205, v209
  v_mfma_f32_16x16x32_bf16 v[100:103], v[44:47], a[232:235], v[100:103]
  v_exp_f32_e64 v26, -v26
  v_mfma_f32_16x16x32_bf16 v[108:111], v[44:47], a[236:239], v[108:111]
  v_mul_f32 v210, v206, v210
  v_mfma_f32_16x16x32_bf16 v[88:91], v[48:51], a[224:227], v[88:91]
  v_exp_f32_e64 v27, -v27
  v_mfma_f32_16x16x32_bf16 v[96:99], v[48:51], a[228:231], v[96:99]
  ds_read_b128 v[40:43], v2 offset:33792
  v_mul_f32 v211, v207, v211
  v_mfma_f32_16x16x32_bf16 v[104:107], v[48:51], a[232:235], v[104:107]
  v_add_f32 v20, 1.0, v20
  v_add_f32 v21, 1.0, v21
  v_mfma_f32_16x16x32_bf16 v[112:115], v[48:51], a[236:239], v[112:115]
  v_add_f32 v22, 1.0, v22
  s_waitcnt lgkmcnt(2)
  v_mfma_f32_16x16x32_bf16 v[84:87], v[28:31], a[240:243], v[84:87]
  v_add_f32 v23, 1.0, v23
  v_add_f32 v24, 1.0, v24
  v_mfma_f32_16x16x32_bf16 v[92:95], v[28:31], a[244:247], v[92:95]
  ds_read_b128 v[44:47], v2 offset:34816
  v_add_f32 v25, 1.0, v25
  v_mfma_f32_16x16x32_bf16 v[100:103], v[28:31], a[248:251], v[100:103]
  v_add_f32 v26, 1.0, v26
  v_add_f32 v27, 1.0, v27
  v_mfma_f32_16x16x32_bf16 v[108:111], v[28:31], a[252:255], v[108:111]
  v_rcp_f32 v20, v20
  v_mfma_f32_16x16x32_bf16 v[88:91], v[32:35], a[240:243], v[88:91]
  v_rcp_f32 v21, v21
  v_mfma_f32_16x16x32_bf16 v[96:99], v[32:35], a[244:247], v[96:99]
  ds_read_b128 v[48:51], v2 offset:35840
  v_mfma_f32_16x16x32_bf16 v[104:107], v[32:35], a[248:251], v[104:107]
  v_rcp_f32 v22, v22
  v_mfma_f32_16x16x32_bf16 v[112:115], v[32:35], a[252:255], v[112:115]
  s_waitcnt lgkmcnt(2)
  v_mfma_f32_16x16x32_bf16 v[84:87], v[36:39], v[52:55], v[84:87]
  v_rcp_f32 v23, v23
  v_mfma_f32_16x16x32_bf16 v[92:95], v[36:39], v[56:59], v[92:95]
  v_rcp_f32 v24, v24
  v_mfma_f32_16x16x32_bf16 v[100:103], v[36:39], v[60:63], v[100:103]
  v_rcp_f32 v25, v25
  v_mfma_f32_16x16x32_bf16 v[108:111], v[36:39], v[64:67], v[108:111]
  v_rcp_f32 v26, v26
  v_mfma_f32_16x16x32_bf16 v[88:91], v[40:43], v[52:55], v[88:91]
  v_rcp_f32 v27, v27
  v_mfma_f32_16x16x32_bf16 v[96:99], v[40:43], v[56:59], v[96:99]
  v_mul_f32 v200, v200, v20
  v_mul_f32 v201, v201, v21
  v_mfma_f32_16x16x32_bf16 v[104:107], v[40:43], v[60:63], v[104:107]
  v_mul_f32 v202, v202, v22
  v_mul_f32 v203, v203, v23
  v_mfma_f32_16x16x32_bf16 v[112:115], v[40:43], v[64:67], v[112:115]
  v_mul_f32 v208, v208, v24
  s_waitcnt lgkmcnt(0)
  v_mfma_f32_16x16x32_bf16 v[84:87], v[44:47], v[68:71], v[84:87]
  v_mul_f32 v209, v209, v25
  v_mul_f32 v210, v210, v26
  v_mfma_f32_16x16x32_bf16 v[92:95], v[44:47], v[72:75], v[92:95]
  v_mul_f32 v211, v211, v27
  v_cvt_pk_bf16_f32 v16, v200, v201
  v_mfma_f32_16x16x32_bf16 v[100:103], v[44:47], v[76:79], v[100:103]
  v_cvt_pk_bf16_f32 v17, v202, v203
  v_cvt_pk_bf16_f32 v18, v208, v209
  v_mfma_f32_16x16x32_bf16 v[108:111], v[44:47], v[80:83], v[108:111]
  v_cvt_pk_bf16_f32 v19, v210, v211
  s_add_u32 s29, s26, 298496
  v_mfma_f32_16x16x32_bf16 v[88:91], v[48:51], v[68:71], v[88:91]
  s_nop 0
  v_permlane16_swap_b32 v16, v18
  v_mfma_f32_16x16x32_bf16 v[96:99], v[48:51], v[72:75], v[96:99]
  v_permlane16_swap_b32 v17, v19
  buffer_store_dwordx4 v[16:19], v6, s[16:19], s29 offen sc1
  v_mfma_f32_16x16x32_bf16 v[104:107], v[48:51], v[76:79], v[104:107]
  v_mfma_f32_16x16x32_bf16 v[112:115], v[48:51], v[80:83], v[112:115]
  s_nop 7
  v_mov_b32 v10, s43
  v_pk_fma_f32 v[20:21], v[84:85], v[84:85], v[10:11] op_sel_hi:[1,1,0]
  v_pk_fma_f32 v[22:23], v[86:87], v[86:87], v[10:11] op_sel_hi:[1,1,0]
  v_pk_fma_f32 v[24:25], v[92:93], v[92:93], v[10:11] op_sel_hi:[1,1,0]
  v_pk_fma_f32 v[26:27], v[94:95], v[94:95], v[10:11] op_sel_hi:[1,1,0]
  v_pk_mul_f32 v[20:21], v[20:21], v[84:85]
  v_pk_mul_f32 v[22:23], v[22:23], v[86:87]
  v_pk_mul_f32 v[24:25], v[24:25], v[92:93]
  v_pk_mul_f32 v[26:27], v[26:27], v[94:95]
  v_exp_f32_e64 v20, -v20
  v_exp_f32_e64 v21, -v21
  v_pk_mul_f32 v[88:89], v[84:85], v[88:89]
  v_exp_f32_e64 v22, -v22
  v_exp_f32_e64 v23, -v23
  v_pk_mul_f32 v[90:91], v[86:87], v[90:91]
  v_exp_f32_e64 v24, -v24
  v_exp_f32_e64 v25, -v25
  v_pk_mul_f32 v[96:97], v[92:93], v[96:97]
  v_exp_f32_e64 v26, -v26
  v_exp_f32_e64 v27, -v27
  v_pk_mul_f32 v[98:99], v[94:95], v[98:99]
  v_pk_add_f32 v[20:21], v[20:21], 1.0 op_sel_hi:[1,0]
  v_pk_add_f32 v[22:23], v[22:23], 1.0 op_sel_hi:[1,0]
  v_pk_add_f32 v[24:25], v[24:25], 1.0 op_sel_hi:[1,0]
  v_pk_add_f32 v[26:27], v[26:27], 1.0 op_sel_hi:[1,0]
  v_rcp_f32 v20, v20
  v_rcp_f32 v21, v21
  v_rcp_f32 v22, v22
  v_rcp_f32 v23, v23
  v_rcp_f32 v24, v24
  v_rcp_f32 v25, v25
  v_rcp_f32 v26, v26
  v_rcp_f32 v27, v27
  s_nop 0
  v_pk_mul_f32 v[88:89], v[88:89], v[20:21]
  v_pk_mul_f32 v[90:91], v[90:91], v[22:23]
  v_pk_mul_f32 v[96:97], v[96:97], v[24:25]
  v_pk_mul_f32 v[98:99], v[98:99], v[26:27]
  v_cvt_pk_bf16_f32 v12, v88, v89
  v_cvt_pk_bf16_f32 v13, v90, v91
  v_cvt_pk_bf16_f32 v14, v96, v97
  v_cvt_pk_bf16_f32 v15, v98, v99
  s_add_u32 s29, s26, 4096
  s_nop 0
  v_permlane16_swap_b32 v12, v14
  v_permlane16_swap_b32 v13, v15
  buffer_store_dwordx4 v[12:15], v6, s[16:19], s29 offen sc1
  v_pk_fma_f32 v[20:21], v[100:101], v[100:101], v[10:11] op_sel_hi:[1,1,0]
  v_pk_fma_f32 v[22:23], v[102:103], v[102:103], v[10:11] op_sel_hi:[1,1,0]
  v_pk_fma_f32 v[24:25], v[108:109], v[108:109], v[10:11] op_sel_hi:[1,1,0]
  v_pk_fma_f32 v[26:27], v[110:111], v[110:111], v[10:11] op_sel_hi:[1,1,0]
  v_pk_mul_f32 v[20:21], v[20:21], v[100:101]
  v_pk_mul_f32 v[22:23], v[22:23], v[102:103]
  v_pk_mul_f32 v[24:25], v[24:25], v[108:109]
  v_pk_mul_f32 v[26:27], v[26:27], v[110:111]
  v_exp_f32_e64 v20, -v20
  v_exp_f32_e64 v21, -v21
  v_pk_mul_f32 v[104:105], v[100:101], v[104:105]
  v_exp_f32_e64 v22, -v22
  v_exp_f32_e64 v23, -v23
  v_pk_mul_f32 v[106:107], v[102:103], v[106:107]
  v_exp_f32_e64 v24, -v24
  v_exp_f32_e64 v25, -v25
  v_pk_mul_f32 v[112:113], v[108:109], v[112:113]
  v_exp_f32_e64 v26, -v26
  v_exp_f32_e64 v27, -v27
  v_pk_mul_f32 v[114:115], v[110:111], v[114:115]
  v_pk_add_f32 v[20:21], v[20:21], 1.0 op_sel_hi:[1,0]
  v_pk_add_f32 v[22:23], v[22:23], 1.0 op_sel_hi:[1,0]
  v_pk_add_f32 v[24:25], v[24:25], 1.0 op_sel_hi:[1,0]
  v_pk_add_f32 v[26:27], v[26:27], 1.0 op_sel_hi:[1,0]
  v_rcp_f32 v20, v20
  v_rcp_f32 v21, v21
  v_rcp_f32 v22, v22
  v_rcp_f32 v23, v23
  v_rcp_f32 v24, v24
  v_rcp_f32 v25, v25
  v_rcp_f32 v26, v26
  v_rcp_f32 v27, v27
  s_nop 0
  v_pk_mul_f32 v[104:105], v[104:105], v[20:21]
  v_pk_mul_f32 v[106:107], v[106:107], v[22:23]
  v_pk_mul_f32 v[112:113], v[112:113], v[24:25]
  v_pk_mul_f32 v[114:115], v[114:115], v[26:27]
  v_cvt_pk_bf16_f32 v16, v104, v105
  v_cvt_pk_bf16_f32 v17, v106, v107
  v_cvt_pk_bf16_f32 v18, v112, v113
  v_cvt_pk_bf16_f32 v19, v114, v115
  s_add_u32 s29, s26, 299008
  s_nop 0
  v_permlane16_swap_b32 v16, v18
  v_permlane16_swap_b32 v17, v19
  buffer_store_dwordx4 v[16:19], v6, s[16:19], s29 offen sc1
K4_END:
  s_endpgm

.globl gemm2_kernel
.p2align 8
.type gemm2_kernel,@function
gemm2_kernel:
L_gemm2_kernel:
  s_cmp_ge_u32 s2, 256
  s_cbranch_scc1 K5_END
  s_load_dwordx2 s[4:5], s[0:1], 136
  s_load_dwordx2 s[36:37], s[0:1], 120
  v_and_b32 v9, 63, v0
  v_lshrrev_b32 v10, 6, v0
  s_nop 0
  v_readfirstlane_b32 s3, v10
  s_and_b32 s6, s2, 7
  s_lshr_b32 s7, s2, 3
  s_and_b32 s30, s6, 3
  s_lshr_b32 s31, s6, 2
  s_lshl_b32 s31, s31, 3
  s_and_b32 s16, s7, 7
  s_add_u32 s31, s31, s16
  s_lshr_b32 s32, s7, 3
  s_lshl_b32 s33, s32, 1
  s_add_u32 s33, s33, s16
  s_and_b32 s33, s33, 7
  s_mov_b32 s33, 0
  v_lshlrev_b32 v1, 4, v9
  v_add_u32 v2, 0, v1
  v_add_u32 v3, 36864, v1
  v_add_u32 v4, 73728, v1
  v_add_u32 v5, 110592, v1
  s_mul_i32 s20, s32, 144
  s_mul_i32 s21, s30, 36
  s_add_u32 s20, s20, s21
  s_mul_i32 s20, s20, 9216
  s_mul_i32 s23, s3, 9216
  s_add_u32 s24, s20, s23
  s_lshl_b32 s25, s31, 3
  s_lshl_b32 s26, s3, 1
  s_add_u32 s25, s25, s26
  s_mul_i32 s25, s25, 147456
  s_lshl_b32 s21, s21, 10
  s_add_u32 s25, s25, s21
  s_lshl_b32 s26, s31, 2
  s_add_u32 s26, s26, s32
  s_lshl_b32 s26, s26, 2
  s_add_u32 s26, s26, s3
  s_mul_i32 s26, s26, 9216
  s_mul_i32 s27, s30, 2359296
  s_add_u32 s26, s26, s27
  v_and_b32 v10, 15, v9
  v_lshrrev_b32 v11, 4, v9
  v_lshlrev_b32 v10, 5, v10
  v_lshl_add_u32 v7, v11, 3, v10
  s_waitcnt lgkmcnt(0)
  s_add_u32 s8, s4, 22593536
  s_addc_u32 s9, s5, 0
  s_mov_b32 s10, 5308416
  s_mov_b32 s11, 0x20000
  s_add_u32 s12, s4, 27901952
  s_addc_u32 s13, s5, 0
  s_mov_b32 s14, 18874368
  s_mov_b32 s15, 0x20000
  s_add_u32 s16, s4, 46776320
  s_addc_u32 s17, s5, 0
  s_mov_b32 s18, 9437184
  s_mov_b32 s19, 0x20000
  s_mul_i32 s34, s33, 36864
  s_add_u32 s34, s34, s24
  s_lshl_b32 s35, s33, 12
  s_add_u32 s35, s35, s25
  s_add_u32 s33, s33, 1
  s_cmp_eq_u32 s33, 9
  s_cselect_b32 s33, 0, s33
  s_add_u32 m0, s23, 0
  s_add_u32 s27, s34, 0
  buffer_load_dwordx4 v1, s[8:11], s27 offen offset:0 lds
  s_add_u32 s28, s35, 0
  buffer_load_dwordx4 a[0:3], v1, s[12:15], s28 offen offset:0
  buffer_load_dwordx4 v1, s[8:11], s27 offen offset:1024 lds
  buffer_load_dwordx4 a[8:11], v1, s[12:15], s28 offen offset:1024
  buffer_load_dwordx4 v1, s[8:11], s27 offen offset:2048 lds
  buffer_load_dwordx4 a[16:19], v1, s[12:15], s28 offen offset:2048
  buffer_load_dwordx4 v1, s[8:11], s27 offen offset:3072 lds
  buffer_load_dwordx4 a[24:27], v1, s[12:15], s28 offen offset:3072
  s_add_u32 m0, s23, 4096
  s_add_u32 s27, s34, 4096
  buffer_load_dwordx4 v1, s[8:11], s27 offen offset:0 lds
  s_add_u32 s28, s35, 147456
  buffer_load_dwordx4 a[4:7], v1, s[12:15], s28 offen offset:0
  buffer_load_dwordx4 v1, s[8:11], s27 offen offset:1024 lds
  buffer_load_dwordx4 a[12:15], v1, s[12:15], s28 offen offset:1024
  buffer_load_dwordx4 v1, s[8:11], s27 offen offset:2048 lds
  buffer_load_dwordx4 a[20:23], v1, s[12:15], s28 offen offset:2048
  buffer_load_dwordx4 v1, s[8:11], s27 offen offset:3072 lds
  buffer_load_dwordx4 a[28:31], v1, s[12:15], s28 offen offset:3072
  s_add_u32 m0, s23, 8192
  s_add_u32 s27, s34, 8192
  buffer_load_dwordx4 v1, s[8:11], s27 offen offset:0 lds
  s_getpc_b64 s[96:97]
PFPC9:
  v_lshlrev_b32 v116, 7, v9
  v_min_u32 v116, K5_END-PFPC9-4, v116
  global_load_dword v117, v116, s[96:97]
  v_add_u32 v116, 8192, v116
  v_min_u32 v116, K5_END-PFPC9-4, v116
  global_load_dword v117, v116, s[96:97]
  v_add_u32 v116, 8192, v116
  v_min_u32 v116, K5_END-PFPC9-4, v116
  global_load_dword v117, v116, s[96:97]
  s_mul_i32 s34, s33, 36864
  s_add_u32 s34, s34, s24
  s_lshl_b32 s35, s33, 12
  s_add_u32 s35, s35, s25
  s_add_u32 s33, s33, 1
  s_cmp_eq_u32 s33, 9
  s_cselect_b32 s33, 0, s33
  s_add_u32 m0, s23, 36864
  s_add_u32 s27, s34, 0
  buffer_load_dwordx4 v1, s[8:11], s27 offen offset:0 lds
  s_add_u32 s28, s35, 0
  buffer_load_dwordx4 a[32:35], v1, s[12:15], s28 offen offset:0
  buffer_load_dwordx4 v1, s[8:11], s27 offen offset:1024 lds
  buffer_load_dwordx4 a[40:43], v1, s[12:15], s28 offen offset:1024
  buffer_load_dwordx4 v1, s[8:11], s27 offen offset:2048 lds
  buffer_load_dwordx4 a[48:51], v1, s[12:15], s28 offen offset:2048
  buffer_load_dwordx4 v1, s[8:11], s27 offen offset:3072 lds
  buffer_load_dwordx4 a[56:59], v1, s[12:15], s28 offen offset:3072
  s_add_u32 m0, s23, 40960
  s_add_u32 s27, s34, 4096
  buffer_load_dwordx4 v1, s[8:11], s27 offen offset:0 lds
  s_add_u32 s28, s35, 147456
  buffer_load_dwordx4 a[36:39], v1, s[12:15], s28 offen offset:0
  buffer_load_dwordx4 v1, s[8:11], s27 offen offset:1024 lds
  buffer_load_dwordx4 a[44:47], v1, s[12:15], s28 offen offset:1024
  buffer_load_dwordx4 v1, s[8:11], s27 offen offset:2048 lds
  buffer_load_dwordx4 a[52:55], v1, s[12:15], s28 offen offset:2048
  buffer_load_dwordx4 v1, s[8:11], s27 offen offset:3072 lds
  buffer_load_dwordx4 a[60:63], v1, s[12:15], s28 offen offset:3072
  s_add_u32 m0, s23, 45056
  s_add_u32 s27, s34, 8192
  buffer_load_dwordx4 v1, s[8:11], s27 offen offset:0 lds
  s_waitcnt lgkmcnt(0)
  s_waitcnt vmcnt(20)
  s_barrier
  ds_read_b128 v[12:15], v2 offset:0
  ds_read_b128 v[16:19], v2 offset:1024
  ds_read_b128 v[20:23], v2 offset:2048
  ds_read_b128 v[24:27], v2 offset:3072
  ds_read_b128 v[28:31], v2 offset:4096
  ds_read_b128 v[32:35], v2 offset:5120
  s_waitcnt lgkmcnt(5)
  v_mfma_f32_16x16x32_bf16 v[44:47], v[12:15], a[0:3], 0
  s_mul_i32 s34, s33, 36864
  s_add_u32 s34, s34, s24
  v_mfma_f32_16x16x32_bf16 v[80:83], v[12:15], a[4:7], 0
  ds_read_b128 v[36:39], v2 offset:6144
  s_waitcnt lgkmcnt(5)
  v_mfma_f32_16x16x32_bf16 v[48:51], v[16:19], a[0:3], 0
  s_lshl_b32 s35, s33, 12
  s_add_u32 s35, s35, s25
  v_mfma_f32_16x16x32_bf16 v[84:87], v[16:19], a[4:7], 0
  ds_read_b128 v[40:43], v2 offset:7168
  s_waitcnt lgkmcnt(5)
  v_mfma_f32_16x16x32_bf16 v[52:55], v[20:23], a[0:3], 0
  s_add_u32 s33, s33, 1
  v_mfma_f32_16x16x32_bf16 v[88:91], v[20:23], a[4:7], 0
  ds_read_b128 v[12:15], v2 offset:8192
  s_waitcnt lgkmcnt(5)
  v_mfma_f32_16x16x32_bf16 v[56:59], v[24:27], a[0:3], 0
  s_cmp_eq_u32 s33, 9
  s_cselect_b32 s33, 0, s33
  v_mfma_f32_16x16x32_bf16 v[92:95], v[24:27], a[4:7], 0
  ds_read_b128 v[16:19], v2 offset:9216
  s_waitcnt lgkmcnt(5)
  v_mfma_f32_16x16x32_bf16 v[60:63], v[28:31], a[0:3], 0
  s_add_u32 m0, s23, 73728
  s_add_u32 s27, s34, 0
  v_mfma_f32_16x16x32_bf16 v[96:99], v[28:31], a[4:7], 0
  ds_read_b128 v[20:23], v2 offset:10240
  s_waitcnt lgkmcnt(5)
  v_mfma_f32_16x16x32_bf16 v[64:67], v[32:35], a[0:3], 0
  buffer_load_dwordx4 v1, s[8:11], s27 offen offset:0 lds
  s_add_u32 s28, s35, 0
  v_mfma_f32_16x16x32_bf16 v[100:103], v[32:35], a[4:7], 0
  ds_read_b128 v[24:27], v2 offset:11264
  s_waitcnt lgkmcnt(5)
  v_mfma_f32_16x16x32_bf16 v[68:71], v[36:39], a[0:3], 0
  buffer_load_dwordx4 a[64:67], v1, s[12:15], s28 offen offset:0
  buffer_load_dwordx4 v1, s[8:11], s27 offen offset:1024 lds
  v_mfma_f32_16x16x32_bf16 v[104:107], v[36:39], a[4:7], 0
  ds_read_b128 v[28:31], v2 offset:12288
  s_waitcnt lgkmcnt(5)
  v_mfma_f32_16x16x32_bf16 v[72:75], v[40:43], a[0:3], 0
  buffer_load_dwordx4 a[72:75], v1, s[12:15], s28 offen offset:1024
  s_lshl_b32 s38, s31, 7
  v_mfma_f32_16x16x32_bf16 v[108:111], v[40:43], a[4:7], 0
  ds_read_b128 v[32:35], v2 offset:13312
  s_waitcnt lgkmcnt(5)
  v_mfma_f32_16x16x32_bf16 v[76:79], v[12:15], a[0:3], 0
  buffer_load_dwordx4 v1, s[8:11], s27 offen offset:2048 lds
  s_lshl_b32 s39, s30, 5
  v_mfma_f32_16x16x32_bf16 v[112:115], v[12:15], a[4:7], 0
  ds_read_b128 v[36:39], v2 offset:14336
  s_waitcnt lgkmcnt(5)
  v_mfma_f32_16x16x32_bf16 v[44:47], v[16:19], a[8:11], v[44:47]
  s_add_u32 s38, s38, s39
  s_mul_i32 s39, s32, 144
  v_mfma_f32_16x16x32_bf16 v[80:83], v[16:19], a[12:15], v[80:83]
  ds_read_b128 v[40:43], v2 offset:15360
  s_waitcnt lgkmcnt(5)
  v_mfma_f32_16x16x32_bf16 v[48:51], v[20:23], a[8:11], v[48:51]
  buffer_load_dwordx4 a[80:83], v1, s[12:15], s28 offen offset:2048
  s_lshl_b32 s40, s31, 2
  v_mfma_f32_16x16x32_bf16 v[84:87], v[20:23], a[12:15], v[84:87]
  ds_read_b128 v[12:15], v2 offset:16384
  s_waitcnt lgkmcnt(5)
  v_mfma_f32_16x16x32_bf16 v[52:55], v[24:27], a[8:11], v[52:55]
  s_add_u32 s40, s40, s32
  s_lshl_b32 s41, s40, 2
  v_mfma_f32_16x16x32_bf16 v[88:91], v[24:27], a[12:15], v[88:91]
  ds_read_b128 v[16:19], v2 offset:17408
  s_waitcnt lgkmcnt(5)
  v_mfma_f32_16x16x32_bf16 v[56:59], v[28:31], a[8:11], v[56:59]
  buffer_load_dwordx4 v1, s[8:11], s27 offen offset:3072 lds
  s_add_u32 s41, s41, s30
  v_mfma_f32_16x16x32_bf16 v[92:95], v[28:31], a[12:15], v[92:95]
  ds_read_b128 v[20:23], v2 offset:18432
  s_waitcnt lgkmcnt(5)
  v_mfma_f32_16x16x32_bf16 v[60:63], v[32:35], a[8:11], v[60:63]
  s_mul_i32 s42, s41, 9216
  v_add_u32 v188, 0, v0
  v_mfma_f32_16x16x32_bf16 v[96:99], v[32:35], a[12:15], v[96:99]
  ds_read_b128 v[24:27], v2 offset:19456
  s_waitcnt lgkmcnt(5)
  v_mfma_f32_16x16x32_bf16 v[64:67], v[36:39], a[8:11], v[64:67]
  buffer_load_dwordx4 a[88:91], v1, s[12:15], s28 offen offset:3072
  v_cmp_le_u32 vcc, 288, v188
  v_mfma_f32_16x16x32_bf16 v[100:103], v[36:39], a[12:15], v[100:103]
  ds_read_b128 v[28:31], v2 offset:20480
  s_waitcnt lgkmcnt(5)
  v_mfma_f32_16x16x32_bf16 v[68:71], v[40:43], a[8:11], v[68:71]
  v_mov_b32 v193, 0
  v_mov_b32 v194, 288
  v_mfma_f32_16x16x32_bf16 v[104:107], v[40:43], a[12:15], v[104:107]
  ds_read_b128 v[32:35], v2 offset:21504
  s_waitcnt lgkmcnt(5)
  v_mfma_f32_16x16x32_bf16 v[72:75], v[12:15], a[8:11], v[72:75]
  s_add_u32 m0, s23, 77824
  s_add_u32 s27, s34, 4096
  v_mfma_f32_16x16x32_bf16 v[108:111], v[12:15], a[12:15], v[108:111]
  ds_read_b128 v[36:39], v2 offset:22528
  s_waitcnt lgkmcnt(5)
  v_mfma_f32_16x16x32_bf16 v[76:79], v[16:19], a[8:11], v[76:79]
  buffer_load_dwordx4 v1, s[8:11], s27 offen offset:0 lds
  v_cndmask_b32 v193, v193, v194, vcc
  v_mfma_f32_16x16x32_bf16 v[112:115], v[16:19], a[12:15], v[112:115]
  ds_read_b128 v[40:43], v2 offset:23552
  s_waitcnt lgkmcnt(5)
  v_mfma_f32_16x16x32_bf16 v[44:47], v[20:23], a[16:19], v[44:47]
  s_add_u32 s28, s35, 147456
  buffer_load_dwordx4 a[68:71], v1, s[12:15], s28 offen offset:0
  v_mfma_f32_16x16x32_bf16 v[80:83], v[20:23], a[20:23], v[80:83]
  ds_read_b128 v[12:15], v2 offset:24576
  s_waitcnt lgkmcnt(5)
  v_mfma_f32_16x16x32_bf16 v[48:51], v[24:27], a[16:19], v[48:51]
  v_sub_u32 v189, v188, v193
  v_mov_b32 v194, 16
  v_mfma_f32_16x16x32_bf16 v[84:87], v[24:27], a[20:23], v[84:87]
  ds_read_b128 v[16:19], v2 offset:25600
  s_waitcnt lgkmcnt(5)
  v_mfma_f32_16x16x32_bf16 v[52:55], v[28:31], a[16:19], v[52:55]
  buffer_load_dwordx4 v1, s[8:11], s27 offen offset:1024 lds
  v_mov_b32 v195, 0
  v_mfma_f32_16x16x32_bf16 v[88:91], v[28:31], a[20:23], v[88:91]
  ds_read_b128 v[20:23], v2 offset:26624
  s_waitcnt lgkmcnt(5)
  v_mfma_f32_16x16x32_bf16 v[56:59], v[32:35], a[16:19], v[56:59]
  v_cndmask_b32 v195, v195, v194, vcc
  v_and_b32 v191, 15, v189
  v_mfma_f32_16x16x32_bf16 v[92:95], v[32:35], a[20:23], v[92:95]
  ds_read_b128 v[24:27], v2 offset:27648
  s_waitcnt lgkmcnt(5)
  v_mfma_f32_16x16x32_bf16 v[60:63], v[36:39], a[16:19], v[60:63]
  buffer_load_dwordx4 a[76:79], v1, s[12:15], s28 offen offset:1024
  v_bfe_u32 v192, v189, 4, 2
  v_mfma_f32_16x16x32_bf16 v[96:99], v[36:39], a[20:23], v[96:99]
  ds_read_b128 v[28:31], v2 offset:28672
  s_waitcnt lgkmcnt(5)
  v_mfma_f32_16x16x32_bf16 v[64:67], v[40:43], a[16:19], v[64:67]
  v_lshlrev_b32 v192, 3, v192
  v_lshrrev_b32 v193, 6, v189
  v_mfma_f32_16x16x32_bf16 v[100:103], v[40:43], a[20:23], v[100:103]
  ds_read_b128 v[32:35], v2 offset:29696
  s_waitcnt lgkmcnt(5)
  v_mfma_f32_16x16x32_bf16 v[68:71], v[12:15], a[16:19], v[68:71]
  buffer_load_dwordx4 v1, s[8:11], s27 offen offset:2048 lds
  v_lshl_add_u32 v192, v193, 5, v192
  v_mfma_f32_16x16x32_bf16 v[104:107], v[12:15], a[20:23], v[104:107]
  ds_read_b128 v[36:39], v2 offset:30720
  s_waitcnt lgkmcnt(5)
  v_mfma_f32_16x16x32_bf16 v[72:75], v[16:19], a[16:19], v[72:75]
  v_subrev_u32 v193, 256, v189
  v_lshrrev_b32 v194, 1, v193
  v_mfma_f32_16x16x32_bf16 v[108:111], v[16:19], a[20:23], v[108:111]
  ds_read_b128 v[40:43], v2 offset:31744
  s_waitcnt lgkmcnt(5)
  v_mfma_f32_16x16x32_bf16 v[76:79], v[20:23], a[16:19], v[76:79]
  buffer_load_dwordx4 a[84:87], v1, s[12:15], s28 offen offset:2048
  v_and_b32 v193, 1, v193
  v_mfma_f32_16x16x32_bf16 v[112:115], v[20:23], a[20:23], v[112:115]
  ds_read_b128 v[12:15], v2 offset:32768
  s_waitcnt lgkmcnt(5)
  v_mfma_f32_16x16x32_bf16 v[44:47], v[24:27], a[24:27], v[44:47]
  v_lshlrev_b32 v193, 3, v193
  v_add_u32 v193, 128, v193
  v_mfma_f32_16x16x32_bf16 v[80:83], v[24:27], a[28:31], v[80:83]
  ds_read_b128 v[16:19], v2 offset:33792
  s_waitcnt lgkmcnt(5)
  v_mfma_f32_16x16x32_bf16 v[48:51], v[28:31], a[24:27], v[48:51]
  buffer_load_dwordx4 v1, s[8:11], s27 offen offset:3072 lds
  v_cmp_gt_u32 vcc, 256, v189
  v_mfma_f32_16x16x32_bf16 v[84:87], v[28:31], a[28:31], v[84:87]
  ds_read_b128 v[20:23], v2 offset:34816
  s_waitcnt lgkmcnt(5)
  v_mfma_f32_16x16x32_bf16 v[52:55], v[32:35], a[24:27], v[52:55]
  v_add_u32 v195, s38, v195
  v_nop
  v_mfma_f32_16x16x32_bf16 v[88:91], v[32:35], a[28:31], v[88:91]
  ds_read_b128 v[24:27], v2 offset:35840
  s_waitcnt lgkmcnt(5)
  v_mfma_f32_16x16x32_bf16 v[56:59], v[36:39], a[24:27], v[56:59]
  buffer_load_dwordx4 a[92:95], v1, s[12:15], s28 offen offset:3072
  v_cndmask_b32 v191, v194, v191, vcc
  v_mfma_f32_16x16x32_bf16 v[92:95], v[36:39], a[28:31], v[92:95]
  s_waitcnt vmcnt(16)
  s_barrier
  ds_read_b128 v[28:31], v3 offset:0
  s_waitcnt lgkmcnt(5)
  v_mfma_f32_16x16x32_bf16 v[60:63], v[40:43], a[24:27], v[60:63]
  v_cndmask_b32 v192, v193, v192, vcc
  v_add_u32 v191, v191, v195
  v_mfma_f32_16x16x32_bf16 v[96:99], v[40:43], a[28:31], v[96:99]
  ds_read_b128 v[32:35], v3 offset:1024
  s_waitcnt lgkmcnt(5)
  v_mfma_f32_16x16x32_bf16 v[64:67], v[12:15], a[24:27], v[64:67]
  s_add_u32 m0, s23, 81920
  s_add_u32 s27, s34, 8192
  v_mfma_f32_16x16x32_bf16 v[100:103], v[12:15], a[28:31], v[100:103]
  ds_read_b128 v[36:39], v3 offset:2048
  s_waitcnt lgkmcnt(5)
  v_mfma_f32_16x16x32_bf16 v[68:71], v[16:19], a[24:27], v[68:71]
  buffer_load_dwordx4 v1, s[8:11], s27 offen offset:0 lds
  v_add_u32 v192, s39, v192
  v_mfma_f32_16x16x32_bf16 v[104:107], v[16:19], a[28:31], v[104:107]
  ds_read_b128 v[40:43], v3 offset:3072
  s_waitcnt lgkmcnt(5)
  v_mfma_f32_16x16x32_bf16 v[72:75], v[20:23], a[24:27], v[72:75]
  s_mul_i32 s34, s33, 36864
  s_add_u32 s34, s34, s24
  v_mfma_f32_16x16x32_bf16 v[108:111], v[20:23], a[28:31], v[108:111]
  ds_read_b128 v[12:15], v3 offset:4096
  s_waitcnt lgkmcnt(5)
  v_mfma_f32_16x16x32_bf16 v[76:79], v[24:27], a[24:27], v[76:79]
  s_lshl_b32 s35, s33, 12
  s_add_u32 s35, s35, s25
  v_mfma_f32_16x16x32_bf16 v[112:115], v[24:27], a[28:31], v[112:115]
  ds_read_b128 v[16:19], v3 offset:5120
  s_waitcnt lgkmcnt(5)
  v_mfma_f32_16x16x32_bf16 v[44:47], v[28:31], a[32:35], v[44:47]
  s_add_u32 s33, s33, 1
  v_lshlrev_b32 v155, 1, v192
  v_mfma_f32_16x16x32_bf16 v[80:83], v[28:31], a[36:39], v[80:83]
  ds_read_b128 v[20:23], v3 offset:6144
  s_waitcnt lgkmcnt(5)
  v_mfma_f32_16x16x32_bf16 v[48:51], v[32:35], a[32:35], v[48:51]
  s_cmp_eq_u32 s33, 9
  s_cselect_b32 s33, 0, s33
  v_mfma_f32_16x16x32_bf16 v[84:87], v[32:35], a[36:39], v[84:87]
  ds_read_b128 v[24:27], v3 offset:7168
  s_waitcnt lgkmcnt(5)
  v_mfma_f32_16x16x32_bf16 v[52:55], v[36:39], a[32:35], v[52:55]
  s_add_u32 m0, s23, 110592
  s_add_u32 s27, s34, 0
  v_mfma_f32_16x16x32_bf16 v[88:91], v[36:39], a[36:39], v[88:91]
  ds_read_b128 v[28:31], v3 offset:8192
  s_waitcnt lgkmcnt(5)
  v_mfma_f32_16x16x32_bf16 v[56:59], v[40:43], a[32:35], v[56:59]
  buffer_load_dwordx4 v1, s[8:11], s27 offen offset:0 lds
  s_add_u32 s28, s35, 0
  v_mfma_f32_16x16x32_bf16 v[92:95], v[40:43], a[36:39], v[92:95]
  ds_read_b128 v[32:35], v3 offset:9216
  s_waitcnt lgkmcnt(5)
  v_mfma_f32_16x16x32_bf16 v[60:63], v[12:15], a[32:35], v[60:63]
  buffer_load_dwordx4 a[96:99], v1, s[12:15], s28 offen offset:0
  buffer_load_dwordx4 v1, s[8:11], s27 offen offset:1024 lds
  v_mfma_f32_16x16x32_bf16 v[96:99], v[12:15], a[36:39], v[96:99]
  ds_read_b128 v[36:39], v3 offset:10240
  s_waitcnt lgkmcnt(5)
  v_mfma_f32_16x16x32_bf16 v[64:67], v[16:19], a[32:35], v[64:67]
  buffer_load_dwordx4 a[104:107], v1, s[12:15], s28 offen offset:1024
  v_mul_u32_u24 v152, 1152, v191
  v_mfma_f32_16x16x32_bf16 v[100:103], v[16:19], a[36:39], v[100:103]
  ds_read_b128 v[40:43], v3 offset:11264
  s_waitcnt lgkmcnt(5)
  v_mfma_f32_16x16x32_bf16 v[68:71], v[20:23], a[32:35], v[68:71]
  buffer_load_dwordx4 v1, s[8:11], s27 offen offset:2048 lds
  v_add_u32 v152, v152, v155
  v_mfma_f32_16x16x32_bf16 v[104:107], v[20:23], a[36:39], v[104:107]
  ds_read_b128 v[12:15], v3 offset:12288
  s_waitcnt lgkmcnt(5)
  v_mfma_f32_16x16x32_bf16 v[72:75], v[24:27], a[32:35], v[72:75]
  v_lshlrev_b32 v158, 4, v188
  v_add_u32 v158, s42, v158
  v_mfma_f32_16x16x32_bf16 v[108:111], v[24:27], a[36:39], v[108:111]
  ds_read_b128 v[16:19], v3 offset:13312
  s_waitcnt lgkmcnt(5)
  v_mfma_f32_16x16x32_bf16 v[76:79], v[28:31], a[32:35], v[76:79]
  buffer_load_dwordx4 a[112:115], v1, s[12:15], s28 offen offset:2048
  v_add_u32 v188, 256, v0
  v_mfma_f32_16x16x32_bf16 v[112:115], v[28:31], a[36:39], v[112:115]
  ds_read_b128 v[20:23], v3 offset:14336
  s_waitcnt lgkmcnt(5)
  v_mfma_f32_16x16x32_bf16 v[44:47], v[32:35], a[40:43], v[44:47]
  v_cmp_le_u32 vcc, 288, v188
  v_mov_b32 v193, 0
  v_mfma_f32_16x16x32_bf16 v[80:83], v[32:35], a[44:47], v[80:83]
  ds_read_b128 v[24:27], v3 offset:15360
  s_waitcnt lgkmcnt(5)
  v_mfma_f32_16x16x32_bf16 v[48:51], v[36:39], a[40:43], v[48:51]
  buffer_load_dwordx4 v1, s[8:11], s27 offen offset:3072 lds
  v_mov_b32 v194, 288
  v_mfma_f32_16x16x32_bf16 v[84:87], v[36:39], a[44:47], v[84:87]
  ds_read_b128 v[28:31], v3 offset:16384
  s_waitcnt lgkmcnt(5)
  v_mfma_f32_16x16x32_bf16 v[52:55], v[40:43], a[40:43], v[52:55]
  v_cndmask_b32 v193, v193, v194, vcc
  v_sub_u32 v189, v188, v193
  v_mfma_f32_16x16x32_bf16 v[88:91], v[40:43], a[44:47], v[88:91]
  ds_read_b128 v[32:35], v3 offset:17408
  s_waitcnt lgkmcnt(5)
  v_mfma_f32_16x16x32_bf16 v[56:59], v[12:15], a[40:43], v[56:59]
  buffer_load_dwordx4 a[120:123], v1, s[12:15], s28 offen offset:3072
  v_mov_b32 v194, 16
  v_mfma_f32_16x16x32_bf16 v[92:95], v[12:15], a[44:47], v[92:95]
  ds_read_b128 v[36:39], v3 offset:18432
  s_waitcnt lgkmcnt(5)
  v_mfma_f32_16x16x32_bf16 v[60:63], v[16:19], a[40:43], v[60:63]
  v_mov_b32 v195, 0
  v_cndmask_b32 v195, v195, v194, vcc
  v_mfma_f32_16x16x32_bf16 v[96:99], v[16:19], a[44:47], v[96:99]
  ds_read_b128 v[40:43], v3 offset:19456
  s_waitcnt lgkmcnt(5)
  v_mfma_f32_16x16x32_bf16 v[64:67], v[20:23], a[40:43], v[64:67]
  s_add_u32 m0, s23, 114688
  s_add_u32 s27, s34, 4096
  v_mfma_f32_16x16x32_bf16 v[100:103], v[20:23], a[44:47], v[100:103]
  ds_read_b128 v[12:15], v3 offset:20480
  s_waitcnt lgkmcnt(5)
  v_mfma_f32_16x16x32_bf16 v[68:71], v[24:27], a[40:43], v[68:71]
  buffer_load_dwordx4 v1, s[8:11], s27 offen offset:0 lds
  v_and_b32 v191, 15, v189
  v_mfma_f32_16x16x32_bf16 v[104:107], v[24:27], a[44:47], v[104:107]
  ds_read_b128 v[16:19], v3 offset:21504
  s_waitcnt lgkmcnt(5)
  v_mfma_f32_16x16x32_bf16 v[72:75], v[28:31], a[40:43], v[72:75]
  s_add_u32 s28, s35, 147456
  buffer_load_dwordx4 a[100:103], v1, s[12:15], s28 offen offset:0
  v_mfma_f32_16x16x32_bf16 v[108:111], v[28:31], a[44:47], v[108:111]
  ds_read_b128 v[20:23], v3 offset:22528
  s_waitcnt lgkmcnt(5)
  v_mfma_f32_16x16x32_bf16 v[76:79], v[32:35], a[40:43], v[76:79]
  v_bfe_u32 v192, v189, 4, 2
  v_lshlrev_b32 v192, 3, v192
  v_mfma_f32_16x16x32_bf16 v[112:115], v[32:35], a[44:47], v[112:115]
  ds_read_b128 v[24:27], v3 offset:23552
  s_waitcnt lgkmcnt(5)
  v_mfma_f32_16x16x32_bf16 v[44:47], v[36:39], a[48:51], v[44:47]
  buffer_load_dwordx4 v1, s[8:11], s27 offen offset:1024 lds
  v_lshrrev_b32 v193, 6, v189
  v_mfma_f32_16x16x32_bf16 v[80:83], v[36:39], a[52:55], v[80:83]
  ds_read_b128 v[28:31], v3 offset:24576
  s_waitcnt lgkmcnt(5)
  v_mfma_f32_16x16x32_bf16 v[48:51], v[40:43], a[48:51], v[48:51]
  v_lshl_add_u32 v192, v193, 5, v192
  v_subrev_u32 v193, 256, v189
  v_mfma_f32_16x16x32_bf16 v[84:87], v[40:43], a[52:55], v[84:87]
  ds_read_b128 v[32:35], v3 offset:25600
  s_waitcnt lgkmcnt(5)
  v_mfma_f32_16x16x32_bf16 v[52:55], v[12:15], a[48:51], v[52:55]
  buffer_load_dwordx4 a[108:111], v1, s[12:15], s28 offen offset:1024
  v_lshrrev_b32 v194, 1, v193
  v_mfma_f32_16x16x32_bf16 v[88:91], v[12:15], a[52:55], v[88:91]
  ds_read_b128 v[36:39], v3 offset:26624
  s_waitcnt lgkmcnt(5)
  v_mfma_f32_16x16x32_bf16 v[56:59], v[16:19], a[48:51], v[56:59]
  v_and_b32 v193, 1, v193
  v_lshlrev_b32 v193, 3, v193
  v_mfma_f32_16x16x32_bf16 v[92:95], v[16:19], a[52:55], v[92:95]
  ds_read_b128 v[40:43], v3 offset:27648
  s_waitcnt lgkmcnt(5)
  v_mfma_f32_16x16x32_bf16 v[60:63], v[20:23], a[48:51], v[60:63]
  buffer_load_dwordx4 v1, s[8:11], s27 offen offset:2048 lds
  v_add_u32 v193, 128, v193
  v_mfma_f32_16x16x32_bf16 v[96:99], v[20:23], a[52:55], v[96:99]
  ds_read_b128 v[12:15], v3 offset:28672
  s_waitcnt lgkmcnt(5)
  v_mfma_f32_16x16x32_bf16 v[64:67], v[24:27], a[48:51], v[64:67]
  v_cmp_gt_u32 vcc, 256, v189
  v_add_u32 v195, s38, v195
  v_mfma_f32_16x16x32_bf16 v[100:103], v[24:27], a[52:55], v[100:103]
  ds_read_b128 v[16:19], v3 offset:29696
  s_waitcnt lgkmcnt(5)
  v_mfma_f32_16x16x32_bf16 v[68:71], v[28:31], a[48:51], v[68:71]
  buffer_load_dwordx4 a[116:119], v1, s[12:15], s28 offen offset:2048
  v_nop
  v_mfma_f32_16x16x32_bf16 v[104:107], v[28:31], a[52:55], v[104:107]
  ds_read_b128 v[20:23], v3 offset:30720
  s_waitcnt lgkmcnt(5)
  v_mfma_f32_16x16x32_bf16 v[72:75], v[32:35], a[48:51], v[72:75]
  v_cndmask_b32 v191, v194, v191, vcc
  v_cndmask_b32 v192, v193, v192, vcc
  v_mfma_f32_16x16x32_bf16 v[108:111], v[32:35], a[52:55], v[108:111]
  ds_read_b128 v[24:27], v3 offset:31744
  s_waitcnt lgkmcnt(5)
  v_mfma_f32_16x16x32_bf16 v[76:79], v[36:39], a[48:51], v[76:79]
  buffer_load_dwordx4 v1, s[8:11], s27 offen offset:3072 lds
  v_add_u32 v191, v191, v195
  v_mfma_f32_16x16x32_bf16 v[112:115], v[36:39], a[52:55], v[112:115]
  ds_read_b128 v[28:31], v3 offset:32768
  s_waitcnt lgkmcnt(5)
  v_mfma_f32_16x16x32_bf16 v[44:47], v[40:43], a[56:59], v[44:47]
  v_add_u32 v192, s39, v192
  v_lshlrev_b32 v156, 1, v192
  v_mfma_f32_16x16x32_bf16 v[80:83], v[40:43], a[60:63], v[80:83]
  ds_read_b128 v[32:35], v3 offset:33792
  s_waitcnt lgkmcnt(5)
  v_mfma_f32_16x16x32_bf16 v[48:51], v[12:15], a[56:59], v[48:51]
  buffer_load_dwordx4 a[124:127], v1, s[12:15], s28 offen offset:3072
  v_mul_u32_u24 v153, 1152, v191
  v_mfma_f32_16x16x32_bf16 v[84:87], v[12:15], a[60:63], v[84:87]
  ds_read_b128 v[36:39], v3 offset:34816
  s_waitcnt lgkmcnt(5)
  v_mfma_f32_16x16x32_bf16 v[52:55], v[16:19], a[56:59], v[52:55]
  v_add_u32 v153, v153, v156
  v_lshlrev_b32 v159, 4, v188
  v_mfma_f32_16x16x32_bf16 v[88:91], v[16:19], a[60:63], v[88:91]
  ds_read_b128 v[40:43], v3 offset:35840
  s_waitcnt lgkmcnt(5)
  v_mfma_f32_16x16x32_bf16 v[56:59], v[20:23], a[56:59], v[56:59]
  s_add_u32 m0, s23, 118784
  s_add_u32 s27, s34, 8192
  v_mfma_f32_16x16x32_bf16 v[92:95], v[20:23], a[60:63], v[92:95]
  s_waitcnt vmcnt(16)
  s_barrier
  ds_read_b128 v[12:15], v4 offset:0
  s_waitcnt lgkmcnt(5)
  v_mfma_f32_16x16x32_bf16 v[60:63], v[24:27], a[56:59], v[60:63]
  buffer_load_dwordx4 v1, s[8:11], s27 offen offset:0 lds
  v_add_u32 v159, s42, v159
  v_mfma_f32_16x16x32_bf16 v[96:99], v[24:27], a[60:63], v[96:99]
  ds_read_b128 v[16:19], v4 offset:1024
  s_waitcnt lgkmcnt(5)
  v_mfma_f32_16x16x32_bf16 v[64:67], v[28:31], a[56:59], v[64:67]
  s_mul_i32 s34, s33, 36864
  s_add_u32 s34, s34, s24
  v_mfma_f32_16x16x32_bf16 v[100:103], v[28:31], a[60:63], v[100:103]
  ds_read_b128 v[20:23], v4 offset:2048
  s_waitcnt lgkmcnt(5)
  v_mfma_f32_16x16x32_bf16 v[68:71], v[32:35], a[56:59], v[68:71]
  s_lshl_b32 s35, s33, 12
  s_add_u32 s35, s35, s25
  v_mfma_f32_16x16x32_bf16 v[104:107], v[32:35], a[60:63], v[104:107]
  ds_read_b128 v[24:27], v4 offset:3072
  s_waitcnt lgkmcnt(5)
  v_mfma_f32_16x16x32_bf16 v[72:75], v[36:39], a[56:59], v[72:75]
  s_add_u32 s33, s33, 1
  v_add_u32 v188, 512, v0
  v_mfma_f32_16x16x32_bf16 v[108:111], v[36:39], a[60:63], v[108:111]
  ds_read_b128 v[28:31], v4 offset:4096
  s_waitcnt lgkmcnt(5)
  v_mfma_f32_16x16x32_bf16 v[76:79], v[40:43], a[56:59], v[76:79]
  s_cmp_eq_u32 s33, 9
  s_cselect_b32 s33, 0, s33
  v_mfma_f32_16x16x32_bf16 v[112:115], v[40:43], a[60:63], v[112:115]
  ds_read_b128 v[32:35], v4 offset:5120
  s_waitcnt lgkmcnt(5)
  v_mfma_f32_16x16x32_bf16 v[44:47], v[12:15], a[64:67], v[44:47]
  s_add_u32 m0, s23, 0
  s_add_u32 s27, s34, 0
  v_mfma_f32_16x16x32_bf16 v[80:83], v[12:15], a[68:71], v[80:83]
  ds_read_b128 v[36:39], v4 offset:6144
  s_waitcnt lgkmcnt(5)
  v_mfma_f32_16x16x32_bf16 v[48:51], v[16:19], a[64:67], v[48:51]
  buffer_load_dwordx4 v1, s[8:11], s27 offen offset:0 lds
  s_add_u32 s28, s35, 0
  v_mfma_f32_16x16x32_bf16 v[84:87], v[16:19], a[68:71], v[84:87]
  ds_read_b128 v[40:43], v4 offset:7168
  s_waitcnt lgkmcnt(5)
  v_mfma_f32_16x16x32_bf16 v[52:55], v[20:23], a[64:67], v[52:55]
  buffer_load_dwordx4 a[0:3], v1, s[12:15], s28 offen offset:0
  buffer_load_dwordx4 v1, s[8:11], s27 offen offset:1024 lds
  v_mfma_f32_16x16x32_bf16 v[88:91], v[20:23], a[68:71], v[88:91]
  ds_read_b128 v[12:15], v4 offset:8192
  s_waitcnt lgkmcnt(5)
  v_mfma_f32_16x16x32_bf16 v[56:59], v[24:27], a[64:67], v[56:59]
  buffer_load_dwordx4 a[8:11], v1, s[12:15], s28 offen offset:1024
  v_cmp_le_u32 vcc, 288, v188
  v_mfma_f32_16x16x32_bf16 v[92:95], v[24:27], a[68:71], v[92:95]
  ds_read_b128 v[16:19], v4 offset:9216
  s_waitcnt lgkmcnt(5)
  v_mfma_f32_16x16x32_bf16 v[60:63], v[28:31], a[64:67], v[60:63]
  buffer_load_dwordx4 v1, s[8:11], s27 offen offset:2048 lds
  v_mov_b32 v193, 0
  v_mfma_f32_16x16x32_bf16 v[96:99], v[28:31], a[68:71], v[96:99]
  ds_read_b128 v[20:23], v4 offset:10240
  s_waitcnt lgkmcnt(5)
  v_mfma_f32_16x16x32_bf16 v[64:67], v[32:35], a[64:67], v[64:67]
  v_mov_b32 v194, 288
  v_cndmask_b32 v193, v193, v194, vcc
  v_mfma_f32_16x16x32_bf16 v[100:103], v[32:35], a[68:71], v[100:103]
  ds_read_b128 v[24:27], v4 offset:11264
  s_waitcnt lgkmcnt(5)
  v_mfma_f32_16x16x32_bf16 v[68:71], v[36:39], a[64:67], v[68:71]
  buffer_load_dwordx4 a[16:19], v1, s[12:15], s28 offen offset:2048
  v_sub_u32 v189, v188, v193
  v_mfma_f32_16x16x32_bf16 v[104:107], v[36:39], a[68:71], v[104:107]
  ds_read_b128 v[28:31], v4 offset:12288
  s_waitcnt lgkmcnt(5)
  v_mfma_f32_16x16x32_bf16 v[72:75], v[40:43], a[64:67], v[72:75]
  v_mov_b32 v194, 16
  v_mov_b32 v195, 0
  v_mfma_f32_16x16x32_bf16 v[108:111], v[40:43], a[68:71], v[108:111]
  ds_read_b128 v[32:35], v4 offset:13312
  s_waitcnt lgkmcnt(5)
  v_mfma_f32_16x16x32_bf16 v[76:79], v[12:15], a[64:67], v[76:79]
  buffer_load_dwordx4 v1, s[8:11], s27 offen offset:3072 lds
  v_cndmask_b32 v195, v195, v194, vcc
  v_mfma_f32_16x16x32_bf16 v[112:115], v[12:15], a[68:71], v[112:115]
  ds_read_b128 v[36:39], v4 offset:14336
  s_waitcnt lgkmcnt(5)
  v_mfma_f32_16x16x32_bf16 v[44:47], v[16:19], a[72:75], v[44:47]
  v_and_b32 v191, 15, v189
  v_bfe_u32 v192, v189, 4, 2
  v_mfma_f32_16x16x32_bf16 v[80:83], v[16:19], a[76:79], v[80:83]
  ds_read_b128 v[40:43], v4 offset:15360
  s_waitcnt lgkmcnt(5)
  v_mfma_f32_16x16x32_bf16 v[48:51], v[20:23], a[72:75], v[48:51]
  buffer_load_dwordx4 a[24:27], v1, s[12:15], s28 offen offset:3072
  v_lshlrev_b32 v192, 3, v192
  v_mfma_f32_16x16x32_bf16 v[84:87], v[20:23], a[76:79], v[84:87]
  ds_read_b128 v[12:15], v4 offset:16384
  s_waitcnt lgkmcnt(5)
  v_mfma_f32_16x16x32_bf16 v[52:55], v[24:27], a[72:75], v[52:55]
  v_lshrrev_b32 v193, 6, v189
  v_lshl_add_u32 v192, v193, 5, v192
  v_mfma_f32_16x16x32_bf16 v[88:91], v[24:27], a[76:79], v[88:91]
  ds_read_b128 v[16:19], v4 offset:17408
  s_waitcnt lgkmcnt(5)
  v_mfma_f32_16x16x32_bf16 v[56:59], v[28:31], a[72:75], v[56:59]
  s_add_u32 m0, s23, 4096
  s_add_u32 s27, s34, 4096
  v_mfma_f32_16x16x32_bf16 v[92:95], v[28:31], a[76:79], v[92:95]
  ds_read_b128 v[20:23], v4 offset:18432
  s_waitcnt lgkmcnt(5)
  v_mfma_f32_16x16x32_bf16 v[60:63], v[32:35], a[72:75], v[60:63]
  buffer_load_dwordx4 v1, s[8:11], s27 offen offset:0 lds
  v_subrev_u32 v193, 256, v189
  v_mfma_f32_16x16x32_bf16 v[96:99], v[32:35], a[76:79], v[96:99]
  ds_read_b128 v[24:27], v4 offset:19456
  s_waitcnt lgkmcnt(5)
  v_mfma_f32_16x16x32_bf16 v[64:67], v[36:39], a[72:75], v[64:67]
  s_add_u32 s28, s35, 147456
  buffer_load_dwordx4 a[4:7], v1, s[12:15], s28 offen offset:0
  v_mfma_f32_16x16x32_bf16 v[100:103], v[36:39], a[76:79], v[100:103]
  ds_read_b128 v[28:31], v4 offset:20480
  s_waitcnt lgkmcnt(5)
  v_mfma_f32_16x16x32_bf16 v[68:71], v[40:43], a[72:75], v[68:71]
  v_lshrrev_b32 v194, 1, v193
  v_and_b32 v193, 1, v193
  v_mfma_f32_16x16x32_bf16 v[104:107], v[40:43], a[76:79], v[104:107]
  ds_read_b128 v[32:35], v4 offset:21504
  s_waitcnt lgkmcnt(5)
  v_mfma_f32_16x16x32_bf16 v[72:75], v[12:15], a[72:75], v[72:75]
  buffer_load_dwordx4 v1, s[8:11], s27 offen offset:1024 lds
  v_lshlrev_b32 v193, 3, v193
  v_mfma_f32_16x16x32_bf16 v[108:111], v[12:15], a[76:79], v[108:111]
  ds_read_b128 v[36:39], v4 offset:22528
  s_waitcnt lgkmcnt(5)
  v_mfma_f32_16x16x32_bf16 v[76:79], v[16:19], a[72:75], v[76:79]
  v_add_u32 v193, 128, v193
  v_cmp_gt_u32 vcc, 256, v189
  v_mfma_f32_16x16x32_bf16 v[112:115], v[16:19], a[76:79], v[112:115]
  ds_read_b128 v[40:43], v4 offset:23552
  s_waitcnt lgkmcnt(5)
  v_mfma_f32_16x16x32_bf16 v[44:47], v[20:23], a[80:83], v[44:47]
  buffer_load_dwordx4 a[12:15], v1, s[12:15], s28 offen offset:1024
  v_add_u32 v195, s38, v195
  v_mfma_f32_16x16x32_bf16 v[80:83], v[20:23], a[84:87], v[80:83]
  ds_read_b128 v[12:15], v4 offset:24576
  s_waitcnt lgkmcnt(5)
  v_mfma_f32_16x16x32_bf16 v[48:51], v[24:27], a[80:83], v[48:51]
  v_nop
  v_cndmask_b32 v191, v194, v191, vcc
  v_mfma_f32_16x16x32_bf16 v[84:87], v[24:27], a[84:87], v[84:87]
  ds_read_b128 v[16:19], v4 offset:25600
  s_waitcnt lgkmcnt(5)
  v_mfma_f32_16x16x32_bf16 v[52:55], v[28:31], a[80:83], v[52:55]
  buffer_load_dwordx4 v1, s[8:11], s27 offen offset:2048 lds
  v_cndmask_b32 v192, v193, v192, vcc
  v_mfma_f32_16x16x32_bf16 v[88:91], v[28:31], a[84:87], v[88:91]
  ds_read_b128 v[20:23], v4 offset:26624
  s_waitcnt lgkmcnt(5)
  v_mfma_f32_16x16x32_bf16 v[56:59], v[32:35], a[80:83], v[56:59]
  v_add_u32 v191, v191, v195
  v_add_u32 v192, s39, v192
  v_mfma_f32_16x16x32_bf16 v[92:95], v[32:35], a[84:87], v[92:95]
  ds_read_b128 v[24:27], v4 offset:27648
  s_waitcnt lgkmcnt(5)
  v_mfma_f32_16x16x32_bf16 v[60:63], v[36:39], a[80:83], v[60:63]
  buffer_load_dwordx4 a[20:23], v1, s[12:15], s28 offen offset:2048
  v_lshlrev_b32 v157, 1, v192
  v_mfma_f32_16x16x32_bf16 v[96:99], v[36:39], a[84:87], v[96:99]
  ds_read_b128 v[28:31], v4 offset:28672
  s_waitcnt lgkmcnt(5)
  v_mfma_f32_16x16x32_bf16 v[64:67], v[40:43], a[80:83], v[64:67]
  v_mul_u32_u24 v154, 1152, v191
  v_add_u32 v154, v154, v157
  v_mfma_f32_16x16x32_bf16 v[100:103], v[40:43], a[84:87], v[100:103]
  ds_read_b128 v[32:35], v4 offset:29696
  s_waitcnt lgkmcnt(5)
  v_mfma_f32_16x16x32_bf16 v[68:71], v[12:15], a[80:83], v[68:71]
  buffer_load_dwordx4 v1, s[8:11], s27 offen offset:3072 lds
  v_lshlrev_b32 v160, 4, v188
  v_mfma_f32_16x16x32_bf16 v[104:107], v[12:15], a[84:87], v[104:107]
  ds_read_b128 v[36:39], v4 offset:30720
  s_waitcnt lgkmcnt(5)
  v_mfma_f32_16x16x32_bf16 v[72:75], v[16:19], a[80:83], v[72:75]
  v_add_u32 v160, s42, v160
  v_cmp_gt_u32 vcc, 64, v0
  v_mfma_f32_16x16x32_bf16 v[108:111], v[16:19], a[84:87], v[108:111]
  ds_read_b128 v[40:43], v4 offset:31744
  s_waitcnt lgkmcnt(5)
  v_mfma_f32_16x16x32_bf16 v[76:79], v[20:23], a[80:83], v[76:79]
  buffer_load_dwordx4 a[28:31], v1, s[12:15], s28 offen offset:3072
  v_mov_b32 v193, 0x40000000
  v_mfma_f32_16x16x32_bf16 v[112:115], v[20:23], a[84:87], v[112:115]
  ds_read_b128 v[12:15], v4 offset:32768
  s_waitcnt lgkmcnt(5)
  v_mfma_f32_16x16x32_bf16 v[44:47], v[24:27], a[88:91], v[44:47]
  v_mov_b32 v194, 0
  v_cndmask_b32 v193, v193, v194, vcc
  v_mfma_f32_16x16x32_bf16 v[80:83], v[24:27], a[92:95], v[80:83]
  ds_read_b128 v[16:19], v4 offset:33792
  s_waitcnt lgkmcnt(5)
  v_mfma_f32_16x16x32_bf16 v[48:51], v[28:31], a[88:91], v[48:51]
  s_add_u32 m0, s23, 8192
  s_add_u32 s27, s34, 8192
  v_mfma_f32_16x16x32_bf16 v[84:87], v[28:31], a[92:95], v[84:87]
  ds_read_b128 v[20:23], v4 offset:34816
  s_waitcnt lgkmcnt(5)
  v_mfma_f32_16x16x32_bf16 v[52:55], v[32:35], a[88:91], v[52:55]
  buffer_load_dwordx4 v1, s[8:11], s27 offen offset:0 lds
  v_add_u32 v154, v154, v193
  v_mfma_f32_16x16x32_bf16 v[88:91], v[32:35], a[92:95], v[88:91]
  ds_read_b128 v[24:27], v4 offset:35840
  s_waitcnt lgkmcnt(5)
  v_mfma_f32_16x16x32_bf16 v[56:59], v[36:39], a[88:91], v[56:59]
  v_add_u32 v157, v157, v193
  v_add_u32 v160, v160, v193
  v_mfma_f32_16x16x32_bf16 v[92:95], v[36:39], a[92:95], v[92:95]
  s_waitcnt vmcnt(17)
  s_barrier
  ds_read_b128 v[28:31], v5 offset:0
  s_waitcnt lgkmcnt(5)
  v_mfma_f32_16x16x32_bf16 v[60:63], v[40:43], a[88:91], v[60:63]
  s_mul_i32 s34, s33, 36864
  s_add_u32 s34, s34, s24
  v_mfma_f32_16x16x32_bf16 v[96:99], v[40:43], a[92:95], v[96:99]
  ds_read_b128 v[32:35], v5 offset:1024
  s_waitcnt lgkmcnt(5)
  v_mfma_f32_16x16x32_bf16 v[64:67], v[12:15], a[88:91], v[64:67]
  s_lshl_b32 s35, s33, 12
  s_add_u32 s35, s35, s25
  v_mfma_f32_16x16x32_bf16 v[100:103], v[12:15], a[92:95], v[100:103]
  ds_read_b128 v[36:39], v5 offset:2048
  s_waitcnt lgkmcnt(5)
  v_mfma_f32_16x16x32_bf16 v[68:71], v[16:19], a[88:91], v[68:71]
  s_add_u32 s33, s33, 1
  v_mfma_f32_16x16x32_bf16 v[104:107], v[16:19], a[92:95], v[104:107]
  ds_read_b128 v[40:43], v5 offset:3072
  s_waitcnt lgkmcnt(5)
  v_mfma_f32_16x16x32_bf16 v[72:75], v[20:23], a[88:91], v[72:75]
  s_cmp_eq_u32 s33, 9
  s_cselect_b32 s33, 0, s33
  v_mfma_f32_16x16x32_bf16 v[108:111], v[20:23], a[92:95], v[108:111]
  ds_read_b128 v[12:15], v5 offset:4096
  s_waitcnt lgkmcnt(5)
  v_mfma_f32_16x16x32_bf16 v[76:79], v[24:27], a[88:91], v[76:79]
  s_add_u32 m0, s23, 36864
  s_add_u32 s27, s34, 0
  v_mfma_f32_16x16x32_bf16 v[112:115], v[24:27], a[92:95], v[112:115]
  ds_read_b128 v[16:19], v5 offset:5120
  s_waitcnt lgkmcnt(5)
  v_mfma_f32_16x16x32_bf16 v[44:47], v[28:31], a[96:99], v[44:47]
  buffer_load_dwordx4 v1, s[8:11], s27 offen offset:0 lds
  s_add_u32 s28, s35, 0
  v_mfma_f32_16x16x32_bf16 v[80:83], v[28:31], a[100:103], v[80:83]
  ds_read_b128 v[20:23], v5 offset:6144
  s_waitcnt lgkmcnt(5)
  v_mfma_f32_16x16x32_bf16 v[48:51], v[32:35], a[96:99], v[48:51]
  buffer_load_dwordx4 a[32:35], v1, s[12:15], s28 offen offset:0
  buffer_load_dwordx4 v1, s[8:11], s27 offen offset:1024 lds
  v_mfma_f32_16x16x32_bf16 v[84:87], v[32:35], a[100:103], v[84:87]
  ds_read_b128 v[24:27], v5 offset:7168
  s_waitcnt lgkmcnt(5)
  v_mfma_f32_16x16x32_bf16 v[52:55], v[36:39], a[96:99], v[52:55]
  buffer_load_dwordx4 a[40:43], v1, s[12:15], s28 offen offset:1024
  v_mfma_f32_16x16x32_bf16 v[88:91], v[36:39], a[100:103], v[88:91]
  ds_read_b128 v[28:31], v5 offset:8192
  s_waitcnt lgkmcnt(5)
  v_mfma_f32_16x16x32_bf16 v[56:59], v[40:43], a[96:99], v[56:59]
  buffer_load_dwordx4 v1, s[8:11], s27 offen offset:2048 lds
  v_mfma_f32_16x16x32_bf16 v[92:95], v[40:43], a[100:103], v[92:95]
  ds_read_b128 v[32:35], v5 offset:9216
  s_waitcnt lgkmcnt(5)
  v_mfma_f32_16x16x32_bf16 v[60:63], v[12:15], a[96:99], v[60:63]
  s_add_u32 s44, s4, 7258112
  s_addc_u32 s45, s5, 0
  v_mfma_f32_16x16x32_bf16 v[96:99], v[12:15], a[100:103], v[96:99]
  ds_read_b128 v[36:39], v5 offset:10240
  s_waitcnt lgkmcnt(5)
  v_mfma_f32_16x16x32_bf16 v[64:67], v[16:19], a[96:99], v[64:67]
  buffer_load_dwordx4 a[48:51], v1, s[12:15], s28 offen offset:2048
  s_mov_b32 s46, 2359296
  v_mfma_f32_16x16x32_bf16 v[100:103], v[16:19], a[100:103], v[100:103]
  ds_read_b128 v[40:43], v5 offset:11264
  s_waitcnt lgkmcnt(5)
  v_mfma_f32_16x16x32_bf16 v[68:71], v[20:23], a[96:99], v[68:71]
  s_mov_b32 s47, 0x20000
  v_mfma_f32_16x16x32_bf16 v[104:107], v[20:23], a[100:103], v[104:107]
  ds_read_b128 v[12:15], v5 offset:12288
  s_waitcnt lgkmcnt(5)
  v_mfma_f32_16x16x32_bf16 v[72:75], v[24:27], a[96:99], v[72:75]
  buffer_load_dwordx4 v1, s[8:11], s27 offen offset:3072 lds
  v_mfma_f32_16x16x32_bf16 v[108:111], v[24:27], a[100:103], v[108:111]
  ds_read_b128 v[16:19], v5 offset:13312
  s_waitcnt lgkmcnt(5)
  v_mfma_f32_16x16x32_bf16 v[76:79], v[28:31], a[96:99], v[76:79]
  s_add_u32 s48, s4, 0
  s_addc_u32 s49, s5, 0
  v_mfma_f32_16x16x32_bf16 v[112:115], v[28:31], a[100:103], v[112:115]
  ds_read_b128 v[20:23], v5 offset:14336
  s_waitcnt lgkmcnt(5)
  v_mfma_f32_16x16x32_bf16 v[44:47], v[32:35], a[104:107], v[44:47]
  buffer_load_dwordx4 a[56:59], v1, s[12:15], s28 offen offset:3072
  s_mov_b32 s50, 6912
  v_mfma_f32_16x16x32_bf16 v[80:83], v[32:35], a[108:111], v[80:83]
  ds_read_b128 v[24:27], v5 offset:15360
  s_waitcnt lgkmcnt(5)
  v_mfma_f32_16x16x32_bf16 v[48:51], v[36:39], a[104:107], v[48:51]
  s_mov_b32 s51, 0x20000
  s_mov_b32 s52, s36
  v_mfma_f32_16x16x32_bf16 v[84:87], v[36:39], a[108:111], v[84:87]
  ds_read_b128 v[28:31], v5 offset:16384
  s_waitcnt lgkmcnt(5)
  v_mfma_f32_16x16x32_bf16 v[52:55], v[40:43], a[104:107], v[52:55]
  s_add_u32 m0, s23, 40960
  s_add_u32 s27, s34, 4096
  v_mfma_f32_16x16x32_bf16 v[88:91], v[40:43], a[108:111], v[88:91]
  ds_read_b128 v[32:35], v5 offset:17408
  s_waitcnt lgkmcnt(5)
  v_mfma_f32_16x16x32_bf16 v[56:59], v[12:15], a[104:107], v[56:59]
  buffer_load_dwordx4 v1, s[8:11], s27 offen offset:0 lds
  s_mov_b32 s53, s37
  v_mfma_f32_16x16x32_bf16 v[92:95], v[12:15], a[108:111], v[92:95]
  ds_read_b128 v[36:39], v5 offset:18432
  s_waitcnt lgkmcnt(5)
  v_mfma_f32_16x16x32_bf16 v[60:63], v[16:19], a[104:107], v[60:63]
  s_add_u32 s28, s35, 147456
  buffer_load_dwordx4 a[36:39], v1, s[12:15], s28 offen offset:0
  v_mfma_f32_16x16x32_bf16 v[96:99], v[16:19], a[108:111], v[96:99]
  ds_read_b128 v[40:43], v5 offset:19456
  s_waitcnt lgkmcnt(5)
  v_mfma_f32_16x16x32_bf16 v[64:67], v[20:23], a[104:107], v[64:67]
  s_mov_b32 s54, 2359296
  s_mov_b32 s55, 0x20000
  v_mfma_f32_16x16x32_bf16 v[100:103], v[20:23], a[108:111], v[100:103]
  ds_read_b128 v[12:15], v5 offset:20480
  s_waitcnt lgkmcnt(5)
  v_mfma_f32_16x16x32_bf16 v[68:71], v[24:27], a[104:107], v[68:71]
  buffer_load_dwordx4 v1, s[8:11], s27 offen offset:1024 lds
  v_mfma_f32_16x16x32_bf16 v[104:107], v[24:27], a[108:111], v[104:107]
  ds_read_b128 v[16:19], v5 offset:21504
  s_waitcnt lgkmcnt(5)
  v_mfma_f32_16x16x32_bf16 v[72:75], v[28:31], a[104:107], v[72:75]
  s_add_u32 s56, s4, 69632
  s_addc_u32 s57, s5, 0
  v_mfma_f32_16x16x32_bf16 v[108:111], v[28:31], a[108:111], v[108:111]
  ds_read_b128 v[20:23], v5 offset:22528
  s_waitcnt lgkmcnt(5)
  v_mfma_f32_16x16x32_bf16 v[76:79], v[32:35], a[104:107], v[76:79]
  buffer_load_dwordx4 a[44:47], v1, s[12:15], s28 offen offset:1024
  s_mov_b32 s58, 32768
  v_mfma_f32_16x16x32_bf16 v[112:115], v[32:35], a[108:111], v[112:115]
  ds_read_b128 v[24:27], v5 offset:23552
  s_waitcnt lgkmcnt(5)
  v_mfma_f32_16x16x32_bf16 v[44:47], v[36:39], a[112:115], v[44:47]
  s_mov_b32 s59, 0x20000
  s_mov_b32 s43, 5760
  v_mfma_f32_16x16x32_bf16 v[80:83], v[36:39], a[116:119], v[80:83]
  ds_read_b128 v[28:31], v5 offset:24576
  s_waitcnt lgkmcnt(5)
  v_mfma_f32_16x16x32_bf16 v[48:51], v[40:43], a[112:115], v[48:51]
  buffer_load_dwordx4 v1, s[8:11], s27 offen offset:2048 lds
  v_mfma_f32_16x16x32_bf16 v[84:87], v[40:43], a[116:119], v[84:87]
  ds_read_b128 v[32:35], v5 offset:25600
  s_waitcnt lgkmcnt(5)
  v_mfma_f32_16x16x32_bf16 v[52:55], v[12:15], a[112:115], v[52:55]
  v_mfma_f32_16x16x32_bf16 v[88:91], v[12:15], a[116:119], v[88:91]
  ds_read_b128 v[36:39], v5 offset:26624
  s_waitcnt lgkmcnt(5)
  v_mfma_f32_16x16x32_bf16 v[56:59], v[16:19], a[112:115], v[56:59]
  buffer_load_dwordx4 a[52:55], v1, s[12:15], s28 offen offset:2048
  v_mfma_f32_16x16x32_bf16 v[92:95], v[16:19], a[116:119], v[92:95]
  ds_read_b128 v[40:43], v5 offset:27648
  s_waitcnt lgkmcnt(5)
  v_mfma_f32_16x16x32_bf16 v[60:63], v[20:23], a[112:115], v[60:63]
  v_mfma_f32_16x16x32_bf16 v[96:99], v[20:23], a[116:119], v[96:99]
  ds_read_b128 v[12:15], v5 offset:28672
  s_waitcnt lgkmcnt(5)
  v_mfma_f32_16x16x32_bf16 v[64:67], v[24:27], a[112:115], v[64:67]
  buffer_load_dwordx4 v1, s[8:11], s27 offen offset:3072 lds
  v_mfma_f32_16x16x32_bf16 v[100:103], v[24:27], a[116:119], v[100:103]
  ds_read_b128 v[16:19], v5 offset:29696
  s_waitcnt lgkmcnt(5)
  v_mfma_f32_16x16x32_bf16 v[68:71], v[28:31], a[112:115], v[68:71]
  v_mfma_f32_16x16x32_bf16 v[104:107], v[28:31], a[116:119], v[104:107]
  ds_read_b128 v[20:23], v5 offset:30720
  s_waitcnt lgkmcnt(5)
  v_mfma_f32_16x16x32_bf16 v[72:75], v[32:35], a[112:115], v[72:75]
  buffer_load_dwordx4 a[60:63], v1, s[12:15], s28 offen offset:3072
  v_mfma_f32_16x16x32_bf16 v[108:111], v[32:35], a[116:119], v[108:111]
  ds_read_b128 v[24:27], v5 offset:31744
  s_waitcnt lgkmcnt(5)
  v_mfma_f32_16x16x32_bf16 v[76:79], v[36:39], a[112:115], v[76:79]
  v_mfma_f32_16x16x32_bf16 v[112:115], v[36:39], a[116:119], v[112:115]
  ds_read_b128 v[28:31], v5 offset:32768
  s_waitcnt lgkmcnt(5)
  v_mfma_f32_16x16x32_bf16 v[44:47], v[40:43], a[120:123], v[44:47]
  s_add_u32 m0, s23, 45056
  s_add_u32 s27, s34, 8192
  v_mfma_f32_16x16x32_bf16 v[80:83], v[40:43], a[124:127], v[80:83]
  ds_read_b128 v[32:35], v5 offset:33792
  s_waitcnt lgkmcnt(5)
  v_mfma_f32_16x16x32_bf16 v[48:51], v[12:15], a[120:123], v[48:51]
  buffer_load_dwordx4 v1, s[8:11], s27 offen offset:0 lds
  v_mfma_f32_16x16x32_bf16 v[84:87], v[12:15], a[124:127], v[84:87]
  ds_read_b128 v[36:39], v5 offset:34816
  s_waitcnt lgkmcnt(5)
  v_mfma_f32_16x16x32_bf16 v[52:55], v[16:19], a[120:123], v[52:55]
  v_mfma_f32_16x16x32_bf16 v[88:91], v[16:19], a[124:127], v[88:91]
  ds_read_b128 v[40:43], v5 offset:35840
  s_waitcnt lgkmcnt(5)
  v_mfma_f32_16x16x32_bf16 v[56:59], v[20:23], a[120:123], v[56:59]
  v_mfma_f32_16x16x32_bf16 v[92:95], v[20:23], a[124:127], v[92:95]
  s_waitcnt vmcnt(17)
  s_barrier
  ds_read_b128 v[12:15], v2 offset:0
  s_waitcnt lgkmcnt(5)
  v_mfma_f32_16x16x32_bf16 v[60:63], v[24:27], a[120:123], v[60:63]
  s_mul_i32 s34, s33, 36864
  s_add_u32 s34, s34, s24
  v_mfma_f32_16x16x32_bf16 v[96:99], v[24:27], a[124:127], v[96:99]
  ds_read_b128 v[16:19], v2 offset:1024
  s_waitcnt lgkmcnt(5)
  v_mfma_f32_16x16x32_bf16 v[64:67], v[28:31], a[120:123], v[64:67]
  s_lshl_b32 s35, s33, 12
  s_add_u32 s35, s35, s25
  v_mfma_f32_16x16x32_bf16 v[100:103], v[28:31], a[124:127], v[100:103]
  ds_read_b128 v[20:23], v2 offset:2048
  s_waitcnt lgkmcnt(5)
  v_mfma_f32_16x16x32_bf16 v[68:71], v[32:35], a[120:123], v[68:71]
  s_add_u32 s33, s33, 1
  v_mfma_f32_16x16x32_bf16 v[104:107], v[32:35], a[124:127], v[104:107]
  ds_read_b128 v[24:27], v2 offset:3072
  s_waitcnt lgkmcnt(5)
  v_mfma_f32_16x16x32_bf16 v[72:75], v[36:39], a[120:123], v[72:75]
  s_cmp_eq_u32 s33, 9
  s_cselect_b32 s33, 0, s33
  v_mfma_f32_16x16x32_bf16 v[108:111], v[36:39], a[124:127], v[108:111]
  ds_read_b128 v[28:31], v2 offset:4096
  s_waitcnt lgkmcnt(5)
  v_mfma_f32_16x16x32_bf16 v[76:79], v[40:43], a[120:123], v[76:79]
  s_add_u32 m0, s23, 73728
  s_add_u32 s27, s34, 0
  v_mfma_f32_16x16x32_bf16 v[112:115], v[40:43], a[124:127], v[112:115]
  ds_read_b128 v[32:35], v2 offset:5120
  s_waitcnt lgkmcnt(5)
  v_mfma_f32_16x16x32_bf16 v[44:47], v[12:15], a[0:3], v[44:47]
  buffer_load_dwordx4 v1, s[8:11], s27 offen offset:0 lds
  s_add_u32 s28, s35, 0
  v_mfma_f32_16x16x32_bf16 v[80:83], v[12:15], a[4:7], v[80:83]
  ds_read_b128 v[36:39], v2 offset:6144
  s_waitcnt lgkmcnt(5)
  v_mfma_f32_16x16x32_bf16 v[48:51], v[16:19], a[0:3], v[48:51]
  buffer_load_dwordx4 a[64:67], v1, s[12:15], s28 offen offset:0
  buffer_load_dwordx4 v1, s[8:11], s27 offen offset:1024 lds
  v_mfma_f32_16x16x32_bf16 v[84:87], v[16:19], a[4:7], v[84:87]
  ds_read_b128 v[40:43], v2 offset:7168
  s_waitcnt lgkmcnt(5)
  v_mfma_f32_16x16x32_bf16 v[52:55], v[20:23], a[0:3], v[52:55]
  buffer_load_dwordx4 a[72:75], v1, s[12:15], s28 offen offset:1024
  v_mfma_f32_16x16x32_bf16 v[88:91], v[20:23], a[4:7], v[88:91]
  ds_read_b128 v[12:15], v2 offset:8192
  s_waitcnt lgkmcnt(5)
  v_mfma_f32_16x16x32_bf16 v[56:59], v[24:27], a[0:3], v[56:59]
  buffer_load_dwordx4 v1, s[8:11], s27 offen offset:2048 lds
  v_mfma_f32_16x16x32_bf16 v[92:95], v[24:27], a[4:7], v[92:95]
  ds_read_b128 v[16:19], v2 offset:9216
  s_waitcnt lgkmcnt(5)
  v_mfma_f32_16x16x32_bf16 v[60:63], v[28:31], a[0:3], v[60:63]
  v_mfma_f32_16x16x32_bf16 v[96:99], v[28:31], a[4:7], v[96:99]
  ds_read_b128 v[20:23], v2 offset:10240
  s_waitcnt lgkmcnt(5)
  v_mfma_f32_16x16x32_bf16 v[64:67], v[32:35], a[0:3], v[64:67]
  buffer_load_dwordx4 a[80:83], v1, s[12:15], s28 offen offset:2048
  v_mfma_f32_16x16x32_bf16 v[100:103], v[32:35], a[4:7], v[100:103]
  ds_read_b128 v[24:27], v2 offset:11264
  s_waitcnt lgkmcnt(5)
  v_mfma_f32_16x16x32_bf16 v[68:71], v[36:39], a[0:3], v[68:71]
  v_mfma_f32_16x16x32_bf16 v[104:107], v[36:39], a[4:7], v[104:107]
  ds_read_b128 v[28:31], v2 offset:12288
  s_waitcnt lgkmcnt(5)
  v_mfma_f32_16x16x32_bf16 v[72:75], v[40:43], a[0:3], v[72:75]
  buffer_load_dwordx4 v1, s[8:11], s27 offen offset:3072 lds
  v_mfma_f32_16x16x32_bf16 v[108:111], v[40:43], a[4:7], v[108:111]
  ds_read_b128 v[32:35], v2 offset:13312
  s_waitcnt lgkmcnt(5)
  v_mfma_f32_16x16x32_bf16 v[76:79], v[12:15], a[0:3], v[76:79]
  v_mfma_f32_16x16x32_bf16 v[112:115], v[12:15], a[4:7], v[112:115]
  ds_read_b128 v[36:39], v2 offset:14336
  s_waitcnt lgkmcnt(5)
  v_mfma_f32_16x16x32_bf16 v[44:47], v[16:19], a[8:11], v[44:47]
  buffer_load_dwordx4 a[88:91], v1, s[12:15], s28 offen offset:3072
  v_mfma_f32_16x16x32_bf16 v[80:83], v[16:19], a[12:15], v[80:83]
  ds_read_b128 v[40:43], v2 offset:15360
  s_waitcnt lgkmcnt(5)
  v_mfma_f32_16x16x32_bf16 v[48:51], v[20:23], a[8:11], v[48:51]
  v_mfma_f32_16x16x32_bf16 v[84:87], v[20:23], a[12:15], v[84:87]
  ds_read_b128 v[12:15], v2 offset:16384
  s_waitcnt lgkmcnt(5)
  v_mfma_f32_16x16x32_bf16 v[52:55], v[24:27], a[8:11], v[52:55]
  s_add_u32 m0, s23, 77824
  s_add_u32 s27, s34, 4096
  v_mfma_f32_16x16x32_bf16 v[88:91], v[24:27], a[12:15], v[88:91]
  ds_read_b128 v[16:19], v2 offset:17408
  s_waitcnt lgkmcnt(5)
  v_mfma_f32_16x16x32_bf16 v[56:59], v[28:31], a[8:11], v[56:59]
  buffer_load_dwordx4 v1, s[8:11], s27 offen offset:0 lds
  v_mfma_f32_16x16x32_bf16 v[92:95], v[28:31], a[12:15], v[92:95]
  ds_read_b128 v[20:23], v2 offset:18432
  s_waitcnt lgkmcnt(5)
  v_mfma_f32_16x16x32_bf16 v[60:63], v[32:35], a[8:11], v[60:63]
  s_add_u32 s28, s35, 147456
  buffer_load_dwordx4 a[68:71], v1, s[12:15], s28 offen offset:0
  v_mfma_f32_16x16x32_bf16 v[96:99], v[32:35], a[12:15], v[96:99]
  ds_read_b128 v[24:27], v2 offset:19456
  s_waitcnt lgkmcnt(5)
  v_mfma_f32_16x16x32_bf16 v[64:67], v[36:39], a[8:11], v[64:67]
  v_mfma_f32_16x16x32_bf16 v[100:103], v[36:39], a[12:15], v[100:103]
  ds_read_b128 v[28:31], v2 offset:20480
  s_waitcnt lgkmcnt(5)
  v_mfma_f32_16x16x32_bf16 v[68:71], v[40:43], a[8:11], v[68:71]
  buffer_load_dwordx4 v1, s[8:11], s27 offen offset:1024 lds
  v_mfma_f32_16x16x32_bf16 v[104:107], v[40:43], a[12:15], v[104:107]
  ds_read_b128 v[32:35], v2 offset:21504
  s_waitcnt lgkmcnt(5)
  v_mfma_f32_16x16x32_bf16 v[72:75], v[12:15], a[8:11], v[72:75]
  v_mfma_f32_16x16x32_bf16 v[108:111], v[12:15], a[12:15], v[108:111]
  ds_read_b128 v[36:39], v2 offset:22528
  s_waitcnt lgkmcnt(5)
  v_mfma_f32_16x16x32_bf16 v[76:79], v[16:19], a[8:11], v[76:79]
  buffer_load_dwordx4 a[76:79], v1, s[12:15], s28 offen offset:1024
  v_mfma_f32_16x16x32_bf16 v[112:115], v[16:19], a[12:15], v[112:115]
  ds_read_b128 v[40:43], v2 offset:23552
  s_waitcnt lgkmcnt(5)
  v_mfma_f32_16x16x32_bf16 v[44:47], v[20:23], a[16:19], v[44:47]
  v_mfma_f32_16x16x32_bf16 v[80:83], v[20:23], a[20:23], v[80:83]
  ds_read_b128 v[12:15], v2 offset:24576
  s_waitcnt lgkmcnt(5)
  v_mfma_f32_16x16x32_bf16 v[48:51], v[24:27], a[16:19], v[48:51]
  buffer_load_dwordx4 v1, s[8:11], s27 offen offset:2048 lds
  v_mfma_f32_16x16x32_bf16 v[84:87], v[24:27], a[20:23], v[84:87]
  ds_read_b128 v[16:19], v2 offset:25600
  s_waitcnt lgkmcnt(5)
  v_mfma_f32_16x16x32_bf16 v[52:55], v[28:31], a[16:19], v[52:55]
  v_mfma_f32_16x16x32_bf16 v[88:91], v[28:31], a[20:23], v[88:91]
  ds_read_b128 v[20:23], v2 offset:26624
  s_waitcnt lgkmcnt(5)
  v_mfma_f32_16x16x32_bf16 v[56:59], v[32:35], a[16:19], v[56:59]
  buffer_load_dwordx4 a[84:87], v1, s[12:15], s28 offen offset:2048
  v_mfma_f32_16x16x32_bf16 v[92:95], v[32:35], a[20:23], v[92:95]
  ds_read_b128 v[24:27], v2 offset:27648
  s_waitcnt lgkmcnt(5)
  v_mfma_f32_16x16x32_bf16 v[60:63], v[36:39], a[16:19], v[60:63]
  v_mfma_f32_16x16x32_bf16 v[96:99], v[36:39], a[20:23], v[96:99]
  ds_read_b128 v[28:31], v2 offset:28672
  s_waitcnt lgkmcnt(5)
  v_mfma_f32_16x16x32_bf16 v[64:67], v[40:43], a[16:19], v[64:67]
  buffer_load_dwordx4 v1, s[8:11], s27 offen offset:3072 lds
  v_mfma_f32_16x16x32_bf16 v[100:103], v[40:43], a[20:23], v[100:103]
  ds_read_b128 v[32:35], v2 offset:29696
  s_waitcnt lgkmcnt(5)
  v_mfma_f32_16x16x32_bf16 v[68:71], v[12:15], a[16:19], v[68:71]
  v_mfma_f32_16x16x32_bf16 v[104:107], v[12:15], a[20:23], v[104:107]
  ds_read_b128 v[36:39], v2 offset:30720
  s_waitcnt lgkmcnt(5)
  v_mfma_f32_16x16x32_bf16 v[72:75], v[16:19], a[16:19], v[72:75]
  buffer_load_dwordx4 a[92:95], v1, s[12:15], s28 offen offset:3072
  v_mfma_f32_16x16x32_bf16 v[108:111], v[16:19], a[20:23], v[108:111]
  ds_read_b128 v[40:43], v2 offset:31744
  s_waitcnt lgkmcnt(5)
  v_mfma_f32_16x16x32_bf16 v[76:79], v[20:23], a[16:19], v[76:79]
  v_mfma_f32_16x16x32_bf16 v[112:115], v[20:23], a[20:23], v[112:115]
  ds_read_b128 v[12:15], v2 offset:32768
  s_waitcnt lgkmcnt(5)
  v_mfma_f32_16x16x32_bf16 v[44:47], v[24:27], a[24:27], v[44:47]
  s_add_u32 m0, s23, 81920
  s_add_u32 s27, s34, 8192
  v_mfma_f32_16x16x32_bf16 v[80:83], v[24:27], a[28:31], v[80:83]
  ds_read_b128 v[16:19], v2 offset:33792
  s_waitcnt lgkmcnt(5)
  v_mfma_f32_16x16x32_bf16 v[48:51], v[28:31], a[24:27], v[48:51]
  buffer_load_dwordx4 v1, s[8:11], s27 offen offset:0 lds
  v_mfma_f32_16x16x32_bf16 v[84:87], v[28:31], a[28:31], v[84:87]
  ds_read_b128 v[20:23], v2 offset:34816
  s_waitcnt lgkmcnt(5)
  v_mfma_f32_16x16x32_bf16 v[52:55], v[32:35], a[24:27], v[52:55]
  v_mfma_f32_16x16x32_bf16 v[88:91], v[32:35], a[28:31], v[88:91]
  ds_read_b128 v[24:27], v2 offset:35840
  s_waitcnt lgkmcnt(5)
  v_mfma_f32_16x16x32_bf16 v[56:59], v[36:39], a[24:27], v[56:59]
  v_mfma_f32_16x16x32_bf16 v[92:95], v[36:39], a[28:31], v[92:95]
  s_waitcnt vmcnt(17)
  s_barrier
  ds_read_b128 v[28:31], v3 offset:0
  s_waitcnt lgkmcnt(5)
  v_mfma_f32_16x16x32_bf16 v[60:63], v[40:43], a[24:27], v[60:63]
  s_mul_i32 s34, s33, 36864
  s_add_u32 s34, s34, s24
  v_mfma_f32_16x16x32_bf16 v[96:99], v[40:43], a[28:31], v[96:99]
  ds_read_b128 v[32:35], v3 offset:1024
  s_waitcnt lgkmcnt(5)
  v_mfma_f32_16x16x32_bf16 v[64:67], v[12:15], a[24:27], v[64:67]
  s_lshl_b32 s35, s33, 12
  s_add_u32 s35, s35, s25
  v_mfma_f32_16x16x32_bf16 v[100:103], v[12:15], a[28:31], v[100:103]
  ds_read_b128 v[36:39], v3 offset:2048
  s_waitcnt lgkmcnt(5)
  v_mfma_f32_16x16x32_bf16 v[68:71], v[16:19], a[24:27], v[68:71]
  s_add_u32 s33, s33, 1
  v_mfma_f32_16x16x32_bf16 v[104:107], v[16:19], a[28:31], v[104:107]
  ds_read_b128 v[40:43], v3 offset:3072
  s_waitcnt lgkmcnt(5)
  v_mfma_f32_16x16x32_bf16 v[72:75], v[20:23], a[24:27], v[72:75]
  s_cmp_eq_u32 s33, 9
  s_cselect_b32 s33, 0, s33
  v_mfma_f32_16x16x32_bf16 v[108:111], v[20:23], a[28:31], v[108:111]
  ds_read_b128 v[12:15], v3 offset:4096
  s_waitcnt lgkmcnt(5)
  v_mfma_f32_16x16x32_bf16 v[76:79], v[24:27], a[24:27], v[76:79]
  s_add_u32 m0, s23, 110592
  s_add_u32 s27, s34, 0
  v_mfma_f32_16x16x32_bf16 v[112:115], v[24:27], a[28:31], v[112:115]
  ds_read_b128 v[16:19], v3 offset:5120
  s_waitcnt lgkmcnt(5)
  v_mfma_f32_16x16x32_bf16 v[44:47], v[28:31], a[32:35], v[44:47]
  buffer_load_dwordx4 v1, s[8:11], s27 offen offset:0 lds
  s_add_u32 s28, s35, 0
  v_mfma_f32_16x16x32_bf16 v[80:83], v[28:31], a[36:39], v[80:83]
  ds_read_b128 v[20:23], v3 offset:6144
  s_waitcnt lgkmcnt(5)
  v_mfma_f32_16x16x32_bf16 v[48:51], v[32:35], a[32:35], v[48:51]
  buffer_load_dwordx4 a[96:99], v1, s[12:15], s28 offen offset:0
  buffer_load_dwordx4 v1, s[8:11], s27 offen offset:1024 lds
  v_mfma_f32_16x16x32_bf16 v[84:87], v[32:35], a[36:39], v[84:87]
  ds_read_b128 v[24:27], v3 offset:7168
  s_waitcnt lgkmcnt(5)
  v_mfma_f32_16x16x32_bf16 v[52:55], v[36:39], a[32:35], v[52:55]
  buffer_load_dwordx4 a[104:107], v1, s[12:15], s28 offen offset:1024
  v_mfma_f32_16x16x32_bf16 v[88:91], v[36:39], a[36:39], v[88:91]
  ds_read_b128 v[28:31], v3 offset:8192
  s_waitcnt lgkmcnt(5)
  v_mfma_f32_16x16x32_bf16 v[56:59], v[40:43], a[32:35], v[56:59]
  buffer_load_dwordx4 v1, s[8:11], s27 offen offset:2048 lds
  v_mfma_f32_16x16x32_bf16 v[92:95], v[40:43], a[36:39], v[92:95]
  ds_read_b128 v[32:35], v3 offset:9216
  s_waitcnt lgkmcnt(5)
  v_mfma_f32_16x16x32_bf16 v[60:63], v[12:15], a[32:35], v[60:63]
  v_mfma_f32_16x16x32_bf16 v[96:99], v[12:15], a[36:39], v[96:99]
  ds_read_b128 v[36:39], v3 offset:10240
  s_waitcnt lgkmcnt(5)
  v_mfma_f32_16x16x32_bf16 v[64:67], v[16:19], a[32:35], v[64:67]
  buffer_load_dwordx4 a[112:115], v1, s[12:15], s28 offen offset:2048
  v_mfma_f32_16x16x32_bf16 v[100:103], v[16:19], a[36:39], v[100:103]
  ds_read_b128 v[40:43], v3 offset:11264
  s_waitcnt lgkmcnt(5)
  v_mfma_f32_16x16x32_bf16 v[68:71], v[20:23], a[32:35], v[68:71]
  v_mfma_f32_16x16x32_bf16 v[104:107], v[20:23], a[36:39], v[104:107]
  ds_read_b128 v[12:15], v3 offset:12288
  s_waitcnt lgkmcnt(5)
  v_mfma_f32_16x16x32_bf16 v[72:75], v[24:27], a[32:35], v[72:75]
  buffer_load_dwordx4 v1, s[8:11], s27 offen offset:3072 lds
  v_mfma_f32_16x16x32_bf16 v[108:111], v[24:27], a[36:39], v[108:111]
  ds_read_b128 v[16:19], v3 offset:13312
  s_waitcnt lgkmcnt(5)
  v_mfma_f32_16x16x32_bf16 v[76:79], v[28:31], a[32:35], v[76:79]
  v_mfma_f32_16x16x32_bf16 v[112:115], v[28:31], a[36:39], v[112:115]
  ds_read_b128 v[20:23], v3 offset:14336
  s_waitcnt lgkmcnt(5)
  v_mfma_f32_16x16x32_bf16 v[44:47], v[32:35], a[40:43], v[44:47]
  buffer_load_dwordx4 a[120:123], v1, s[12:15], s28 offen offset:3072
  v_mfma_f32_16x16x32_bf16 v[80:83], v[32:35], a[44:47], v[80:83]
  ds_read_b128 v[24:27], v3 offset:15360
  s_waitcnt lgkmcnt(5)
  v_mfma_f32_16x16x32_bf16 v[48:51], v[36:39], a[40:43], v[48:51]
  v_mfma_f32_16x16x32_bf16 v[84:87], v[36:39], a[44:47], v[84:87]
  ds_read_b128 v[28:31], v3 offset:16384
  s_waitcnt lgkmcnt(5)
  v_mfma_f32_16x16x32_bf16 v[52:55], v[40:43], a[40:43], v[52:55]
  s_add_u32 m0, s23, 114688
  s_add_u32 s27, s34, 4096
  v_mfma_f32_16x16x32_bf16 v[88:91], v[40:43], a[44:47], v[88:91]
  ds_read_b128 v[32:35], v3 offset:17408
  s_waitcnt lgkmcnt(5)
  v_mfma_f32_16x16x32_bf16 v[56:59], v[12:15], a[40:43], v[56:59]
  buffer_load_dwordx4 v1, s[8:11], s27 offen offset:0 lds
  v_mfma_f32_16x16x32_bf16 v[92:95], v[12:15], a[44:47], v[92:95]
  ds_read_b128 v[36:39], v3 offset:18432
  s_waitcnt lgkmcnt(5)
  v_mfma_f32_16x16x32_bf16 v[60:63], v[16:19], a[40:43], v[60:63]
  s_add_u32 s28, s35, 147456
  buffer_load_dwordx4 a[100:103], v1, s[12:15], s28 offen offset:0
  v_mfma_f32_16x16x32_bf16 v[96:99], v[16:19], a[44:47], v[96:99]
  ds_read_b128 v[40:43], v3 offset:19456
  s_waitcnt lgkmcnt(5)
  v_mfma_f32_16x16x32_bf16 v[64:67], v[20:23], a[40:43], v[64:67]
  v_mfma_f32_16x16x32_bf16 v[100:103], v[20:23], a[44:47], v[100:103]
  ds_read_b128 v[12:15], v3 offset:20480
  s_waitcnt lgkmcnt(5)
  v_mfma_f32_16x16x32_bf16 v[68:71], v[24:27], a[40:43], v[68:71]
  buffer_load_dwordx4 v1, s[8:11], s27 offen offset:1024 lds
  v_mfma_f32_16x16x32_bf16 v[104:107], v[24:27], a[44:47], v[104:107]
  ds_read_b128 v[16:19], v3 offset:21504
  s_waitcnt lgkmcnt(5)
  v_mfma_f32_16x16x32_bf16 v[72:75], v[28:31], a[40:43], v[72:75]
  v_mfma_f32_16x16x32_bf16 v[108:111], v[28:31], a[44:47], v[108:111]
  ds_read_b128 v[20:23], v3 offset:22528
  s_waitcnt lgkmcnt(5)
  v_mfma_f32_16x16x32_bf16 v[76:79], v[32:35], a[40:43], v[76:79]
  buffer_load_dwordx4 a[108:111], v1, s[12:15], s28 offen offset:1024
  v_mfma_f32_16x16x32_bf16 v[112:115], v[32:35], a[44:47], v[112:115]
  ds_read_b128 v[24:27], v3 offset:23552
  s_waitcnt lgkmcnt(5)
  v_mfma_f32_16x16x32_bf16 v[44:47], v[36:39], a[48:51], v[44:47]
  v_mfma_f32_16x16x32_bf16 v[80:83], v[36:39], a[52:55], v[80:83]
  ds_read_b128 v[28:31], v3 offset:24576
  s_waitcnt lgkmcnt(5)
  v_mfma_f32_16x16x32_bf16 v[48:51], v[40:43], a[48:51], v[48:51]
  buffer_load_dwordx4 v1, s[8:11], s27 offen offset:2048 lds
  v_mfma_f32_16x16x32_bf16 v[84:87], v[40:43], a[52:55], v[84:87]
  ds_read_b128 v[32:35], v3 offset:25600
  s_waitcnt lgkmcnt(5)
  v_mfma_f32_16x16x32_bf16 v[52:55], v[12:15], a[48:51], v[52:55]
  v_mfma_f32_16x16x32_bf16 v[88:91], v[12:15], a[52:55], v[88:91]
  ds_read_b128 v[36:39], v3 offset:26624
  s_waitcnt lgkmcnt(5)
  v_mfma_f32_16x16x32_bf16 v[56:59], v[16:19], a[48:51], v[56:59]
  buffer_load_dwordx4 a[116:119], v1, s[12:15], s28 offen offset:2048
  v_mfma_f32_16x16x32_bf16 v[92:95], v[16:19], a[52:55], v[92:95]
  ds_read_b128 v[40:43], v3 offset:27648
  s_waitcnt lgkmcnt(5)
  v_mfma_f32_16x16x32_bf16 v[60:63], v[20:23], a[48:51], v[60:63]
  v_mfma_f32_16x16x32_bf16 v[96:99], v[20:23], a[52:55], v[96:99]
  ds_read_b128 v[12:15], v3 offset:28672
  s_waitcnt lgkmcnt(5)
  v_mfma_f32_16x16x32_bf16 v[64:67], v[24:27], a[48:51], v[64:67]
  buffer_load_dwordx4 v1, s[8:11], s27 offen offset:3072 lds
  v_mfma_f32_16x16x32_bf16 v[100:103], v[24:27], a[52:55], v[100:103]
  ds_read_b128 v[16:19], v3 offset:29696
  s_waitcnt lgkmcnt(5)
  v_mfma_f32_16x16x32_bf16 v[68:71], v[28:31], a[48:51], v[68:71]
  v_mfma_f32_16x16x32_bf16 v[104:107], v[28:31], a[52:55], v[104:107]
  ds_read_b128 v[20:23], v3 offset:30720
  s_waitcnt lgkmcnt(5)
  v_mfma_f32_16x16x32_bf16 v[72:75], v[32:35], a[48:51], v[72:75]
  buffer_load_dwordx4 a[124:127], v1, s[12:15], s28 offen offset:3072
  v_mfma_f32_16x16x32_bf16 v[108:111], v[32:35], a[52:55], v[108:111]
  ds_read_b128 v[24:27], v3 offset:31744
  s_waitcnt lgkmcnt(5)
  v_mfma_f32_16x16x32_bf16 v[76:79], v[36:39], a[48:51], v[76:79]
  v_mfma_f32_16x16x32_bf16 v[112:115], v[36:39], a[52:55], v[112:115]
  ds_read_b128 v[28:31], v3 offset:32768
  s_waitcnt lgkmcnt(5)
  v_mfma_f32_16x16x32_bf16 v[44:47], v[40:43], a[56:59], v[44:47]
  s_add_u32 m0, s23, 118784
  s_add_u32 s27, s34, 8192
  v_mfma_f32_16x16x32_bf16 v[80:83], v[40:43], a[60:63], v[80:83]
  ds_read_b128 v[32:35], v3 offset:33792
  s_waitcnt lgkmcnt(5)
  v_mfma_f32_16x16x32_bf16 v[48:51], v[12:15], a[56:59], v[48:51]
  buffer_load_dwordx4 v1, s[8:11], s27 offen offset:0 lds
  v_mfma_f32_16x16x32_bf16 v[84:87], v[12:15], a[60:63], v[84:87]
  ds_read_b128 v[36:39], v3 offset:34816
  s_waitcnt lgkmcnt(5)
  v_mfma_f32_16x16x32_bf16 v[52:55], v[16:19], a[56:59], v[52:55]
  v_mfma_f32_16x16x32_bf16 v[88:91], v[16:19], a[60:63], v[88:91]
  ds_read_b128 v[40:43], v3 offset:35840
  s_waitcnt lgkmcnt(5)
  v_mfma_f32_16x16x32_bf16 v[56:59], v[20:23], a[56:59], v[56:59]
  v_mfma_f32_16x16x32_bf16 v[92:95], v[20:23], a[60:63], v[92:95]
  s_waitcnt vmcnt(17)
  s_barrier
  ds_read_b128 v[12:15], v4 offset:0
  s_waitcnt lgkmcnt(5)
  v_mfma_f32_16x16x32_bf16 v[60:63], v[24:27], a[56:59], v[60:63]
  s_mul_i32 s34, s33, 36864
  s_add_u32 s34, s34, s24
  v_mfma_f32_16x16x32_bf16 v[96:99], v[24:27], a[60:63], v[96:99]
  ds_read_b128 v[16:19], v4 offset:1024
  s_waitcnt lgkmcnt(5)
  v_mfma_f32_16x16x32_bf16 v[64:67], v[28:31], a[56:59], v[64:67]
  s_lshl_b32 s35, s33, 12
  s_add_u32 s35, s35, s25
  v_mfma_f32_16x16x32_bf16 v[100:103], v[28:31], a[60:63], v[100:103]
  ds_read_b128 v[20:23], v4 offset:2048
  s_waitcnt lgkmcnt(5)
  v_mfma_f32_16x16x32_bf16 v[68:71], v[32:35], a[56:59], v[68:71]
  s_add_u32 s33, s33, 1
  v_mfma_f32_16x16x32_bf16 v[104:107], v[32:35], a[60:63], v[104:107]
  ds_read_b128 v[24:27], v4 offset:3072
  s_waitcnt lgkmcnt(5)
  v_mfma_f32_16x16x32_bf16 v[72:75], v[36:39], a[56:59], v[72:75]
  s_cmp_eq_u32 s33, 9
  s_cselect_b32 s33, 0, s33
  v_mfma_f32_16x16x32_bf16 v[108:111], v[36:39], a[60:63], v[108:111]
  ds_read_b128 v[28:31], v4 offset:4096
  s_waitcnt lgkmcnt(5)
  v_mfma_f32_16x16x32_bf16 v[76:79], v[40:43], a[56:59], v[76:79]
  s_add_u32 m0, s23, 0
  s_add_u32 s27, s34, 0
  v_mfma_f32_16x16x32_bf16 v[112:115], v[40:43], a[60:63], v[112:115]
  ds_read_b128 v[32:35], v4 offset:5120
  s_waitcnt lgkmcnt(5)
  v_mfma_f32_16x16x32_bf16 v[44:47], v[12:15], a[64:67], v[44:47]
  buffer_load_dwordx4 v1, s[8:11], s27 offen offset:0 lds
  s_add_u32 s28, s35, 0
  v_mfma_f32_16x16x32_bf16 v[80:83], v[12:15], a[68:71], v[80:83]
  ds_read_b128 v[36:39], v4 offset:6144
  s_waitcnt lgkmcnt(5)
  v_mfma_f32_16x16x32_bf16 v[48:51], v[16:19], a[64:67], v[48:51]
  buffer_load_dwordx4 a[0:3], v1, s[12:15], s28 offen offset:0
  buffer_load_dwordx4 v1, s[8:11], s27 offen offset:1024 lds
  v_mfma_f32_16x16x32_bf16 v[84:87], v[16:19], a[68:71], v[84:87]
  ds_read_b128 v[40:43], v4 offset:7168
  s_waitcnt lgkmcnt(5)
  v_mfma_f32_16x16x32_bf16 v[52:55], v[20:23], a[64:67], v[52:55]
  buffer_load_dwordx4 a[8:11], v1, s[12:15], s28 offen offset:1024
  v_mfma_f32_16x16x32_bf16 v[88:91], v[20:23], a[68:71], v[88:91]
  ds_read_b128 v[12:15], v4 offset:8192
  s_waitcnt lgkmcnt(5)
  v_mfma_f32_16x16x32_bf16 v[56:59], v[24:27], a[64:67], v[56:59]
  buffer_load_dwordx4 v1, s[8:11], s27 offen offset:2048 lds
  v_mfma_f32_16x16x32_bf16 v[92:95], v[24:27], a[68:71], v[92:95]
  ds_read_b128 v[16:19], v4 offset:9216
  s_waitcnt lgkmcnt(5)
  v_mfma_f32_16x16x32_bf16 v[60:63], v[28:31], a[64:67], v[60:63]
  v_mfma_f32_16x16x32_bf16 v[96:99], v[28:31], a[68:71], v[96:99]
  ds_read_b128 v[20:23], v4 offset:10240
  s_waitcnt lgkmcnt(5)
  v_mfma_f32_16x16x32_bf16 v[64:67], v[32:35], a[64:67], v[64:67]
  buffer_load_dwordx4 a[16:19], v1, s[12:15], s28 offen offset:2048
  v_mfma_f32_16x16x32_bf16 v[100:103], v[32:35], a[68:71], v[100:103]
  ds_read_b128 v[24:27], v4 offset:11264
  s_waitcnt lgkmcnt(5)
  v_mfma_f32_16x16x32_bf16 v[68:71], v[36:39], a[64:67], v[68:71]
  v_mfma_f32_16x16x32_bf16 v[104:107], v[36:39], a[68:71], v[104:107]
  ds_read_b128 v[28:31], v4 offset:12288
  s_waitcnt lgkmcnt(5)
  v_mfma_f32_16x16x32_bf16 v[72:75], v[40:43], a[64:67], v[72:75]
  buffer_load_dwordx4 v1, s[8:11], s27 offen offset:3072 lds
  v_mfma_f32_16x16x32_bf16 v[108:111], v[40:43], a[68:71], v[108:111]
  ds_read_b128 v[32:35], v4 offset:13312
  s_waitcnt lgkmcnt(5)
  v_mfma_f32_16x16x32_bf16 v[76:79], v[12:15], a[64:67], v[76:79]
  v_mfma_f32_16x16x32_bf16 v[112:115], v[12:15], a[68:71], v[112:115]
  ds_read_b128 v[36:39], v4 offset:14336
  s_waitcnt lgkmcnt(5)
  v_mfma_f32_16x16x32_bf16 v[44:47], v[16:19], a[72:75], v[44:47]
  buffer_load_dwordx4 a[24:27], v1, s[12:15], s28 offen offset:3072
  v_mfma_f32_16x16x32_bf16 v[80:83], v[16:19], a[76:79], v[80:83]
  ds_read_b128 v[40:43], v4 offset:15360
  s_waitcnt lgkmcnt(5)
  v_mfma_f32_16x16x32_bf16 v[48:51], v[20:23], a[72:75], v[48:51]
  v_mfma_f32_16x16x32_bf16 v[84:87], v[20:23], a[76:79], v[84:87]
  ds_read_b128 v[12:15], v4 offset:16384
  s_waitcnt lgkmcnt(5)
  v_mfma_f32_16x16x32_bf16 v[52:55], v[24:27], a[72:75], v[52:55]
  s_add_u32 m0, s23, 4096
  s_add_u32 s27, s34, 4096
  v_mfma_f32_16x16x32_bf16 v[88:91], v[24:27], a[76:79], v[88:91]
  ds_read_b128 v[16:19], v4 offset:17408
  s_waitcnt lgkmcnt(5)
  v_mfma_f32_16x16x32_bf16 v[56:59], v[28:31], a[72:75], v[56:59]
  buffer_load_dwordx4 v1, s[8:11], s27 offen offset:0 lds
  v_mfma_f32_16x16x32_bf16 v[92:95], v[28:31], a[76:79], v[92:95]
  ds_read_b128 v[20:23], v4 offset:18432
  s_waitcnt lgkmcnt(5)
  v_mfma_f32_16x16x32_bf16 v[60:63], v[32:35], a[72:75], v[60:63]
  s_add_u32 s28, s35, 147456
  buffer_load_dwordx4 a[4:7], v1, s[12:15], s28 offen offset:0
  v_mfma_f32_16x16x32_bf16 v[96:99], v[32:35], a[76:79], v[96:99]
  ds_read_b128 v[24:27], v4 offset:19456
  s_waitcnt lgkmcnt(5)
  v_mfma_f32_16x16x32_bf16 v[64:67], v[36:39], a[72:75], v[64:67]
  v_mfma_f32_16x16x32_bf16 v[100:103], v[36:39], a[76:79], v[100:103]
  ds_read_b128 v[28:31], v4 offset:20480
  s_waitcnt lgkmcnt(5)
  v_mfma_f32_16x16x32_bf16 v[68:71], v[40:43], a[72:75], v[68:71]
  buffer_load_dwordx4 v1, s[8:11], s27 offen offset:1024 lds
  v_mfma_f32_16x16x32_bf16 v[104:107], v[40:43], a[76:79], v[104:107]
  ds_read_b128 v[32:35], v4 offset:21504
  s_waitcnt lgkmcnt(5)
  v_mfma_f32_16x16x32_bf16 v[72:75], v[12:15], a[72:75], v[72:75]
  v_mfma_f32_16x16x32_bf16 v[108:111], v[12:15], a[76:79], v[108:111]
  ds_read_b128 v[36:39], v4 offset:22528
  s_waitcnt lgkmcnt(5)
  v_mfma_f32_16x16x32_bf16 v[76:79], v[16:19], a[72:75], v[76:79]
  buffer_load_dwordx4 a[12:15], v1, s[12:15], s28 offen offset:1024
  v_mfma_f32_16x16x32_bf16 v[112:115], v[16:19], a[76:79], v[112:115]
  ds_read_b128 v[40:43], v4 offset:23552
  s_waitcnt lgkmcnt(5)
  v_mfma_f32_16x16x32_bf16 v[44:47], v[20:23], a[80:83], v[44:47]
  v_mfma_f32_16x16x32_bf16 v[80:83], v[20:23], a[84:87], v[80:83]
  ds_read_b128 v[12:15], v4 offset:24576
  s_waitcnt lgkmcnt(5)
  v_mfma_f32_16x16x32_bf16 v[48:51], v[24:27], a[80:83], v[48:51]
  buffer_load_dwordx4 v1, s[8:11], s27 offen offset:2048 lds
  v_mfma_f32_16x16x32_bf16 v[84:87], v[24:27], a[84:87], v[84:87]
  ds_read_b128 v[16:19], v4 offset:25600
  s_waitcnt lgkmcnt(5)
  v_mfma_f32_16x16x32_bf16 v[52:55], v[28:31], a[80:83], v[52:55]
  v_mfma_f32_16x16x32_bf16 v[88:91], v[28:31], a[84:87], v[88:91]
  ds_read_b128 v[20:23], v4 offset:26624
  s_waitcnt lgkmcnt(5)
  v_mfma_f32_16x16x32_bf16 v[56:59], v[32:35], a[80:83], v[56:59]
  buffer_load_dwordx4 a[20:23], v1, s[12:15], s28 offen offset:2048
  v_mfma_f32_16x16x32_bf16 v[92:95], v[32:35], a[84:87], v[92:95]
  ds_read_b128 v[24:27], v4 offset:27648
  s_waitcnt lgkmcnt(5)
  v_mfma_f32_16x16x32_bf16 v[60:63], v[36:39], a[80:83], v[60:63]
  v_mfma_f32_16x16x32_bf16 v[96:99], v[36:39], a[84:87], v[96:99]
  ds_read_b128 v[28:31], v4 offset:28672
  s_waitcnt lgkmcnt(5)
  v_mfma_f32_16x16x32_bf16 v[64:67], v[40:43], a[80:83], v[64:67]
  buffer_load_dwordx4 v1, s[8:11], s27 offen offset:3072 lds
  v_mfma_f32_16x16x32_bf16 v[100:103], v[40:43], a[84:87], v[100:103]
  ds_read_b128 v[32:35], v4 offset:29696
  s_waitcnt lgkmcnt(5)
  v_mfma_f32_16x16x32_bf16 v[68:71], v[12:15], a[80:83], v[68:71]
  v_mfma_f32_16x16x32_bf16 v[104:107], v[12:15], a[84:87], v[104:107]
  ds_read_b128 v[36:39], v4 offset:30720
  s_waitcnt lgkmcnt(5)
  v_mfma_f32_16x16x32_bf16 v[72:75], v[16:19], a[80:83], v[72:75]
  buffer_load_dwordx4 a[28:31], v1, s[12:15], s28 offen offset:3072
  v_mfma_f32_16x16x32_bf16 v[108:111], v[16:19], a[84:87], v[108:111]
  ds_read_b128 v[40:43], v4 offset:31744
  s_waitcnt lgkmcnt(5)
  v_mfma_f32_16x16x32_bf16 v[76:79], v[20:23], a[80:83], v[76:79]
  v_mfma_f32_16x16x32_bf16 v[112:115], v[20:23], a[84:87], v[112:115]
  ds_read_b128 v[12:15], v4 offset:32768
  s_waitcnt lgkmcnt(5)
  v_mfma_f32_16x16x32_bf16 v[44:47], v[24:27], a[88:91], v[44:47]
  s_add_u32 m0, s23, 8192
  s_add_u32 s27, s34, 8192
  v_mfma_f32_16x16x32_bf16 v[80:83], v[24:27], a[92:95], v[80:83]
  ds_read_b128 v[16:19], v4 offset:33792
  s_waitcnt lgkmcnt(5)
  v_mfma_f32_16x16x32_bf16 v[48:51], v[28:31], a[88:91], v[48:51]
  buffer_load_dwordx4 v1, s[8:11], s27 offen offset:0 lds
  v_mfma_f32_16x16x32_bf16 v[84:87], v[28:31], a[92:95], v[84:87]
  ds_read_b128 v[20:23], v4 offset:34816
  s_waitcnt lgkmcnt(5)
  v_mfma_f32_16x16x32_bf16 v[52:55], v[32:35], a[88:91], v[52:55]
  v_mfma_f32_16x16x32_bf16 v[88:91], v[32:35], a[92:95], v[88:91]
  ds_read_b128 v[24:27], v4 offset:35840
  s_waitcnt lgkmcnt(5)
  v_mfma_f32_16x16x32_bf16 v[56:59], v[36:39], a[88:91], v[56:59]
  v_mfma_f32_16x16x32_bf16 v[92:95], v[36:39], a[92:95], v[92:95]
  s_waitcnt vmcnt(17)
  s_barrier
  ds_read_b128 v[28:31], v5 offset:0
  s_waitcnt lgkmcnt(5)
  v_mfma_f32_16x16x32_bf16 v[60:63], v[40:43], a[88:91], v[60:63]
  v_mfma_f32_16x16x32_bf16 v[96:99], v[40:43], a[92:95], v[96:99]
  ds_read_b128 v[32:35], v5 offset:1024
  s_waitcnt lgkmcnt(5)
  v_mfma_f32_16x16x32_bf16 v[64:67], v[12:15], a[88:91], v[64:67]
  v_mfma_f32_16x16x32_bf16 v[100:103], v[12:15], a[92:95], v[100:103]
  ds_read_b128 v[36:39], v5 offset:2048
  s_waitcnt lgkmcnt(5)
  v_mfma_f32_16x16x32_bf16 v[68:71], v[16:19], a[88:91], v[68:71]
  v_mfma_f32_16x16x32_bf16 v[104:107], v[16:19], a[92:95], v[104:107]
  ds_read_b128 v[40:43], v5 offset:3072
  s_waitcnt lgkmcnt(5)
  v_mfma_f32_16x16x32_bf16 v[72:75], v[20:23], a[88:91], v[72:75]
  v_mfma_f32_16x16x32_bf16 v[108:111], v[20:23], a[92:95], v[108:111]
  ds_read_b128 v[12:15], v5 offset:4096
  s_waitcnt lgkmcnt(5)
  v_mfma_f32_16x16x32_bf16 v[76:79], v[24:27], a[88:91], v[76:79]
  v_mfma_f32_16x16x32_bf16 v[112:115], v[24:27], a[92:95], v[112:115]
  ds_read_b128 v[16:19], v5 offset:5120
  s_waitcnt lgkmcnt(5)
  v_mfma_f32_16x16x32_bf16 v[44:47], v[28:31], a[96:99], v[44:47]
  v_mfma_f32_16x16x32_bf16 v[80:83], v[28:31], a[100:103], v[80:83]
  ds_read_b128 v[20:23], v5 offset:6144
  s_waitcnt lgkmcnt(5)
  v_mfma_f32_16x16x32_bf16 v[48:51], v[32:35], a[96:99], v[48:51]
  v_mfma_f32_16x16x32_bf16 v[84:87], v[32:35], a[100:103], v[84:87]
  ds_read_b128 v[24:27], v5 offset:7168
  s_waitcnt lgkmcnt(5)
  v_mfma_f32_16x16x32_bf16 v[52:55], v[36:39], a[96:99], v[52:55]
  v_mfma_f32_16x16x32_bf16 v[88:91], v[36:39], a[100:103], v[88:91]
  ds_read_b128 v[28:31], v5 offset:8192
  s_waitcnt lgkmcnt(5)
  v_mfma_f32_16x16x32_bf16 v[56:59], v[40:43], a[96:99], v[56:59]
  v_mfma_f32_16x16x32_bf16 v[92:95], v[40:43], a[100:103], v[92:95]
  ds_read_b128 v[32:35], v5 offset:9216
  s_waitcnt lgkmcnt(5)
  v_mfma_f32_16x16x32_bf16 v[60:63], v[12:15], a[96:99], v[60:63]
  v_mfma_f32_16x16x32_bf16 v[96:99], v[12:15], a[100:103], v[96:99]
  ds_read_b128 v[36:39], v5 offset:10240
  s_waitcnt lgkmcnt(5)
  v_mfma_f32_16x16x32_bf16 v[64:67], v[16:19], a[96:99], v[64:67]
  v_mfma_f32_16x16x32_bf16 v[100:103], v[16:19], a[100:103], v[100:103]
  ds_read_b128 v[40:43], v5 offset:11264
  s_waitcnt lgkmcnt(5)
  v_mfma_f32_16x16x32_bf16 v[68:71], v[20:23], a[96:99], v[68:71]
  v_mfma_f32_16x16x32_bf16 v[104:107], v[20:23], a[100:103], v[104:107]
  ds_read_b128 v[12:15], v5 offset:12288
  s_waitcnt lgkmcnt(5)
  v_mfma_f32_16x16x32_bf16 v[72:75], v[24:27], a[96:99], v[72:75]
  v_mfma_f32_16x16x32_bf16 v[108:111], v[24:27], a[100:103], v[108:111]
  ds_read_b128 v[16:19], v5 offset:13312
  s_waitcnt lgkmcnt(5)
  v_mfma_f32_16x16x32_bf16 v[76:79], v[28:31], a[96:99], v[76:79]
  v_mfma_f32_16x16x32_bf16 v[112:115], v[28:31], a[100:103], v[112:115]
  ds_read_b128 v[20:23], v5 offset:14336
  s_waitcnt lgkmcnt(5)
  v_mfma_f32_16x16x32_bf16 v[44:47], v[32:35], a[104:107], v[44:47]
  v_mfma_f32_16x16x32_bf16 v[80:83], v[32:35], a[108:111], v[80:83]
  ds_read_b128 v[24:27], v5 offset:15360
  s_waitcnt lgkmcnt(5)
  v_mfma_f32_16x16x32_bf16 v[48:51], v[36:39], a[104:107], v[48:51]
  v_mfma_f32_16x16x32_bf16 v[84:87], v[36:39], a[108:111], v[84:87]
  ds_read_b128 v[28:31], v5 offset:16384
  s_waitcnt lgkmcnt(5)
  v_mfma_f32_16x16x32_bf16 v[52:55], v[40:43], a[104:107], v[52:55]
  v_mfma_f32_16x16x32_bf16 v[88:91], v[40:43], a[108:111], v[88:91]
  ds_read_b128 v[32:35], v5 offset:17408
  s_waitcnt lgkmcnt(5)
  v_mfma_f32_16x16x32_bf16 v[56:59], v[12:15], a[104:107], v[56:59]
  v_mfma_f32_16x16x32_bf16 v[92:95], v[12:15], a[108:111], v[92:95]
  ds_read_b128 v[36:39], v5 offset:18432
  s_waitcnt lgkmcnt(5)
  v_mfma_f32_16x16x32_bf16 v[60:63], v[16:19], a[104:107], v[60:63]
  v_mfma_f32_16x16x32_bf16 v[96:99], v[16:19], a[108:111], v[96:99]
  ds_read_b128 v[40:43], v5 offset:19456
  s_waitcnt lgkmcnt(5)
  v_mfma_f32_16x16x32_bf16 v[64:67], v[20:23], a[104:107], v[64:67]
  v_mfma_f32_16x16x32_bf16 v[100:103], v[20:23], a[108:111], v[100:103]
  ds_read_b128 v[12:15], v5 offset:20480
  s_waitcnt lgkmcnt(5)
  v_mfma_f32_16x16x32_bf16 v[68:71], v[24:27], a[104:107], v[68:71]
  v_mfma_f32_16x16x32_bf16 v[104:107], v[24:27], a[108:111], v[104:107]
  ds_read_b128 v[16:19], v5 offset:21504
  s_waitcnt lgkmcnt(5)
  v_mfma_f32_16x16x32_bf16 v[72:75], v[28:31], a[104:107], v[72:75]
  v_mfma_f32_16x16x32_bf16 v[108:111], v[28:31], a[108:111], v[108:111]
  ds_read_b128 v[20:23], v5 offset:22528
  s_waitcnt lgkmcnt(5)
  v_mfma_f32_16x16x32_bf16 v[76:79], v[32:35], a[104:107], v[76:79]
  v_mfma_f32_16x16x32_bf16 v[112:115], v[32:35], a[108:111], v[112:115]
  ds_read_b128 v[24:27], v5 offset:23552
  s_waitcnt lgkmcnt(5)
  v_mfma_f32_16x16x32_bf16 v[44:47], v[36:39], a[112:115], v[44:47]
  v_mfma_f32_16x16x32_bf16 v[80:83], v[36:39], a[116:119], v[80:83]
  ds_read_b128 v[28:31], v5 offset:24576
  s_waitcnt lgkmcnt(5)
  v_mfma_f32_16x16x32_bf16 v[48:51], v[40:43], a[112:115], v[48:51]
  v_mfma_f32_16x16x32_bf16 v[84:87], v[40:43], a[116:119], v[84:87]
  ds_read_b128 v[32:35], v5 offset:25600
  s_waitcnt lgkmcnt(5)
  v_mfma_f32_16x16x32_bf16 v[52:55], v[12:15], a[112:115], v[52:55]
  v_mfma_f32_16x16x32_bf16 v[88:91], v[12:15], a[116:119], v[88:91]
  ds_read_b128 v[36:39], v5 offset:26624
  s_waitcnt lgkmcnt(5)
  v_mfma_f32_16x16x32_bf16 v[56:59], v[16:19], a[112:115], v[56:59]
  v_mfma_f32_16x16x32_bf16 v[92:95], v[16:19], a[116:119], v[92:95]
  ds_read_b128 v[40:43], v5 offset:27648
  s_waitcnt lgkmcnt(5)
  v_mfma_f32_16x16x32_bf16 v[60:63], v[20:23], a[112:115], v[60:63]
  v_mfma_f32_16x16x32_bf16 v[96:99], v[20:23], a[116:119], v[96:99]
  ds_read_b128 v[12:15], v5 offset:28672
  s_waitcnt lgkmcnt(5)
  v_mfma_f32_16x16x32_bf16 v[64:67], v[24:27], a[112:115], v[64:67]
  v_mfma_f32_16x16x32_bf16 v[100:103], v[24:27], a[116:119], v[100:103]
  ds_read_b128 v[16:19], v5 offset:29696
  s_waitcnt lgkmcnt(5)
  v_mfma_f32_16x16x32_bf16 v[68:71], v[28:31], a[112:115], v[68:71]
  v_mfma_f32_16x16x32_bf16 v[104:107], v[28:31], a[116:119], v[104:107]
  ds_read_b128 v[20:23], v5 offset:30720
  s_waitcnt lgkmcnt(5)
  v_mfma_f32_16x16x32_bf16 v[72:75], v[32:35], a[112:115], v[72:75]
  v_mfma_f32_16x16x32_bf16 v[108:111], v[32:35], a[116:119], v[108:111]
  ds_read_b128 v[24:27], v5 offset:31744
  s_waitcnt lgkmcnt(5)
  v_mfma_f32_16x16x32_bf16 v[76:79], v[36:39], a[112:115], v[76:79]
  v_mfma_f32_16x16x32_bf16 v[112:115], v[36:39], a[116:119], v[112:115]
  ds_read_b128 v[28:31], v5 offset:32768
  s_waitcnt lgkmcnt(5)
  v_mfma_f32_16x16x32_bf16 v[44:47], v[40:43], a[120:123], v[44:47]
  v_mfma_f32_16x16x32_bf16 v[80:83], v[40:43], a[124:127], v[80:83]
  ds_read_b128 v[32:35], v5 offset:33792
  s_waitcnt lgkmcnt(5)
  v_mfma_f32_16x16x32_bf16 v[48:51], v[12:15], a[120:123], v[48:51]
  v_mfma_f32_16x16x32_bf16 v[84:87], v[12:15], a[124:127], v[84:87]
  ds_read_b128 v[36:39], v5 offset:34816
  s_waitcnt lgkmcnt(5)
  v_mfma_f32_16x16x32_bf16 v[52:55], v[16:19], a[120:123], v[52:55]
  v_mfma_f32_16x16x32_bf16 v[88:91], v[16:19], a[124:127], v[88:91]
  ds_read_b128 v[40:43], v5 offset:35840
  s_waitcnt lgkmcnt(5)
  v_mfma_f32_16x16x32_bf16 v[56:59], v[20:23], a[120:123], v[56:59]
  v_mfma_f32_16x16x32_bf16 v[92:95], v[20:23], a[124:127], v[92:95]
  s_waitcnt vmcnt(0)
  s_barrier
  ds_read_b128 v[12:15], v2 offset:0
  s_waitcnt lgkmcnt(5)
  v_mfma_f32_16x16x32_bf16 v[60:63], v[24:27], a[120:123], v[60:63]
  buffer_load_dwordx4 v[164:167], v152, s[44:47], 0 offen
  v_mfma_f32_16x16x32_bf16 v[96:99], v[24:27], a[124:127], v[96:99]
  ds_read_b128 v[16:19], v2 offset:1024
  s_waitcnt lgkmcnt(5)
  v_mfma_f32_16x16x32_bf16 v[64:67], v[28:31], a[120:123], v[64:67]
  buffer_load_dwordx4 v[176:179], v155, s[48:51], s43 offen
  v_mfma_f32_16x16x32_bf16 v[100:103], v[28:31], a[124:127], v[100:103]
  ds_read_b128 v[20:23], v2 offset:2048
  s_waitcnt lgkmcnt(5)
  v_mfma_f32_16x16x32_bf16 v[68:71], v[32:35], a[120:123], v[68:71]
  v_mfma_f32_16x16x32_bf16 v[104:107], v[32:35], a[124:127], v[104:107]
  ds_read_b128 v[24:27], v2 offset:3072
  s_waitcnt lgkmcnt(5)
  v_mfma_f32_16x16x32_bf16 v[72:75], v[36:39], a[120:123], v[72:75]
  buffer_load_dwordx4 v[168:171], v153, s[44:47], 0 offen
  v_mfma_f32_16x16x32_bf16 v[108:111], v[36:39], a[124:127], v[108:111]
  ds_read_b128 v[28:31], v2 offset:4096
  s_waitcnt lgkmcnt(5)
  v_mfma_f32_16x16x32_bf16 v[76:79], v[40:43], a[120:123], v[76:79]
  buffer_load_dwordx4 v[180:183], v156, s[48:51], s43 offen
  v_mfma_f32_16x16x32_bf16 v[112:115], v[40:43], a[124:127], v[112:115]
  ds_read_b128 v[32:35], v2 offset:5120
  s_waitcnt lgkmcnt(5)
  v_mfma_f32_16x16x32_bf16 v[44:47], v[12:15], a[0:3], v[44:47]
  v_mfma_f32_16x16x32_bf16 v[80:83], v[12:15], a[4:7], v[80:83]
  ds_read_b128 v[36:39], v2 offset:6144
  s_waitcnt lgkmcnt(5)
  v_mfma_f32_16x16x32_bf16 v[48:51], v[16:19], a[0:3], v[48:51]
  buffer_load_dwordx4 v[172:175], v154, s[44:47], 0 offen
  v_mfma_f32_16x16x32_bf16 v[84:87], v[16:19], a[4:7], v[84:87]
  ds_read_b128 v[40:43], v2 offset:7168
  s_waitcnt lgkmcnt(5)
  v_mfma_f32_16x16x32_bf16 v[52:55], v[20:23], a[0:3], v[52:55]
  buffer_load_dwordx4 v[184:187], v157, s[48:51], s43 offen
  v_mfma_f32_16x16x32_bf16 v[88:91], v[20:23], a[4:7], v[88:91]
  ds_read_b128 v[12:15], v2 offset:8192
  s_waitcnt lgkmcnt(5)
  v_mfma_f32_16x16x32_bf16 v[56:59], v[24:27], a[0:3], v[56:59]
  v_mfma_f32_16x16x32_bf16 v[92:95], v[24:27], a[4:7], v[92:95]
  ds_read_b128 v[16:19], v2 offset:9216
  s_waitcnt lgkmcnt(5)
  v_mfma_f32_16x16x32_bf16 v[60:63], v[28:31], a[0:3], v[60:63]
  v_mfma_f32_16x16x32_bf16 v[96:99], v[28:31], a[4:7], v[96:99]
  ds_read_b128 v[20:23], v2 offset:10240
  s_waitcnt lgkmcnt(5)
  v_mfma_f32_16x16x32_bf16 v[64:67], v[32:35], a[0:3], v[64:67]
  v_mfma_f32_16x16x32_bf16 v[100:103], v[32:35], a[4:7], v[100:103]
  ds_read_b128 v[24:27], v2 offset:11264
  s_waitcnt lgkmcnt(5)
  v_mfma_f32_16x16x32_bf16 v[68:71], v[36:39], a[0:3], v[68:71]
  v_mfma_f32_16x16x32_bf16 v[104:107], v[36:39], a[4:7], v[104:107]
  ds_read_b128 v[28:31], v2 offset:12288
  s_waitcnt lgkmcnt(5)
  v_mfma_f32_16x16x32_bf16 v[72:75], v[40:43], a[0:3], v[72:75]
  v_mfma_f32_16x16x32_bf16 v[108:111], v[40:43], a[4:7], v[108:111]
  ds_read_b128 v[32:35], v2 offset:13312
  s_waitcnt lgkmcnt(5)
  v_mfma_f32_16x16x32_bf16 v[76:79], v[12:15], a[0:3], v[76:79]
  v_mfma_f32_16x16x32_bf16 v[112:115], v[12:15], a[4:7], v[112:115]
  ds_read_b128 v[36:39], v2 offset:14336
  s_waitcnt lgkmcnt(5)
  v_mfma_f32_16x16x32_bf16 v[44:47], v[16:19], a[8:11], v[44:47]
  v_mfma_f32_16x16x32_bf16 v[80:83], v[16:19], a[12:15], v[80:83]
  ds_read_b128 v[40:43], v2 offset:15360
  s_waitcnt lgkmcnt(5)
  v_mfma_f32_16x16x32_bf16 v[48:51], v[20:23], a[8:11], v[48:51]
  v_mfma_f32_16x16x32_bf16 v[84:87], v[20:23], a[12:15], v[84:87]
  ds_read_b128 v[12:15], v2 offset:16384
  s_waitcnt lgkmcnt(5)
  v_mfma_f32_16x16x32_bf16 v[52:55], v[24:27], a[8:11], v[52:55]
  v_mfma_f32_16x16x32_bf16 v[88:91], v[24:27], a[12:15], v[88:91]
  ds_read_b128 v[16:19], v2 offset:17408
  s_waitcnt lgkmcnt(5)
  v_mfma_f32_16x16x32_bf16 v[56:59], v[28:31], a[8:11], v[56:59]
  v_mfma_f32_16x16x32_bf16 v[92:95], v[28:31], a[12:15], v[92:95]
  ds_read_b128 v[20:23], v2 offset:18432
  s_waitcnt lgkmcnt(5)
  v_mfma_f32_16x16x32_bf16 v[60:63], v[32:35], a[8:11], v[60:63]
  v_mfma_f32_16x16x32_bf16 v[96:99], v[32:35], a[12:15], v[96:99]
  ds_read_b128 v[24:27], v2 offset:19456
  s_waitcnt lgkmcnt(5)
  v_mfma_f32_16x16x32_bf16 v[64:67], v[36:39], a[8:11], v[64:67]
  v_mfma_f32_16x16x32_bf16 v[100:103], v[36:39], a[12:15], v[100:103]
  ds_read_b128 v[28:31], v2 offset:20480
  s_waitcnt lgkmcnt(5)
  v_mfma_f32_16x16x32_bf16 v[68:71], v[40:43], a[8:11], v[68:71]
  v_mfma_f32_16x16x32_bf16 v[104:107], v[40:43], a[12:15], v[104:107]
  ds_read_b128 v[32:35], v2 offset:21504
  s_waitcnt lgkmcnt(5)
  v_mfma_f32_16x16x32_bf16 v[72:75], v[12:15], a[8:11], v[72:75]
  v_mfma_f32_16x16x32_bf16 v[108:111], v[12:15], a[12:15], v[108:111]
  ds_read_b128 v[36:39], v2 offset:22528
  s_waitcnt lgkmcnt(5)
  v_mfma_f32_16x16x32_bf16 v[76:79], v[16:19], a[8:11], v[76:79]
  v_mfma_f32_16x16x32_bf16 v[112:115], v[16:19], a[12:15], v[112:115]
  ds_read_b128 v[40:43], v2 offset:23552
  s_waitcnt lgkmcnt(5)
  v_mfma_f32_16x16x32_bf16 v[44:47], v[20:23], a[16:19], v[44:47]
  v_mfma_f32_16x16x32_bf16 v[80:83], v[20:23], a[20:23], v[80:83]
  ds_read_b128 v[12:15], v2 offset:24576
  s_waitcnt lgkmcnt(5)
  v_mfma_f32_16x16x32_bf16 v[48:51], v[24:27], a[16:19], v[48:51]
  v_mfma_f32_16x16x32_bf16 v[84:87], v[24:27], a[20:23], v[84:87]
  ds_read_b128 v[16:19], v2 offset:25600
  s_waitcnt lgkmcnt(5)
  v_mfma_f32_16x16x32_bf16 v[52:55], v[28:31], a[16:19], v[52:55]
  v_mfma_f32_16x16x32_bf16 v[88:91], v[28:31], a[20:23], v[88:91]
  ds_read_b128 v[20:23], v2 offset:26624
  s_waitcnt lgkmcnt(5)
  v_mfma_f32_16x16x32_bf16 v[56:59], v[32:35], a[16:19], v[56:59]
  v_mfma_f32_16x16x32_bf16 v[92:95], v[32:35], a[20:23], v[92:95]
  ds_read_b128 v[24:27], v2 offset:27648
  s_waitcnt lgkmcnt(5)
  v_mfma_f32_16x16x32_bf16 v[60:63], v[36:39], a[16:19], v[60:63]
  v_mfma_f32_16x16x32_bf16 v[96:99], v[36:39], a[20:23], v[96:99]
  ds_read_b128 v[28:31], v2 offset:28672
  s_waitcnt lgkmcnt(5)
  v_mfma_f32_16x16x32_bf16 v[64:67], v[40:43], a[16:19], v[64:67]
  v_mfma_f32_16x16x32_bf16 v[100:103], v[40:43], a[20:23], v[100:103]
  ds_read_b128 v[32:35], v2 offset:29696
  s_waitcnt lgkmcnt(5)
  v_mfma_f32_16x16x32_bf16 v[68:71], v[12:15], a[16:19], v[68:71]
  v_mfma_f32_16x16x32_bf16 v[104:107], v[12:15], a[20:23], v[104:107]
  ds_read_b128 v[36:39], v2 offset:30720
  s_waitcnt lgkmcnt(5)
  v_mfma_f32_16x16x32_bf16 v[72:75], v[16:19], a[16:19], v[72:75]
  v_mfma_f32_16x16x32_bf16 v[108:111], v[16:19], a[20:23], v[108:111]
  ds_read_b128 v[40:43], v2 offset:31744
  s_waitcnt lgkmcnt(5)
  v_mfma_f32_16x16x32_bf16 v[76:79], v[20:23], a[16:19], v[76:79]
  v_mfma_f32_16x16x32_bf16 v[112:115], v[20:23], a[20:23], v[112:115]
  ds_read_b128 v[12:15], v2 offset:32768
  s_waitcnt lgkmcnt(5)
  v_mfma_f32_16x16x32_bf16 v[44:47], v[24:27], a[24:27], v[44:47]
  v_mfma_f32_16x16x32_bf16 v[80:83], v[24:27], a[28:31], v[80:83]
  ds_read_b128 v[16:19], v2 offset:33792
  s_waitcnt lgkmcnt(5)
  v_mfma_f32_16x16x32_bf16 v[48:51], v[28:31], a[24:27], v[48:51]
  v_mfma_f32_16x16x32_bf16 v[84:87], v[28:31], a[28:31], v[84:87]
  ds_read_b128 v[20:23], v2 offset:34816
  s_waitcnt lgkmcnt(5)
  v_mfma_f32_16x16x32_bf16 v[52:55], v[32:35], a[24:27], v[52:55]
  v_mfma_f32_16x16x32_bf16 v[88:91], v[32:35], a[28:31], v[88:91]
  ds_read_b128 v[24:27], v2 offset:35840
  s_waitcnt lgkmcnt(5)
  v_mfma_f32_16x16x32_bf16 v[56:59], v[36:39], a[24:27], v[56:59]
  v_mfma_f32_16x16x32_bf16 v[92:95], v[36:39], a[28:31], v[92:95]
  s_waitcnt lgkmcnt(4)
  v_mfma_f32_16x16x32_bf16 v[60:63], v[40:43], a[24:27], v[60:63]
  v_mfma_f32_16x16x32_bf16 v[96:99], v[40:43], a[28:31], v[96:99]
  s_waitcnt lgkmcnt(3)
  v_mfma_f32_16x16x32_bf16 v[64:67], v[12:15], a[24:27], v[64:67]
  v_mfma_f32_16x16x32_bf16 v[100:103], v[12:15], a[28:31], v[100:103]
  s_waitcnt lgkmcnt(2)
  v_mfma_f32_16x16x32_bf16 v[68:71], v[16:19], a[24:27], v[68:71]
  v_mfma_f32_16x16x32_bf16 v[104:107], v[16:19], a[28:31], v[104:107]
  s_waitcnt lgkmcnt(1)
  v_mfma_f32_16x16x32_bf16 v[72:75], v[20:23], a[24:27], v[72:75]
  v_mfma_f32_16x16x32_bf16 v[108:111], v[20:23], a[28:31], v[108:111]
  s_waitcnt lgkmcnt(0)
  v_mfma_f32_16x16x32_bf16 v[76:79], v[24:27], a[24:27], v[76:79]
  v_mfma_f32_16x16x32_bf16 v[112:115], v[24:27], a[28:31], v[112:115]
  s_nop 7
  v_add_u32 v8, 73728, v1
  v_add_u32 v10, 73728, v7
  v_cvt_pk_bf16_f32 v116, v44, v48
  v_cvt_pk_bf16_f32 v117, v52, v56
  v_cvt_pk_bf16_f32 v118, v60, v64
  v_cvt_pk_bf16_f32 v119, v68, v72
  v_cvt_pk_bf16_f32 v120, v45, v49
  v_cvt_pk_bf16_f32 v121, v53, v57
  v_cvt_pk_bf16_f32 v122, v61, v65
  v_cvt_pk_bf16_f32 v123, v69, v73
  v_cvt_pk_bf16_f32 v124, v46, v50
  v_cvt_pk_bf16_f32 v125, v54, v58
  v_cvt_pk_bf16_f32 v126, v62, v66
  v_cvt_pk_bf16_f32 v127, v70, v74
  v_cvt_pk_bf16_f32 v128, v47, v51
  v_cvt_pk_bf16_f32 v129, v55, v59
  v_cvt_pk_bf16_f32 v130, v63, v67
  v_cvt_pk_bf16_f32 v131, v71, v75
  v_cvt_pk_bf16_f32 v148, v76, v77
  v_cvt_pk_bf16_f32 v149, v78, v79
  v_permlane16_swap_b32 v116, v120
  v_permlane16_swap_b32 v117, v121
  v_permlane16_swap_b32 v118, v122
  v_permlane16_swap_b32 v119, v123
  v_permlane16_swap_b32 v124, v128
  v_permlane16_swap_b32 v125, v129
  v_permlane16_swap_b32 v126, v130
  v_permlane16_swap_b32 v127, v131
  v_permlane32_swap_b32 v116, v124
  v_permlane32_swap_b32 v117, v125
  v_permlane32_swap_b32 v118, v126
  v_permlane32_swap_b32 v119, v127
  v_permlane32_swap_b32 v120, v128
  v_permlane32_swap_b32 v121, v129
  v_permlane32_swap_b32 v122, v130
  v_permlane32_swap_b32 v123, v131
  s_cmp_eq_u32 s3, s30
  s_cbranch_scc1 K5_OWN0
  s_add_u32 s29, s26, 0
  buffer_store_dwordx4 v[116:119], v1, s[16:19], s29 offen offset:0 sc1
  buffer_store_dwordx4 v[120:123], v1, s[16:19], s29 offen offset:1024 sc1
  buffer_store_dwordx4 v[124:127], v1, s[16:19], s29 offen offset:2048 sc1
  buffer_store_dwordx4 v[128:131], v1, s[16:19], s29 offen offset:3072 sc1
  s_add_u32 s29, s29, 4096
  buffer_store_dwordx2 v[148:149], v7, s[16:19], s29 offen sc1
  s_branch K5_J0
K5_OWN0:
  ds_write_b128 v8, v[116:119] offset:0
  ds_write_b128 v8, v[120:123] offset:1024
  ds_write_b128 v8, v[124:127] offset:2048
  ds_write_b128 v8, v[128:131] offset:3072
  ds_write_b64 v10, v[148:149] offset:4096
K5_J0:
  v_cvt_pk_bf16_f32 v132, v80, v84
  v_cvt_pk_bf16_f32 v133, v88, v92
  v_cvt_pk_bf16_f32 v134, v96, v100
  v_cvt_pk_bf16_f32 v135, v104, v108
  v_cvt_pk_bf16_f32 v136, v81, v85
  v_cvt_pk_bf16_f32 v137, v89, v93
  v_cvt_pk_bf16_f32 v138, v97, v101
  v_cvt_pk_bf16_f32 v139, v105, v109
  v_cvt_pk_bf16_f32 v140, v82, v86
  v_cvt_pk_bf16_f32 v141, v90, v94
  v_cvt_pk_bf16_f32 v142, v98, v102
  v_cvt_pk_bf16_f32 v143, v106, v110
  v_cvt_pk_bf16_f32 v144, v83, v87
  v_cvt_pk_bf16_f32 v145, v91, v95
  v_cvt_pk_bf16_f32 v146, v99, v103
  v_cvt_pk_bf16_f32 v147, v107, v111
  v_cvt_pk_bf16_f32 v150, v112, v113
  v_cvt_pk_bf16_f32 v151, v114, v115
  v_permlane16_swap_b32 v132, v136
  v_permlane16_swap_b32 v133, v137
  v_permlane16_swap_b32 v134, v138
  v_permlane16_swap_b32 v135, v139
  v_permlane16_swap_b32 v140, v144
  v_permlane16_swap_b32 v141, v145
  v_permlane16_swap_b32 v142, v146
  v_permlane16_swap_b32 v143, v147
  v_permlane32_swap_b32 v132, v140
  v_permlane32_swap_b32 v133, v141
  v_permlane32_swap_b32 v134, v142
  v_permlane32_swap_b32 v135, v143
  v_permlane32_swap_b32 v136, v144
  v_permlane32_swap_b32 v137, v145
  v_permlane32_swap_b32 v138, v146
  v_permlane32_swap_b32 v139, v147
  s_cmp_eq_u32 s3, s30
  s_cbranch_scc1 K5_OWN1
  s_add_u32 s29, s26, 4608
  buffer_store_dwordx4 v[132:135], v1, s[16:19], s29 offen offset:0 sc1
  buffer_store_dwordx4 v[136:139], v1, s[16:19], s29 offen offset:1024 sc1
  buffer_store_dwordx4 v[140:143], v1, s[16:19], s29 offen offset:2048 sc1
  buffer_store_dwordx4 v[144:147], v1, s[16:19], s29 offen offset:3072 sc1
  s_add_u32 s29, s29, 4096
  buffer_store_dwordx2 v[150:151], v7, s[16:19], s29 offen sc1
  s_branch K5_J1
K5_OWN1:
  ds_write_b128 v8, v[132:135] offset:4608
  ds_write_b128 v8, v[136:139] offset:5632
  ds_write_b128 v8, v[140:143] offset:6656
  ds_write_b128 v8, v[144:147] offset:7680
  ds_write_b64 v10, v[150:151] offset:8704
K5_J1:
  s_cmp_eq_u32 s3, s30
  s_cbranch_scc1 K5_WOWN
  s_waitcnt vmcnt(10)
  s_branch K5_WJ
K5_WOWN:
  s_waitcnt vmcnt(0)
K5_WJ:
  v_mov_b32 v28, 0x4091afa4
  v_lshlrev_b32 v200, 16, v176
  v_and_b32 v201, 0xffff0000, v176
  v_lshlrev_b32 v202, 16, v177
  v_and_b32 v203, 0xffff0000, v177
  v_lshlrev_b32 v204, 16, v178
  v_and_b32 v205, 0xffff0000, v178
  v_lshlrev_b32 v206, 16, v179
  v_and_b32 v207, 0xffff0000, v179
  v_lshlrev_b32 v224, 16, v164
  v_and_b32 v225, 0xffff0000, v164
  v_lshlrev_b32 v226, 16, v165
  v_and_b32 v227, 0xffff0000, v165
  v_lshlrev_b32 v228, 16, v166
  v_and_b32 v229, 0xffff0000, v166
  v_lshlrev_b32 v230, 16, v167
  v_and_b32 v231, 0xffff0000, v167
  v_pk_mul_f32 v[200:201], v[200:201], v[28:29] op_sel_hi:[1,0]
  v_pk_mul_f32 v[202:203], v[202:203], v[28:29] op_sel_hi:[1,0]
  v_pk_mul_f32 v[204:205], v[204:205], v[28:29] op_sel_hi:[1,0]
  v_pk_mul_f32 v[206:207], v[206:207], v[28:29] op_sel_hi:[1,0]
  v_lshlrev_b32 v208, 16, v180
  v_and_b32 v209, 0xffff0000, v180
  v_lshlrev_b32 v210, 16, v181
  v_and_b32 v211, 0xffff0000, v181
  v_lshlrev_b32 v212, 16, v182
  v_and_b32 v213, 0xffff0000, v182
  v_lshlrev_b32 v214, 16, v183
  v_and_b32 v215, 0xffff0000, v183
  v_lshlrev_b32 v232, 16, v168
  v_and_b32 v233, 0xffff0000, v168
  v_lshlrev_b32 v234, 16, v169
  v_and_b32 v235, 0xffff0000, v169
  v_lshlrev_b32 v236, 16, v170
  v_and_b32 v237, 0xffff0000, v170
  v_lshlrev_b32 v238, 16, v171
  v_and_b32 v239, 0xffff0000, v171
  v_pk_mul_f32 v[208:209], v[208:209], v[28:29] op_sel_hi:[1,0]
  v_pk_mul_f32 v[210:211], v[210:211], v[28:29] op_sel_hi:[1,0]
  v_pk_mul_f32 v[212:213], v[212:213], v[28:29] op_sel_hi:[1,0]
  v_pk_mul_f32 v[214:215], v[214:215], v[28:29] op_sel_hi:[1,0]
  v_lshlrev_b32 v216, 16, v184
  v_and_b32 v217, 0xffff0000, v184
  v_lshlrev_b32 v218, 16, v185
  v_and_b32 v219, 0xffff0000, v185
  v_lshlrev_b32 v220, 16, v186
  v_and_b32 v221, 0xffff0000, v186
  v_lshlrev_b32 v222, 16, v187
  v_and_b32 v223, 0xffff0000, v187
  v_lshlrev_b32 v240, 16, v172
  v_and_b32 v241, 0xffff0000, v172
  v_lshlrev_b32 v242, 16, v173
  v_and_b32 v243, 0xffff0000, v173
  v_lshlrev_b32 v244, 16, v174
  v_and_b32 v245, 0xffff0000, v174
  v_lshlrev_b32 v246, 16, v175
  v_and_b32 v247, 0xffff0000, v175
  v_pk_mul_f32 v[216:217], v[216:217], v[28:29] op_sel_hi:[1,0]
  v_pk_mul_f32 v[218:219], v[218:219], v[28:29] op_sel_hi:[1,0]
  v_pk_mul_f32 v[220:221], v[220:221], v[28:29] op_sel_hi:[1,0]
  v_pk_mul_f32 v[222:223], v[222:223], v[28:29] op_sel_hi:[1,0]
  s_waitcnt vmcnt(0)
  s_waitcnt lgkmcnt(0)
  s_barrier
  s_cmp_eq_u32 s3, 0
  s_cbranch_scc0 K5_NOPOLL
  s_lshl_b32 s29, s41, 7
  v_mov_b32 v10, 1
  v_mov_b32 v11, 0
  s_mov_b64 exec, 1
  buffer_store_dword v10, v11, s[56:59], s29 offen sc1
  s_mov_b64 exec, -1
  v_and_b32 v11, 3, v9
  v_lshlrev_b32 v11, 7, v11
  s_lshl_b32 s28, s40, 9
  s_mov_b32 s29, 0
K5_POLL:
  buffer_load_dword v12, v11, s[56:59], s28 offen sc1
  s_add_u32 s29, s29, 1
  s_waitcnt vmcnt(0)
  v_cmp_eq_u32 vcc, 1, v12
  s_cmp_gt_u32 s29, 400000
  s_cbranch_scc1 K5_NOPOLL
  s_cmp_eq_u64 vcc, exec
  s_cbranch_scc0 K5_POLL
K5_NOPOLL:
  s_barrier
  s_add_u32 s21, s30, 1
  s_and_b32 s21, s21, 3
  s_mul_i32 s21, s21, 2359296
  s_add_u32 s22, s30, 2
  s_and_b32 s22, s22, 3
  s_mul_i32 s22, s22, 2359296
  s_add_u32 s23, s30, 3
  s_and_b32 s23, s23, 3
  s_mul_i32 s23, s23, 2359296
  buffer_load_dwordx4 v[44:47], v158, s[16:19], s21 offen sc1
  buffer_load_dwordx4 v[48:51], v158, s[16:19], s22 offen sc1
  buffer_load_dwordx4 v[52:55], v158, s[16:19], s23 offen sc1
  buffer_load_dwordx4 v[60:63], v159, s[16:19], s21 offen sc1
  buffer_load_dwordx4 v[64:67], v159, s[16:19], s22 offen sc1
  buffer_load_dwordx4 v[68:71], v159, s[16:19], s23 offen sc1
  buffer_load_dwordx4 v[76:79], v160, s[16:19], s21 offen sc1
  buffer_load_dwordx4 v[80:83], v160, s[16:19], s22 offen sc1
  buffer_load_dwordx4 v[84:87], v160, s[16:19], s23 offen sc1
  v_lshlrev_b32 v8, 4, v0
  v_add_u32 v8, 73728, v8
  ds_read_b128 v[56:59], v8 offset:0
  ds_read_b128 v[72:75], v8 offset:4096
  ds_read_b128 v[88:91], v8 offset:8192
  s_waitcnt lgkmcnt(0)
  s_waitcnt vmcnt(6)
  v_lshlrev_b32 v12, 16, v44
  v_and_b32 v13, 0xffff0000, v44
  v_lshlrev_b32 v14, 16, v45
  v_and_b32 v15, 0xffff0000, v45
  v_lshlrev_b32 v16, 16, v46
  v_and_b32 v17, 0xffff0000, v46
  v_lshlrev_b32 v18, 16, v47
  v_and_b32 v19, 0xffff0000, v47
  v_lshlrev_b32 v20, 16, v48
  v_and_b32 v21, 0xffff0000, v48
  v_lshlrev_b32 v22, 16, v49
  v_and_b32 v23, 0xffff0000, v49
  v_lshlrev_b32 v24, 16, v50
  v_and_b32 v25, 0xffff0000, v50
  v_lshlrev_b32 v26, 16, v51
  v_and_b32 v27, 0xffff0000, v51
  v_pk_add_f32 v[12:13], v[12:13], v[20:21]
  v_pk_add_f32 v[14:15], v[14:15], v[22:23]
  v_pk_add_f32 v[16:17], v[16:17], v[24:25]
  v_pk_add_f32 v[18:19], v[18:19], v[26:27]
  v_lshlrev_b32 v20, 16, v52
  v_and_b32 v21, 0xffff0000, v52
  v_lshlrev_b32 v22, 16, v53
  v_and_b32 v23, 0xffff0000, v53
  v_lshlrev_b32 v24, 16, v54
  v_and_b32 v25, 0xffff0000, v54
  v_lshlrev_b32 v26, 16, v55
  v_and_b32 v27, 0xffff0000, v55
  v_pk_add_f32 v[12:13], v[12:13], v[20:21]
  v_pk_add_f32 v[14:15], v[14:15], v[22:23]
  v_pk_add_f32 v[16:17], v[16:17], v[24:25]
  v_pk_add_f32 v[18:19], v[18:19], v[26:27]
  v_lshlrev_b32 v20, 16, v56
  v_and_b32 v21, 0xffff0000, v56
  v_lshlrev_b32 v22, 16, v57
  v_and_b32 v23, 0xffff0000, v57
  v_lshlrev_b32 v24, 16, v58
  v_and_b32 v25, 0xffff0000, v58
  v_lshlrev_b32 v26, 16, v59
  v_and_b32 v27, 0xffff0000, v59
  v_pk_add_f32 v[12:13], v[12:13], v[20:21]
  v_pk_add_f32 v[14:15], v[14:15], v[22:23]
  v_pk_add_f32 v[16:17], v[16:17], v[24:25]
  v_pk_add_f32 v[18:19], v[18:19], v[26:27]
  v_pk_fma_f32 v[12:13], v[12:13], v[200:201], v[224:225]
  v_pk_fma_f32 v[14:15], v[14:15], v[202:203], v[226:227]
  v_pk_fma_f32 v[16:17], v[16:17], v[204:205], v[228:229]
  v_pk_fma_f32 v[18:19], v[18:19], v[206:207], v[230:231]
  v_cvt_pk_bf16_f32 v44, v12, v13
  v_cvt_pk_bf16_f32 v45, v14, v15
  v_cvt_pk_bf16_f32 v46, v16, v17
  v_cvt_pk_bf16_f32 v47, v18, v19
  buffer_store_dwordx4 v[44:47], v152, s[52:55], 0 offen
  s_waitcnt vmcnt(4)
  v_lshlrev_b32 v12, 16, v60
  v_and_b32 v13, 0xffff0000, v60
  v_lshlrev_b32 v14, 16, v61
  v_and_b32 v15, 0xffff0000, v61
  v_lshlrev_b32 v16, 16, v62
  v_and_b32 v17, 0xffff0000, v62
  v_lshlrev_b32 v18, 16, v63
  v_and_b32 v19, 0xffff0000, v63
  v_lshlrev_b32 v20, 16, v64
  v_and_b32 v21, 0xffff0000, v64
  v_lshlrev_b32 v22, 16, v65
  v_and_b32 v23, 0xffff0000, v65
  v_lshlrev_b32 v24, 16, v66
  v_and_b32 v25, 0xffff0000, v66
  v_lshlrev_b32 v26, 16, v67
  v_and_b32 v27, 0xffff0000, v67
  v_pk_add_f32 v[12:13], v[12:13], v[20:21]
  v_pk_add_f32 v[14:15], v[14:15], v[22:23]
  v_pk_add_f32 v[16:17], v[16:17], v[24:25]
  v_pk_add_f32 v[18:19], v[18:19], v[26:27]
  v_lshlrev_b32 v20, 16, v68
  v_and_b32 v21, 0xffff0000, v68
  v_lshlrev_b32 v22, 16, v69
  v_and_b32 v23, 0xffff0000, v69
  v_lshlrev_b32 v24, 16, v70
  v_and_b32 v25, 0xffff0000, v70
  v_lshlrev_b32 v26, 16, v71
  v_and_b32 v27, 0xffff0000, v71
  v_pk_add_f32 v[12:13], v[12:13], v[20:21]
  v_pk_add_f32 v[14:15], v[14:15], v[22:23]
  v_pk_add_f32 v[16:17], v[16:17], v[24:25]
  v_pk_add_f32 v[18:19], v[18:19], v[26:27]
  v_lshlrev_b32 v20, 16, v72
  v_and_b32 v21, 0xffff0000, v72
  v_lshlrev_b32 v22, 16, v73
  v_and_b32 v23, 0xffff0000, v73
  v_lshlrev_b32 v24, 16, v74
  v_and_b32 v25, 0xffff0000, v74
  v_lshlrev_b32 v26, 16, v75
  v_and_b32 v27, 0xffff0000, v75
  v_pk_add_f32 v[12:13], v[12:13], v[20:21]
  v_pk_add_f32 v[14:15], v[14:15], v[22:23]
  v_pk_add_f32 v[16:17], v[16:17], v[24:25]
  v_pk_add_f32 v[18:19], v[18:19], v[26:27]
  v_pk_fma_f32 v[12:13], v[12:13], v[208:209], v[232:233]
  v_pk_fma_f32 v[14:15], v[14:15], v[210:211], v[234:235]
  v_pk_fma_f32 v[16:17], v[16:17], v[212:213], v[236:237]
  v_pk_fma_f32 v[18:19], v[18:19], v[214:215], v[238:239]
  v_cvt_pk_bf16_f32 v60, v12, v13
  v_cvt_pk_bf16_f32 v61, v14, v15
  v_cvt_pk_bf16_f32 v62, v16, v17
  v_cvt_pk_bf16_f32 v63, v18, v19
  buffer_store_dwordx4 v[60:63], v153, s[52:55], 0 offen
  s_waitcnt vmcnt(2)
  v_lshlrev_b32 v12, 16, v76
  v_and_b32 v13, 0xffff0000, v76
  v_lshlrev_b32 v14, 16, v77
  v_and_b32 v15, 0xffff0000, v77
  v_lshlrev_b32 v16, 16, v78
  v_and_b32 v17, 0xffff0000, v78
  v_lshlrev_b32 v18, 16, v79
  v_and_b32 v19, 0xffff0000, v79
  v_lshlrev_b32 v20, 16, v80
  v_and_b32 v21, 0xffff0000, v80
  v_lshlrev_b32 v22, 16, v81
  v_and_b32 v23, 0xffff0000, v81
  v_lshlrev_b32 v24, 16, v82
  v_and_b32 v25, 0xffff0000, v82
  v_lshlrev_b32 v26, 16, v83
  v_and_b32 v27, 0xffff0000, v83
  v_pk_add_f32 v[12:13], v[12:13], v[20:21]
  v_pk_add_f32 v[14:15], v[14:15], v[22:23]
  v_pk_add_f32 v[16:17], v[16:17], v[24:25]
  v_pk_add_f32 v[18:19], v[18:19], v[26:27]
  v_lshlrev_b32 v20, 16, v84
  v_and_b32 v21, 0xffff0000, v84
  v_lshlrev_b32 v22, 16, v85
  v_and_b32 v23, 0xffff0000, v85
  v_lshlrev_b32 v24, 16, v86
  v_and_b32 v25, 0xffff0000, v86
  v_lshlrev_b32 v26, 16, v87
  v_and_b32 v27, 0xffff0000, v87
  v_pk_add_f32 v[12:13], v[12:13], v[20:21]
  v_pk_add_f32 v[14:15], v[14:15], v[22:23]
  v_pk_add_f32 v[16:17], v[16:17], v[24:25]
  v_pk_add_f32 v[18:19], v[18:19], v[26:27]
  v_lshlrev_b32 v20, 16, v88
  v_and_b32 v21, 0xffff0000, v88
  v_lshlrev_b32 v22, 16, v89
  v_and_b32 v23, 0xffff0000, v89
  v_lshlrev_b32 v24, 16, v90
  v_and_b32 v25, 0xffff0000, v90
  v_lshlrev_b32 v26, 16, v91
  v_and_b32 v27, 0xffff0000, v91
  v_pk_add_f32 v[12:13], v[12:13], v[20:21]
  v_pk_add_f32 v[14:15], v[14:15], v[22:23]
  v_pk_add_f32 v[16:17], v[16:17], v[24:25]
  v_pk_add_f32 v[18:19], v[18:19], v[26:27]
  v_pk_fma_f32 v[12:13], v[12:13], v[216:217], v[240:241]
  v_pk_fma_f32 v[14:15], v[14:15], v[218:219], v[242:243]
  v_pk_fma_f32 v[16:17], v[16:17], v[220:221], v[244:245]
  v_pk_fma_f32 v[18:19], v[18:19], v[222:223], v[246:247]
  v_cvt_pk_bf16_f32 v76, v12, v13
  v_cvt_pk_bf16_f32 v77, v14, v15
  v_cvt_pk_bf16_f32 v78, v16, v17
  v_cvt_pk_bf16_f32 v79, v18, v19
  buffer_store_dwordx4 v[76:79], v154, s[52:55], 0 offen
K5_END:
  s_endpgm
TEXT_END:

.section .rodata,"a"
.p2align 6
.amdhsa_kernel prep_kernel
  .amdhsa_next_free_vgpr 168
  .amdhsa_next_free_sgpr 102
  .amdhsa_accum_offset 168
  .amdhsa_group_segment_fixed_size 0
  .amdhsa_kernarg_size 144
  .amdhsa_user_sgpr_count 2
  .amdhsa_user_sgpr_kernarg_segment_ptr 1
  .amdhsa_system_sgpr_workgroup_id_x 1
  .amdhsa_float_denorm_mode_32 3
.end_amdhsa_kernel

.p2align 6
.amdhsa_kernel conv_kernel
  .amdhsa_next_free_vgpr 220
  .amdhsa_next_free_sgpr 102
  .amdhsa_accum_offset 220
  .amdhsa_group_segment_fixed_size 0
  .amdhsa_kernarg_size 144
  .amdhsa_user_sgpr_count 2
  .amdhsa_user_sgpr_kernarg_segment_ptr 1
  .amdhsa_system_sgpr_workgroup_id_x 1
  .amdhsa_float_denorm_mode_32 3
.end_amdhsa_kernel

.p2align 6
.amdhsa_kernel gemm1_kernel
  .amdhsa_next_free_vgpr 512
  .amdhsa_next_free_sgpr 102
  .amdhsa_accum_offset 256
  .amdhsa_group_segment_fixed_size 0
  .amdhsa_kernarg_size 144
  .amdhsa_user_sgpr_count 2
  .amdhsa_user_sgpr_kernarg_segment_ptr 1
  .amdhsa_system_sgpr_workgroup_id_x 1
  .amdhsa_float_denorm_mode_32 3
.end_amdhsa_kernel

.p2align 6
.amdhsa_kernel gemm2_kernel
  .amdhsa_next_free_vgpr 376
  .amdhsa_next_free_sgpr 102
  .amdhsa_accum_offset 248
  .amdhsa_group_segment_fixed_size 0
  .amdhsa_kernarg_size 144
  .amdhsa_user_sgpr_count 2
  .amdhsa_user_sgpr_kernarg_segment_ptr 1
  .amdhsa_system_sgpr_workgroup_id_x 1
  .amdhsa_float_denorm_mode_32 3
.end_amdhsa_kernel
```
